```python
import torch

def _softmax(x, axis=-1):
    return torch.softmax(x, dim=axis)
def _gelu(x):
    return torch.nn.functional.gelu(x, approximate="tanh")
def _silu(x):
    return torch.nn.functional.silu(x)
def _sigmoid(x):
    return torch.sigmoid(x)
def _layernorm(x, axis=-1, eps=1e-5):
    m = x.mean(dim=axis, keepdim=True)
    v = x.var(dim=axis, keepdim=True, unbiased=False)
    return (x - m) / torch.sqrt(v + eps)
def _scatter_add(tgt, idx, src, axis=0):
    return tgt.clone().index_add_(axis, idx, src)
def _segment_sum(src, seg, n):
    out = torch.zeros((n,) + src.shape[1:], dtype=src.dtype)
    return out.index_add_(0, seg, src)
def _pad(x, pw):
    flat = tuple(v for pair in reversed(pw) for v in pair)
    return torch.nn.functional.pad(x, flat)

kernel_name = 'recurrent_scan__ssm_conv_s5__dense_activation_gelu__prompt'

def setup_inputs():

    _w = (lambda a: (lambda t: t.to(torch.bfloat16) if t.is_floating_point() else t)(torch.as_tensor(a)))
    def _A_setup():
        B, S, D = 1, 2048, 640
        P = D
        Lambda_re = -0.5 * (lambda _x: torch.exp(torch.as_tensor(_x)))((lambda *s: torch.randn(*s, dtype=torch.bfloat16) * 0.4)(P))
        Lambda_im = (lambda *s: torch.randn(*s, dtype=torch.bfloat16) * 0.8)(P) * 1.0
        B_re = (lambda *s: torch.randn(*s, dtype=torch.bfloat16) * 0.8)(P, D) * (D ** -0.5)
        B_im = (lambda *s: torch.randn(*s, dtype=torch.bfloat16) * 0.8)(P, D) * (D ** -0.5)
        C_re = (lambda *s: torch.randn(*s, dtype=torch.bfloat16) * 0.4)(D, P) * (P ** -0.5)
        C_im = (lambda *s: torch.randn(*s, dtype=torch.bfloat16) * 0.8)(D, P) * (P ** -0.5)
        log_dt = (lambda *s: torch.randn(*s, dtype=torch.bfloat16) * 0.4)(P) * 0.3 - 2.0
        Dskip = (lambda *s: torch.randn(*s, dtype=torch.bfloat16) * 0.2)(D)
        return {
            "x": _w((lambda *s: torch.randn(*s, dtype=torch.bfloat16) * 0.05)(B, S, D)),
            "Lambda_re": _w(Lambda_re),
            "Lambda_im": _w(Lambda_im),
            "B_re": _w(B_re),
            "B_im": _w(B_im),
            "C_re": _w(C_re),
            "C_im": _w(C_im),
            "log_dt": _w(log_dt),
            "Dskip": _w(Dskip),
        }
    _A_in = _A_setup()

    def _B_setup():
        B, S, D, F = 1, 2048, 640, 1536
        return {
            "x": _w((lambda *s: torch.randn(*s, dtype=torch.bfloat16) * 0.05)(B, S, D)),
            "w1": _w((lambda *s: torch.randn(*s, dtype=torch.bfloat16) * 0.8)(D, F) * (D ** -0.5)),
            "b1": _w((lambda *s: torch.randn(*s, dtype=torch.bfloat16) * 12.8)(F) * 0.01),
            "w2": _w((lambda *s: torch.randn(*s, dtype=torch.bfloat16) * 1.6)(F, D) * (F ** -0.5)),
            "b2": _w((lambda *s: torch.randn(*s, dtype=torch.bfloat16) * 12.8)(D) * 0.01),
        }
    _B_in = _B_setup()

    return {
        "A_x": _A_in["x"],
        "A_Lambda_re": _A_in["Lambda_re"],
        "A_Lambda_im": _A_in["Lambda_im"],
        "A_B_re": _A_in["B_re"],
        "A_B_im": _A_in["B_im"],
        "A_C_re": _A_in["C_re"],
        "A_C_im": _A_in["C_im"],
        "A_log_dt": _A_in["log_dt"],
        "A_Dskip": _A_in["Dskip"],
        "B_x": _B_in["x"],
        "B_w1": _B_in["w1"],
        "B_b1": _B_in["b1"],
        "B_w2": _B_in["w2"],
        "B_b2": _B_in["b2"],
    }

def reference(A_x, A_Lambda_re, A_Lambda_im, A_B_re, A_B_im, A_C_re, A_C_im, A_log_dt, A_Dskip, B_x, B_w1, B_b1, B_w2, B_b2):
    def _A_ref(x, Lambda_re, Lambda_im, B_re, B_im, C_re, C_im, log_dt, Dskip):
        Bsz, L, H = x.shape
        Lam = Lambda_re + 1j * Lambda_im
        Bmat = B_re + 1j * B_im
        Cmat = C_re + 1j * C_im
        dt = torch.exp(log_dt)
        Lam_bar = torch.exp(dt * Lam)
        B_bar = ((Lam_bar - 1.0) / Lam)[:, None] * Bmat
        Bu = torch.einsum("bld,pd->blp", x + 0j, B_bar)
        h = torch.zeros_like(Bu[:, 0, :])
        hs = []
        for t in range(L):
            h = Lam_bar[None, :] * h + Bu[:, t, :]
            hs.append(h)
        hseq = torch.stack(hs, 1)
        y = 2.0 * torch.einsum("blp,dp->bld", hseq, Cmat).real + x * Dskip[None, None, :]
        return y

    def _B_ref(x, w1, b1, w2, b2):
        h = torch.einsum("bsd,df->bsf", x, w1) + b1
        h = _gelu(h)
        return torch.einsum("bsf,fd->bsd", h, w2) + b2

    x = A_x
    xn = _layernorm(x, axis=-1)
    s = _A_ref(xn, A_Lambda_re, A_Lambda_im, A_B_re, A_B_im, A_C_re, A_C_im, A_log_dt, A_Dskip)
    g = _silu(_B_ref(xn, B_w1, B_b1, B_w2, B_b2))
    return x + s * g
```

```asm
; @launch grid=(256,1,1) block=(512,1,1) lds=163840
.amdgcn_target "amdgcn-amd-amdhsa--gfx950"
.text
.globl recurrent_scan__ssm_conv_s5__dense_activation_gelu__prompt_kernel
.p2align 8
.type recurrent_scan__ssm_conv_s5__dense_activation_gelu__prompt_kernel,@function
recurrent_scan__ssm_conv_s5__dense_activation_gelu__prompt_kernel:
    s_cmp_ge_u32 s2, 256
    s_cbranch_scc1 U_end_1
    s_load_dwordx16 s[32:47], s[0:1], 0
    s_load_dwordx16 s[48:63], s[0:1], 64
    s_load_dwordx2 s[10:11], s[0:1], 128
    s_getpc_b64 s[4:5]
    s_lshr_b32 s6, s2, 3
    s_lshl_b32 s6, s6, 11
    v_subrev_u32 v1, 320, v0
    v_cmp_gt_u32 vcc, 16, v1
    v_lshlrev_b32 v1, 7, v1
    v_add_u32 v1, s6, v1
    v_min_u32 v1, 0xa668, v1
    s_and_saveexec_b64 s[6:7], vcc
    s_cbranch_execz U_cpf
    global_load_dword v30, v1, s[4:5]
U_cpf:
    s_mov_b64 exec, -1
    s_lshr_b32 s20, s2, 3
    s_and_b32 s21, s20, 7
    s_lshr_b32 s20, s20, 3
    s_and_b32 s13, s2, 1
    s_lshl_b32 s13, s13, 3
    s_add_u32 s13, s13, s21
    s_lshr_b32 s14, s2, 1
    s_and_b32 s14, s14, 3
    s_lshl_b32 s14, s14, 2
    s_add_u32 s14, s14, s20
    s_lshl_b32 s22, s13, 4
    s_add_u32 s22, s22, s14
    s_mul_i32 s22, s22, 10240
    v_lshrrev_b32 v11, 5, v0
    v_and_b32 v12, 31, v0
    v_mul_u32_u24 v10, 1280, v11
    v_lshl_add_u32 v10, v12, 4, v10
    v_cmp_gt_u32 s[26:27], 16, v12
    v_mov_b32 v13, 0x10000
    v_mov_b32 v17, 0
    v_cndmask_b32 v13, v13, v10, s[26:27]
    s_waitcnt lgkmcnt(0)
    s_add_u32 s64, s32, s22
    s_addc_u32 s65, s33, 0
    s_and_b32 s65, s65, 0xffff
    s_mov_b32 s66, 0x2800
    s_mov_b32 s67, 0x00020000
    buffer_load_dwordx4 v[76:79], v10, s[64:67], 0 offen
    buffer_load_dwordx4 v[80:83], v10, s[64:67], 0 offen offset:512
    buffer_load_dwordx4 v[84:87], v13, s[64:67], 0 offen offset:1024
    s_mov_b32 s92, s62
    s_and_b32 s93, s63, 0xffff
    s_mov_b32 s94, 0x100
    s_mov_b32 s95, 0x00020000
    s_cmp_lg_u32 s2, 0
    s_cbranch_scc1 U_nonon_3
    s_memrealtime s[24:25]
    v_cmp_eq_u32 vcc, 256, v0
    s_and_saveexec_b64 s[6:7], vcc
    s_cbranch_execz U_nonon_3
    s_waitcnt lgkmcnt(0)
    s_or_b32 s24, s24, 1
    v_mov_b32 v20, s24
    v_mov_b32 v21, s25
    buffer_store_dwordx2 v[20:21], v17, s[92:95], 0 offen sc1
U_nonon_3:
    s_mov_b64 exec, -1
    v_lshrrev_b32 v2, 6, v0
    v_and_b32 v1, 63, v0
    s_nop 0
    v_readfirstlane_b32 s12, v2
    s_and_b32 s15, s2, 3
    s_lshl_b32 s15, s15, 3
    s_add_u32 s15, s15, s21
    s_lshr_b32 s16, s2, 2
    s_and_b32 s16, s16, 1
    s_lshl_b32 s16, s16, 2
    s_add_u32 s16, s16, s20
    s_and_b32 s17, s12, 3
    s_and_b32 s18, s17, 1
    s_lshr_b32 s19, s17, 1
    v_lshrrev_b32 v2, 3, v1
    v_and_b32 v3, 7, v1
    v_lshrrev_b32 v6, 4, v1
    v_and_b32 v7, 15, v1
    v_xor_b32 v4, v6, v3
    v_lshlrev_b32 v8, 7, v7
    v_lshl_add_u32 v8, v4, 4, v8
    v_xor_b32 v9, 64, v8
    v_xor_b32 v4, v2, v3
    s_waitcnt lgkmcnt(0)
    s_add_u32 s76, s10, 0x780000
    s_addc_u32 s77, s11, 0
    s_and_b32 s77, s77, 0xffff
    s_mov_b32 s78, 0x6a00
    s_mov_b32 s79, 0x00020000
    s_cmp_ge_u32 s12, 4
    s_cbranch_scc1 U_ld_2
    s_lshl_b32 s21, s13, 7
    s_lshr_b32 s22, s14, 2
    s_lshl_b32 s22, s22, 5
    s_add_u32 s21, s21, s22
    s_lshl_b32 s22, s19, 4
    s_add_u32 s21, s21, s22
    s_and_b32 s22, s14, 3
    s_lshl_b32 s22, s22, 2
    s_add_u32 s21, s21, s22
    s_lshl_b32 s22, s18, 1
    s_add_u32 s21, s21, s22
    s_mul_i32 s21, s21, 1280
    s_add_u32 s21, s21, 0
    s_add_u32 s68, s10, s21
    s_addc_u32 s69, s11, 0
    s_and_b32 s69, s69, 0xffff
    s_mov_b32 s70, 0xa00
    s_mov_b32 s71, 0x00020000
    s_mul_i32 s20, s17, 2560
    v_subrev_u32 v10, s20, v10
    v_subrev_u32 v13, s20, v13
    v_mov_b32 v15, 147456
    v_mov_b32 v24, 0
    v_mov_b32 v25, 0
    v_mov_b32 v26, 0
    v_mov_b32 v27, 0
    ds_write_b128 v15, v[24:27]
    ds_write_b128 v15, v[24:27] offset:16
    s_waitcnt lgkmcnt(0)
    s_barrier
    s_mov_b32 s24, 0xffff0000
    s_waitcnt vmcnt(0)
    v_lshlrev_b32 v88, 16, v76
    v_and_b32 v89, s24, v76
    v_lshlrev_b32 v90, 16, v77
    v_and_b32 v91, s24, v77
    v_lshlrev_b32 v92, 16, v78
    v_and_b32 v93, s24, v78
    v_lshlrev_b32 v94, 16, v79
    v_and_b32 v95, s24, v79
    v_lshlrev_b32 v96, 16, v80
    v_and_b32 v97, s24, v80
    v_lshlrev_b32 v98, 16, v81
    v_and_b32 v99, s24, v81
    v_lshlrev_b32 v100, 16, v82
    v_and_b32 v101, s24, v82
    v_lshlrev_b32 v102, 16, v83
    v_and_b32 v103, s24, v83
    v_lshlrev_b32 v104, 16, v84
    v_and_b32 v105, s24, v84
    v_lshlrev_b32 v106, 16, v85
    v_and_b32 v107, s24, v85
    v_lshlrev_b32 v108, 16, v86
    v_and_b32 v109, s24, v86
    v_lshlrev_b32 v110, 16, v87
    v_and_b32 v111, s24, v87
    v_pk_add_f32 v[112:113], v[88:89], v[90:91]
    v_pk_add_f32 v[114:115], v[92:93], v[94:95]
    v_pk_add_f32 v[112:113], v[112:113], v[96:97]
    v_pk_add_f32 v[114:115], v[114:115], v[98:99]
    v_pk_add_f32 v[112:113], v[112:113], v[100:101]
    v_pk_add_f32 v[114:115], v[114:115], v[102:103]
    v_pk_add_f32 v[112:113], v[112:113], v[104:105]
    v_pk_add_f32 v[114:115], v[114:115], v[106:107]
    v_pk_add_f32 v[112:113], v[112:113], v[108:109]
    v_pk_add_f32 v[114:115], v[114:115], v[110:111]
    v_pk_add_f32 v[112:113], v[112:113], v[114:115]
    v_add_f32 v112, v112, v113
    s_nop 1
    v_add_f32_dpp v112, v112, v112 row_ror:8 row_mask:0xf bank_mask:0xf
    s_nop 1
    v_add_f32_dpp v112, v112, v112 row_ror:4 row_mask:0xf bank_mask:0xf
    s_nop 1
    v_add_f32_dpp v112, v112, v112 row_ror:2 row_mask:0xf bank_mask:0xf
    s_nop 1
    v_add_f32_dpp v112, v112, v112 row_ror:1 row_mask:0xf bank_mask:0xf
    ds_swizzle_b32 v113, v112 offset:0x401F
    s_waitcnt lgkmcnt(0)
    v_add_f32 v112, v112, v113
    v_mul_f32 v112, 0xbacccccd, v112
    v_mov_b32 v113, v112
    v_pk_add_f32 v[116:117], v[88:89], v[112:113]
    v_pk_mul_f32 v[120:121], v[116:117], v[116:117]
    v_pk_add_f32 v[118:119], v[90:91], v[112:113]
    v_pk_fma_f32 v[120:121], v[118:119], v[118:119], v[120:121]
    v_pk_add_f32 v[116:117], v[92:93], v[112:113]
    v_pk_fma_f32 v[120:121], v[116:117], v[116:117], v[120:121]
    v_pk_add_f32 v[118:119], v[94:95], v[112:113]
    v_pk_fma_f32 v[120:121], v[118:119], v[118:119], v[120:121]
    v_pk_add_f32 v[116:117], v[96:97], v[112:113]
    v_pk_fma_f32 v[120:121], v[116:117], v[116:117], v[120:121]
    v_pk_add_f32 v[118:119], v[98:99], v[112:113]
    v_pk_fma_f32 v[120:121], v[118:119], v[118:119], v[120:121]
    v_pk_add_f32 v[116:117], v[100:101], v[112:113]
    v_pk_fma_f32 v[120:121], v[116:117], v[116:117], v[120:121]
    v_pk_add_f32 v[118:119], v[102:103], v[112:113]
    v_pk_fma_f32 v[120:121], v[118:119], v[118:119], v[120:121]
    v_pk_add_f32 v[116:117], v[104:105], v[112:113]
    v_pk_mul_f32 v[122:123], v[116:117], v[116:117]
    v_pk_add_f32 v[118:119], v[106:107], v[112:113]
    v_pk_fma_f32 v[122:123], v[118:119], v[118:119], v[122:123]
    v_pk_add_f32 v[116:117], v[108:109], v[112:113]
    v_pk_fma_f32 v[122:123], v[116:117], v[116:117], v[122:123]
    v_pk_add_f32 v[118:119], v[110:111], v[112:113]
    v_pk_fma_f32 v[122:123], v[118:119], v[118:119], v[122:123]
    v_add_f32 v120, v120, v121
    v_add_f32 v122, v122, v123
    v_cndmask_b32 v122, 0, v122, s[26:27]
    v_add_f32 v120, v120, v122
    s_nop 1
    v_add_f32_dpp v120, v120, v120 row_ror:8 row_mask:0xf bank_mask:0xf
    s_nop 1
    v_add_f32_dpp v120, v120, v120 row_ror:4 row_mask:0xf bank_mask:0xf
    s_nop 1
    v_add_f32_dpp v120, v120, v120 row_ror:2 row_mask:0xf bank_mask:0xf
    s_nop 1
    v_add_f32_dpp v120, v120, v120 row_ror:1 row_mask:0xf bank_mask:0xf
    ds_swizzle_b32 v121, v120 offset:0x401F
    s_waitcnt lgkmcnt(0)
    v_add_f32 v120, v120, v121
    v_mul_f32 v120, 0x3acccccd, v120
    v_cvt_pk_bf16_f32 v114, v112, v120
    v_lshlrev_b32 v112, 16, v114
    v_mov_b32 v113, v112
    v_and_b32 v120, s24, v114
    v_add_f32 v120, 0x3727c5ac, v120
    v_cvt_pk_bf16_f32 v120, v120, v120
    v_and_b32 v120, s24, v120
    v_sqrt_f32 v120, v120
    s_nop 0
    v_cvt_pk_bf16_f32 v120, v120, v120
    v_and_b32 v120, s24, v120
    v_rcp_f32 v116, v120
    s_nop 0
    v_fma_f32 v118, -v120, v116, 1.0
    v_fma_f32 v116, v118, v116, v116
    v_mov_b32 v117, v116
    v_sub_f32 v120, 0, v120
    v_mov_b32 v121, v120
    v_pk_add_f32 v[88:89], v[88:89], v[112:113]
    v_pk_add_f32 v[90:91], v[90:91], v[112:113]
    v_pk_add_f32 v[92:93], v[92:93], v[112:113]
    v_pk_add_f32 v[94:95], v[94:95], v[112:113]
    v_pk_add_f32 v[96:97], v[96:97], v[112:113]
    v_pk_add_f32 v[98:99], v[98:99], v[112:113]
    v_pk_add_f32 v[100:101], v[100:101], v[112:113]
    v_pk_add_f32 v[102:103], v[102:103], v[112:113]
    v_pk_add_f32 v[104:105], v[104:105], v[112:113]
    v_pk_add_f32 v[106:107], v[106:107], v[112:113]
    v_pk_add_f32 v[108:109], v[108:109], v[112:113]
    v_pk_add_f32 v[110:111], v[110:111], v[112:113]
    v_cvt_pk_bf16_f32 v76, v88, v89
    v_cvt_pk_bf16_f32 v77, v90, v91
    v_cvt_pk_bf16_f32 v78, v92, v93
    v_cvt_pk_bf16_f32 v79, v94, v95
    v_cvt_pk_bf16_f32 v80, v96, v97
    v_cvt_pk_bf16_f32 v81, v98, v99
    v_cvt_pk_bf16_f32 v82, v100, v101
    v_cvt_pk_bf16_f32 v83, v102, v103
    v_cvt_pk_bf16_f32 v84, v104, v105
    v_cvt_pk_bf16_f32 v85, v106, v107
    v_cvt_pk_bf16_f32 v86, v108, v109
    v_cvt_pk_bf16_f32 v87, v110, v111
    v_lshlrev_b32 v88, 16, v76
    v_and_b32 v89, s24, v76
    v_pk_mul_f32 v[124:125], v[88:89], v[116:117]
    v_pk_fma_f32 v[126:127], v[124:125], v[120:121], v[88:89]
    v_pk_fma_f32 v[124:125], v[126:127], v[116:117], v[124:125]
    v_cvt_pk_bf16_f32 v76, v124, v125
    v_lshlrev_b32 v90, 16, v77
    v_and_b32 v91, s24, v77
    v_pk_mul_f32 v[128:129], v[90:91], v[116:117]
    v_pk_fma_f32 v[130:131], v[128:129], v[120:121], v[90:91]
    v_pk_fma_f32 v[128:129], v[130:131], v[116:117], v[128:129]
    v_cvt_pk_bf16_f32 v77, v128, v129
    v_lshlrev_b32 v92, 16, v78
    v_and_b32 v93, s24, v78
    v_pk_mul_f32 v[132:133], v[92:93], v[116:117]
    v_pk_fma_f32 v[134:135], v[132:133], v[120:121], v[92:93]
    v_pk_fma_f32 v[132:133], v[134:135], v[116:117], v[132:133]
    v_cvt_pk_bf16_f32 v78, v132, v133
    v_lshlrev_b32 v94, 16, v79
    v_and_b32 v95, s24, v79
    v_pk_mul_f32 v[136:137], v[94:95], v[116:117]
    v_pk_fma_f32 v[138:139], v[136:137], v[120:121], v[94:95]
    v_pk_fma_f32 v[136:137], v[138:139], v[116:117], v[136:137]
    v_cvt_pk_bf16_f32 v79, v136, v137
    v_lshlrev_b32 v96, 16, v80
    v_and_b32 v97, s24, v80
    v_pk_mul_f32 v[124:125], v[96:97], v[116:117]
    v_pk_fma_f32 v[126:127], v[124:125], v[120:121], v[96:97]
    v_pk_fma_f32 v[124:125], v[126:127], v[116:117], v[124:125]
    v_cvt_pk_bf16_f32 v80, v124, v125
    v_lshlrev_b32 v98, 16, v81
    v_and_b32 v99, s24, v81
    v_pk_mul_f32 v[128:129], v[98:99], v[116:117]
    v_pk_fma_f32 v[130:131], v[128:129], v[120:121], v[98:99]
    v_pk_fma_f32 v[128:129], v[130:131], v[116:117], v[128:129]
    v_cvt_pk_bf16_f32 v81, v128, v129
    v_lshlrev_b32 v100, 16, v82
    v_and_b32 v101, s24, v82
    v_pk_mul_f32 v[132:133], v[100:101], v[116:117]
    v_pk_fma_f32 v[134:135], v[132:133], v[120:121], v[100:101]
    v_pk_fma_f32 v[132:133], v[134:135], v[116:117], v[132:133]
    v_cvt_pk_bf16_f32 v82, v132, v133
    v_lshlrev_b32 v102, 16, v83
    v_and_b32 v103, s24, v83
    v_pk_mul_f32 v[136:137], v[102:103], v[116:117]
    v_pk_fma_f32 v[138:139], v[136:137], v[120:121], v[102:103]
    v_pk_fma_f32 v[136:137], v[138:139], v[116:117], v[136:137]
    v_cvt_pk_bf16_f32 v83, v136, v137
    v_lshlrev_b32 v104, 16, v84
    v_and_b32 v105, s24, v84
    v_pk_mul_f32 v[124:125], v[104:105], v[116:117]
    v_pk_fma_f32 v[126:127], v[124:125], v[120:121], v[104:105]
    v_pk_fma_f32 v[124:125], v[126:127], v[116:117], v[124:125]
    v_cvt_pk_bf16_f32 v84, v124, v125
    v_lshlrev_b32 v106, 16, v85
    v_and_b32 v107, s24, v85
    v_pk_mul_f32 v[128:129], v[106:107], v[116:117]
    v_pk_fma_f32 v[130:131], v[128:129], v[120:121], v[106:107]
    v_pk_fma_f32 v[128:129], v[130:131], v[116:117], v[128:129]
    v_cvt_pk_bf16_f32 v85, v128, v129
    v_lshlrev_b32 v108, 16, v86
    v_and_b32 v109, s24, v86
    v_pk_mul_f32 v[132:133], v[108:109], v[116:117]
    v_pk_fma_f32 v[134:135], v[132:133], v[120:121], v[108:109]
    v_pk_fma_f32 v[132:133], v[134:135], v[116:117], v[132:133]
    v_cvt_pk_bf16_f32 v86, v132, v133
    v_lshlrev_b32 v110, 16, v87
    v_and_b32 v111, s24, v87
    v_pk_mul_f32 v[136:137], v[110:111], v[116:117]
    v_pk_fma_f32 v[138:139], v[136:137], v[120:121], v[110:111]
    v_pk_fma_f32 v[136:137], v[138:139], v[116:117], v[136:137]
    v_cvt_pk_bf16_f32 v87, v136, v137
    buffer_store_dwordx4 v[76:79], v10, s[68:71], 0 offen sc1
    buffer_store_dwordx4 v[80:83], v10, s[68:71], 0 offen offset:512 sc1
    buffer_store_dwordx4 v[84:87], v13, s[68:71], 0 offen offset:1024 sc1
    s_waitcnt vmcnt(0)
    v_mov_b32 v16, 1
    v_cmp_eq_u32 vcc, 0, v1
    s_and_saveexec_b64 s[26:27], vcc
    ds_add_rtn_u32 v18, v15, v16
    s_waitcnt lgkmcnt(0)
    v_readfirstlane_b32 s20, v18
    s_nop 3
    s_cmp_lg_u32 s20, 3
    s_cbranch_scc1 U_nsig_4
    s_mov_b32 s31, 0x1000000
U_iw_5:
    ds_read_b32 v18, v15 offset:16
    s_waitcnt lgkmcnt(0)
    v_readfirstlane_b32 s30, v18
    s_sub_u32 s31, s31, 1
    s_cbranch_scc1 U_iwd_6
    s_nop 1
    s_cmp_ge_u32 s30, 1
    s_cbranch_scc1 U_iwd_6
    s_sleep 1
    s_branch U_iw_5
U_iwd_6:
    ds_read_b64 v[20:21], v15 offset:16
    s_lshl_b32 s20, s13, 8
    s_lshl_b32 s21, s14, 3
    s_add_u32 s20, s20, s21
    s_waitcnt lgkmcnt(0)
    buffer_store_dwordx2 v[20:21], v17, s[76:79], s20 offen sc1
U_nsig_4:
    s_mov_b64 exec, -1
    s_cmp_lg_u32 s17, 0
    s_cbranch_scc1 U_p0d_9
    s_mov_b32 s31, 0x1000000
U_iw_10:
    ds_read_b32 v18, v15 offset:16
    s_waitcnt lgkmcnt(0)
    v_readfirstlane_b32 s30, v18
    s_sub_u32 s31, s31, 1
    s_cbranch_scc1 U_iwd_11
    s_nop 1
    s_cmp_ge_u32 s30, 1
    s_cbranch_scc1 U_iwd_11
    s_sleep 1
    s_branch U_iw_10
U_iwd_11:
    ds_read_b64 v[20:21], v15 offset:16
    s_lshl_b32 s24, s13, 8
    v_lshlrev_b32 v19, 3, v7
    s_mov_b32 s31, 0x100000
U_xq_12:
    buffer_load_dwordx2 v[22:23], v19, s[76:79], s24 offen sc1
    s_waitcnt vmcnt(0) lgkmcnt(0)
    v_cmp_eq_u64 vcc, v[20:21], v[22:23]
    s_nop 3
    s_cmp_eq_u64 vcc, -1
    s_cbranch_scc1 U_xqd_13
    s_sleep 2
    s_sub_u32 s31, s31, 1
    s_cmp_lg_u32 s31, 0
    s_cbranch_scc1 U_xq_12
U_xqd_13:
    ds_write_b32 v15, v16 offset:4
U_p0d_9:
    s_mov_b32 s80, s54
    s_and_b32 s81, s55, 0xffff
    s_mov_b32 s82, 0xc00
    s_mov_b32 s83, 0x00020000
    s_mul_i32 s21, s14, 192
    v_lshlrev_b32 v11, 3, v6
    buffer_load_dwordx2 v[64:65], v11, s[80:83], s21 offen offset:0
    buffer_load_dwordx2 v[66:67], v11, s[80:83], s21 offen offset:32
    buffer_load_dwordx2 v[68:69], v11, s[80:83], s21 offen offset:64
    buffer_load_dwordx2 v[70:71], v11, s[80:83], s21 offen offset:96
    buffer_load_dwordx2 v[72:73], v11, s[80:83], s21 offen offset:128
    buffer_load_dwordx2 v[74:75], v11, s[80:83], s21 offen offset:160
    v_lshrrev_b32 v10, 2, v7
    v_and_b32 v11, 3, v7
    v_lshrrev_b32 v12, 1, v6
    v_and_b32 v13, 1, v6
    v_lshlrev_b32 v12, 4, v12
    v_lshl_add_u32 v12, v13, 2, v12
    v_add_u32 v12, v12, v10
    v_lshlrev_b32 v12, 6, v12
    v_lshl_add_u32 v12, v13, 5, v12
    v_lshl_add_u32 v12, v11, 3, v12
    v_xor_b32 v13, 32, v12
    s_lshl_b32 s20, s17, 12
    s_add_u32 s21, s20, 0
    v_add_u32 v228, s21, v8
    v_add_u32 v229, s21, v9
    v_add_u32 v230, 16384, v12
    v_add_u32 v231, 16384, v13
    v_add_u32 v232, 16384, v8
    v_add_u32 v233, 16384, v9
    s_add_u32 s21, s20, 36864
    v_add_u32 v234, s21, v8
    v_add_u32 v235, s21, v9
    v_add_u32 v236, 53248, v12
    v_add_u32 v237, 53248, v13
    v_add_u32 v238, 53248, v8
    v_add_u32 v239, 53248, v9
    s_add_u32 s21, s20, 73728
    v_add_u32 v240, s21, v8
    v_add_u32 v241, s21, v9
    v_add_u32 v242, 90112, v12
    v_add_u32 v243, 90112, v13
    v_add_u32 v244, 90112, v8
    v_add_u32 v245, 90112, v9
    s_add_u32 s21, s20, 110592
    v_add_u32 v246, s21, v8
    v_add_u32 v247, s21, v9
    v_add_u32 v248, 126976, v12
    v_add_u32 v249, 126976, v13
    v_add_u32 v250, 126976, v8
    v_add_u32 v251, 126976, v9
    v_lshlrev_b32 v5, 2, v7
    s_waitcnt lgkmcnt(0)
    s_waitcnt lgkmcnt(0)
    s_barrier
    ds_read_b64_tr_b16 v[84:85], v230 offset:0
    ds_read_b64_tr_b16 v[86:87], v230 offset:512
    ds_read_b128 v[76:79], v228 offset:0
    ds_read_b128 v[80:83], v228 offset:2048
    ds_read_b64_tr_b16 v[88:89], v231 offset:0
    ds_read_b64_tr_b16 v[90:91], v231 offset:512
    ds_read_b64_tr_b16 v[92:93], v230 offset:4096
    ds_read_b64_tr_b16 v[94:95], v230 offset:4608
    ds_read_b64_tr_b16 v[96:97], v231 offset:4096
    ds_read_b64_tr_b16 v[98:99], v231 offset:4608
    ds_read_b64_tr_b16 v[100:101], v230 offset:8192
    ds_read_b64_tr_b16 v[102:103], v230 offset:8704
    ds_read_b64_tr_b16 v[104:105], v231 offset:8192
    ds_read_b64_tr_b16 v[106:107], v231 offset:8704
    s_waitcnt lgkmcnt(0)
    v_mfma_f32_16x16x32_bf16 v[16:19], v[84:87], v[76:79], 0
    ds_read_b64_tr_b16 v[116:117], v230 offset:2048
    ds_read_b64_tr_b16 v[118:119], v230 offset:2560
    v_mfma_f32_16x16x32_bf16 v[40:43], v[84:87], v[80:83], 0
    ds_read_b128 v[108:111], v229 offset:0
    ds_read_b128 v[112:115], v229 offset:2048
    v_mfma_f32_16x16x32_bf16 v[20:23], v[88:91], v[76:79], 0
    ds_read_b64_tr_b16 v[120:121], v231 offset:2048
    ds_read_b64_tr_b16 v[122:123], v231 offset:2560
    v_mfma_f32_16x16x32_bf16 v[44:47], v[88:91], v[80:83], 0
    ds_read_b64_tr_b16 v[124:125], v230 offset:6144
    ds_read_b64_tr_b16 v[126:127], v230 offset:6656
    v_mfma_f32_16x16x32_bf16 v[24:27], v[92:95], v[76:79], 0
    ds_read_b64_tr_b16 v[128:129], v231 offset:6144
    ds_read_b64_tr_b16 v[130:131], v231 offset:6656
    v_mfma_f32_16x16x32_bf16 v[48:51], v[92:95], v[80:83], 0
    ds_read_b64_tr_b16 v[132:133], v230 offset:10240
    ds_read_b64_tr_b16 v[134:135], v230 offset:10752
    v_mfma_f32_16x16x32_bf16 v[28:31], v[96:99], v[76:79], 0
    ds_read_b64_tr_b16 v[136:137], v231 offset:10240
    ds_read_b64_tr_b16 v[138:139], v231 offset:10752
    v_mfma_f32_16x16x32_bf16 v[52:55], v[96:99], v[80:83], 0
    v_mfma_f32_16x16x32_bf16 v[32:35], v[100:103], v[76:79], 0
    v_mfma_f32_16x16x32_bf16 v[56:59], v[100:103], v[80:83], 0
    v_mfma_f32_16x16x32_bf16 v[36:39], v[104:107], v[76:79], 0
    v_mfma_f32_16x16x32_bf16 v[60:63], v[104:107], v[80:83], 0
    s_waitcnt lgkmcnt(0)
    s_barrier
    v_mfma_f32_16x16x32_bf16 v[16:19], v[116:119], v[108:111], v[16:19]
    ds_read_b64_tr_b16 v[84:85], v236 offset:0
    ds_read_b64_tr_b16 v[86:87], v236 offset:512
    v_mfma_f32_16x16x32_bf16 v[40:43], v[116:119], v[112:115], v[40:43]
    ds_read_b128 v[76:79], v234 offset:0
    ds_read_b128 v[80:83], v234 offset:2048
    v_mfma_f32_16x16x32_bf16 v[20:23], v[120:123], v[108:111], v[20:23]
    ds_read_b64_tr_b16 v[88:89], v237 offset:0
    ds_read_b64_tr_b16 v[90:91], v237 offset:512
    v_mfma_f32_16x16x32_bf16 v[44:47], v[120:123], v[112:115], v[44:47]
    ds_read_b64_tr_b16 v[92:93], v236 offset:4096
    ds_read_b64_tr_b16 v[94:95], v236 offset:4608
    v_mfma_f32_16x16x32_bf16 v[24:27], v[124:127], v[108:111], v[24:27]
    ds_read_b64_tr_b16 v[96:97], v237 offset:4096
    ds_read_b64_tr_b16 v[98:99], v237 offset:4608
    v_mfma_f32_16x16x32_bf16 v[48:51], v[124:127], v[112:115], v[48:51]
    ds_read_b64_tr_b16 v[100:101], v236 offset:8192
    ds_read_b64_tr_b16 v[102:103], v236 offset:8704
    v_mfma_f32_16x16x32_bf16 v[28:31], v[128:131], v[108:111], v[28:31]
    ds_read_b64_tr_b16 v[104:105], v237 offset:8192
    ds_read_b64_tr_b16 v[106:107], v237 offset:8704
    v_mfma_f32_16x16x32_bf16 v[52:55], v[128:131], v[112:115], v[52:55]
    v_mfma_f32_16x16x32_bf16 v[32:35], v[132:135], v[108:111], v[32:35]
    v_mfma_f32_16x16x32_bf16 v[56:59], v[132:135], v[112:115], v[56:59]
    v_mfma_f32_16x16x32_bf16 v[36:39], v[136:139], v[108:111], v[36:39]
    v_mfma_f32_16x16x32_bf16 v[60:63], v[136:139], v[112:115], v[60:63]
    s_waitcnt lgkmcnt(0)
    v_mfma_f32_16x16x32_bf16 v[16:19], v[84:87], v[76:79], v[16:19]
    ds_read_b64_tr_b16 v[116:117], v236 offset:2048
    ds_read_b64_tr_b16 v[118:119], v236 offset:2560
    v_mfma_f32_16x16x32_bf16 v[40:43], v[84:87], v[80:83], v[40:43]
    ds_read_b128 v[108:111], v235 offset:0
    ds_read_b128 v[112:115], v235 offset:2048
    v_mfma_f32_16x16x32_bf16 v[20:23], v[88:91], v[76:79], v[20:23]
    ds_read_b64_tr_b16 v[120:121], v237 offset:2048
    ds_read_b64_tr_b16 v[122:123], v237 offset:2560
    v_mfma_f32_16x16x32_bf16 v[44:47], v[88:91], v[80:83], v[44:47]
    ds_read_b64_tr_b16 v[124:125], v236 offset:6144
    ds_read_b64_tr_b16 v[126:127], v236 offset:6656
    v_mfma_f32_16x16x32_bf16 v[24:27], v[92:95], v[76:79], v[24:27]
    ds_read_b64_tr_b16 v[128:129], v237 offset:6144
    ds_read_b64_tr_b16 v[130:131], v237 offset:6656
    v_mfma_f32_16x16x32_bf16 v[48:51], v[92:95], v[80:83], v[48:51]
    ds_read_b64_tr_b16 v[132:133], v236 offset:10240
    ds_read_b64_tr_b16 v[134:135], v236 offset:10752
    v_mfma_f32_16x16x32_bf16 v[28:31], v[96:99], v[76:79], v[28:31]
    ds_read_b64_tr_b16 v[136:137], v237 offset:10240
    ds_read_b64_tr_b16 v[138:139], v237 offset:10752
    v_mfma_f32_16x16x32_bf16 v[52:55], v[96:99], v[80:83], v[52:55]
    v_mfma_f32_16x16x32_bf16 v[32:35], v[100:103], v[76:79], v[32:35]
    v_mfma_f32_16x16x32_bf16 v[56:59], v[100:103], v[80:83], v[56:59]
    v_mfma_f32_16x16x32_bf16 v[36:39], v[104:107], v[76:79], v[36:39]
    v_mfma_f32_16x16x32_bf16 v[60:63], v[104:107], v[80:83], v[60:63]
    s_waitcnt lgkmcnt(0)
    s_barrier
    v_mfma_f32_16x16x32_bf16 v[16:19], v[116:119], v[108:111], v[16:19]
    ds_read_b64_tr_b16 v[84:85], v242 offset:0
    ds_read_b64_tr_b16 v[86:87], v242 offset:512
    v_mfma_f32_16x16x32_bf16 v[40:43], v[116:119], v[112:115], v[40:43]
    ds_read_b128 v[76:79], v240 offset:0
    ds_read_b128 v[80:83], v240 offset:2048
    v_mfma_f32_16x16x32_bf16 v[20:23], v[120:123], v[108:111], v[20:23]
    ds_read_b64_tr_b16 v[88:89], v243 offset:0
    ds_read_b64_tr_b16 v[90:91], v243 offset:512
    v_mfma_f32_16x16x32_bf16 v[44:47], v[120:123], v[112:115], v[44:47]
    ds_read_b64_tr_b16 v[92:93], v242 offset:4096
    ds_read_b64_tr_b16 v[94:95], v242 offset:4608
    v_mfma_f32_16x16x32_bf16 v[24:27], v[124:127], v[108:111], v[24:27]
    ds_read_b64_tr_b16 v[96:97], v243 offset:4096
    ds_read_b64_tr_b16 v[98:99], v243 offset:4608
    v_mfma_f32_16x16x32_bf16 v[48:51], v[124:127], v[112:115], v[48:51]
    ds_read_b64_tr_b16 v[100:101], v242 offset:8192
    ds_read_b64_tr_b16 v[102:103], v242 offset:8704
    v_mfma_f32_16x16x32_bf16 v[28:31], v[128:131], v[108:111], v[28:31]
    ds_read_b64_tr_b16 v[104:105], v243 offset:8192
    ds_read_b64_tr_b16 v[106:107], v243 offset:8704
    v_mfma_f32_16x16x32_bf16 v[52:55], v[128:131], v[112:115], v[52:55]
    v_mfma_f32_16x16x32_bf16 v[32:35], v[132:135], v[108:111], v[32:35]
    v_mfma_f32_16x16x32_bf16 v[56:59], v[132:135], v[112:115], v[56:59]
    v_mfma_f32_16x16x32_bf16 v[36:39], v[136:139], v[108:111], v[36:39]
    v_mfma_f32_16x16x32_bf16 v[60:63], v[136:139], v[112:115], v[60:63]
    s_waitcnt lgkmcnt(0)
    v_mfma_f32_16x16x32_bf16 v[16:19], v[84:87], v[76:79], v[16:19]
    ds_read_b64_tr_b16 v[116:117], v242 offset:2048
    ds_read_b64_tr_b16 v[118:119], v242 offset:2560
    v_mfma_f32_16x16x32_bf16 v[40:43], v[84:87], v[80:83], v[40:43]
    ds_read_b128 v[108:111], v241 offset:0
    ds_read_b128 v[112:115], v241 offset:2048
    v_mfma_f32_16x16x32_bf16 v[20:23], v[88:91], v[76:79], v[20:23]
    ds_read_b64_tr_b16 v[120:121], v243 offset:2048
    ds_read_b64_tr_b16 v[122:123], v243 offset:2560
    v_mfma_f32_16x16x32_bf16 v[44:47], v[88:91], v[80:83], v[44:47]
    ds_read_b64_tr_b16 v[124:125], v242 offset:6144
    ds_read_b64_tr_b16 v[126:127], v242 offset:6656
    v_mfma_f32_16x16x32_bf16 v[24:27], v[92:95], v[76:79], v[24:27]
    ds_read_b64_tr_b16 v[128:129], v243 offset:6144
    ds_read_b64_tr_b16 v[130:131], v243 offset:6656
    v_mfma_f32_16x16x32_bf16 v[48:51], v[92:95], v[80:83], v[48:51]
    ds_read_b64_tr_b16 v[132:133], v242 offset:10240
    ds_read_b64_tr_b16 v[134:135], v242 offset:10752
    v_mfma_f32_16x16x32_bf16 v[28:31], v[96:99], v[76:79], v[28:31]
    ds_read_b64_tr_b16 v[136:137], v243 offset:10240
    ds_read_b64_tr_b16 v[138:139], v243 offset:10752
    v_mfma_f32_16x16x32_bf16 v[52:55], v[96:99], v[80:83], v[52:55]
    v_mfma_f32_16x16x32_bf16 v[32:35], v[100:103], v[76:79], v[32:35]
    v_mfma_f32_16x16x32_bf16 v[56:59], v[100:103], v[80:83], v[56:59]
    v_mfma_f32_16x16x32_bf16 v[36:39], v[104:107], v[76:79], v[36:39]
    v_mfma_f32_16x16x32_bf16 v[60:63], v[104:107], v[80:83], v[60:63]
    s_waitcnt lgkmcnt(0)
    s_barrier
    v_mfma_f32_16x16x32_bf16 v[16:19], v[116:119], v[108:111], v[16:19]
    ds_read_b64_tr_b16 v[84:85], v248 offset:0
    ds_read_b64_tr_b16 v[86:87], v248 offset:512
    v_mfma_f32_16x16x32_bf16 v[40:43], v[116:119], v[112:115], v[40:43]
    ds_read_b128 v[76:79], v246 offset:0
    ds_read_b128 v[80:83], v246 offset:2048
    v_mfma_f32_16x16x32_bf16 v[20:23], v[120:123], v[108:111], v[20:23]
    ds_read_b64_tr_b16 v[88:89], v249 offset:0
    ds_read_b64_tr_b16 v[90:91], v249 offset:512
    v_mfma_f32_16x16x32_bf16 v[44:47], v[120:123], v[112:115], v[44:47]
    ds_read_b64_tr_b16 v[92:93], v248 offset:4096
    ds_read_b64_tr_b16 v[94:95], v248 offset:4608
    v_mfma_f32_16x16x32_bf16 v[24:27], v[124:127], v[108:111], v[24:27]
    ds_read_b64_tr_b16 v[96:97], v249 offset:4096
    ds_read_b64_tr_b16 v[98:99], v249 offset:4608
    v_mfma_f32_16x16x32_bf16 v[48:51], v[124:127], v[112:115], v[48:51]
    ds_read_b64_tr_b16 v[100:101], v248 offset:8192
    ds_read_b64_tr_b16 v[102:103], v248 offset:8704
    v_mfma_f32_16x16x32_bf16 v[28:31], v[128:131], v[108:111], v[28:31]
    ds_read_b64_tr_b16 v[104:105], v249 offset:8192
    ds_read_b64_tr_b16 v[106:107], v249 offset:8704
    v_mfma_f32_16x16x32_bf16 v[52:55], v[128:131], v[112:115], v[52:55]
    v_mfma_f32_16x16x32_bf16 v[32:35], v[132:135], v[108:111], v[32:35]
    v_mfma_f32_16x16x32_bf16 v[56:59], v[132:135], v[112:115], v[56:59]
    v_mfma_f32_16x16x32_bf16 v[36:39], v[136:139], v[108:111], v[36:39]
    v_mfma_f32_16x16x32_bf16 v[60:63], v[136:139], v[112:115], v[60:63]
    s_waitcnt lgkmcnt(0)
    v_mfma_f32_16x16x32_bf16 v[16:19], v[84:87], v[76:79], v[16:19]
    ds_read_b64_tr_b16 v[116:117], v248 offset:2048
    ds_read_b64_tr_b16 v[118:119], v248 offset:2560
    v_mfma_f32_16x16x32_bf16 v[40:43], v[84:87], v[80:83], v[40:43]
    ds_read_b128 v[108:111], v247 offset:0
    ds_read_b128 v[112:115], v247 offset:2048
    v_mfma_f32_16x16x32_bf16 v[20:23], v[88:91], v[76:79], v[20:23]
    ds_read_b64_tr_b16 v[120:121], v249 offset:2048
    ds_read_b64_tr_b16 v[122:123], v249 offset:2560
    v_mfma_f32_16x16x32_bf16 v[44:47], v[88:91], v[80:83], v[44:47]
    ds_read_b64_tr_b16 v[124:125], v248 offset:6144
    ds_read_b64_tr_b16 v[126:127], v248 offset:6656
    v_mfma_f32_16x16x32_bf16 v[24:27], v[92:95], v[76:79], v[24:27]
    ds_read_b64_tr_b16 v[128:129], v249 offset:6144
    ds_read_b64_tr_b16 v[130:131], v249 offset:6656
    v_mfma_f32_16x16x32_bf16 v[48:51], v[92:95], v[80:83], v[48:51]
    ds_read_b64_tr_b16 v[132:133], v248 offset:10240
    ds_read_b64_tr_b16 v[134:135], v248 offset:10752
    v_mfma_f32_16x16x32_bf16 v[28:31], v[96:99], v[76:79], v[28:31]
    ds_read_b64_tr_b16 v[136:137], v249 offset:10240
    ds_read_b64_tr_b16 v[138:139], v249 offset:10752
    v_mfma_f32_16x16x32_bf16 v[52:55], v[96:99], v[80:83], v[52:55]
    v_mfma_f32_16x16x32_bf16 v[32:35], v[100:103], v[76:79], v[32:35]
    v_mfma_f32_16x16x32_bf16 v[56:59], v[100:103], v[80:83], v[56:59]
    v_mfma_f32_16x16x32_bf16 v[36:39], v[104:107], v[76:79], v[36:39]
    v_mfma_f32_16x16x32_bf16 v[60:63], v[104:107], v[80:83], v[60:63]
    s_waitcnt lgkmcnt(0)
    s_barrier
    v_mfma_f32_16x16x32_bf16 v[16:19], v[116:119], v[108:111], v[16:19]
    ds_read_b64_tr_b16 v[84:85], v230 offset:0
    ds_read_b64_tr_b16 v[86:87], v230 offset:512
    v_mfma_f32_16x16x32_bf16 v[40:43], v[116:119], v[112:115], v[40:43]
    ds_read_b128 v[76:79], v228 offset:0
    ds_read_b128 v[80:83], v228 offset:2048
    v_mfma_f32_16x16x32_bf16 v[20:23], v[120:123], v[108:111], v[20:23]
    ds_read_b64_tr_b16 v[88:89], v231 offset:0
    ds_read_b64_tr_b16 v[90:91], v231 offset:512
    v_mfma_f32_16x16x32_bf16 v[44:47], v[120:123], v[112:115], v[44:47]
    ds_read_b64_tr_b16 v[92:93], v230 offset:4096
    ds_read_b64_tr_b16 v[94:95], v230 offset:4608
    v_mfma_f32_16x16x32_bf16 v[24:27], v[124:127], v[108:111], v[24:27]
    ds_read_b64_tr_b16 v[96:97], v231 offset:4096
    ds_read_b64_tr_b16 v[98:99], v231 offset:4608
    v_mfma_f32_16x16x32_bf16 v[48:51], v[124:127], v[112:115], v[48:51]
    ds_read_b64_tr_b16 v[100:101], v230 offset:8192
    ds_read_b64_tr_b16 v[102:103], v230 offset:8704
    v_mfma_f32_16x16x32_bf16 v[28:31], v[128:131], v[108:111], v[28:31]
    ds_read_b64_tr_b16 v[104:105], v231 offset:8192
    ds_read_b64_tr_b16 v[106:107], v231 offset:8704
    v_mfma_f32_16x16x32_bf16 v[52:55], v[128:131], v[112:115], v[52:55]
    v_mfma_f32_16x16x32_bf16 v[32:35], v[132:135], v[108:111], v[32:35]
    v_mfma_f32_16x16x32_bf16 v[56:59], v[132:135], v[112:115], v[56:59]
    v_mfma_f32_16x16x32_bf16 v[36:39], v[136:139], v[108:111], v[36:39]
    v_mfma_f32_16x16x32_bf16 v[60:63], v[136:139], v[112:115], v[60:63]
    s_waitcnt lgkmcnt(0)
    v_mfma_f32_16x16x32_bf16 v[16:19], v[84:87], v[76:79], v[16:19]
    ds_read_b64_tr_b16 v[116:117], v230 offset:2048
    ds_read_b64_tr_b16 v[118:119], v230 offset:2560
    v_mfma_f32_16x16x32_bf16 v[40:43], v[84:87], v[80:83], v[40:43]
    ds_read_b128 v[108:111], v229 offset:0
    ds_read_b128 v[112:115], v229 offset:2048
    v_mfma_f32_16x16x32_bf16 v[20:23], v[88:91], v[76:79], v[20:23]
    ds_read_b64_tr_b16 v[120:121], v231 offset:2048
    ds_read_b64_tr_b16 v[122:123], v231 offset:2560
    v_mfma_f32_16x16x32_bf16 v[44:47], v[88:91], v[80:83], v[44:47]
    ds_read_b64_tr_b16 v[124:125], v230 offset:6144
    ds_read_b64_tr_b16 v[126:127], v230 offset:6656
    v_mfma_f32_16x16x32_bf16 v[24:27], v[92:95], v[76:79], v[24:27]
    ds_read_b64_tr_b16 v[128:129], v231 offset:6144
    ds_read_b64_tr_b16 v[130:131], v231 offset:6656
    v_mfma_f32_16x16x32_bf16 v[48:51], v[92:95], v[80:83], v[48:51]
    ds_read_b64_tr_b16 v[132:133], v230 offset:10240
    ds_read_b64_tr_b16 v[134:135], v230 offset:10752
    v_mfma_f32_16x16x32_bf16 v[28:31], v[96:99], v[76:79], v[28:31]
    ds_read_b64_tr_b16 v[136:137], v231 offset:10240
    ds_read_b64_tr_b16 v[138:139], v231 offset:10752
    v_mfma_f32_16x16x32_bf16 v[52:55], v[96:99], v[80:83], v[52:55]
    v_mfma_f32_16x16x32_bf16 v[32:35], v[100:103], v[76:79], v[32:35]
    v_mfma_f32_16x16x32_bf16 v[56:59], v[100:103], v[80:83], v[56:59]
    v_mfma_f32_16x16x32_bf16 v[36:39], v[104:107], v[76:79], v[36:39]
    v_mfma_f32_16x16x32_bf16 v[60:63], v[104:107], v[80:83], v[60:63]
    s_waitcnt lgkmcnt(0)
    s_barrier
    v_mfma_f32_16x16x32_bf16 v[16:19], v[116:119], v[108:111], v[16:19]
    ds_read_b64_tr_b16 v[84:85], v236 offset:0
    ds_read_b64_tr_b16 v[86:87], v236 offset:512
    v_mfma_f32_16x16x32_bf16 v[40:43], v[116:119], v[112:115], v[40:43]
    ds_read_b128 v[76:79], v234 offset:0
    ds_read_b128 v[80:83], v234 offset:2048
    v_mfma_f32_16x16x32_bf16 v[20:23], v[120:123], v[108:111], v[20:23]
    ds_read_b64_tr_b16 v[88:89], v237 offset:0
    ds_read_b64_tr_b16 v[90:91], v237 offset:512
    v_mfma_f32_16x16x32_bf16 v[44:47], v[120:123], v[112:115], v[44:47]
    ds_read_b64_tr_b16 v[92:93], v236 offset:4096
    ds_read_b64_tr_b16 v[94:95], v236 offset:4608
    v_mfma_f32_16x16x32_bf16 v[24:27], v[124:127], v[108:111], v[24:27]
    ds_read_b64_tr_b16 v[96:97], v237 offset:4096
    ds_read_b64_tr_b16 v[98:99], v237 offset:4608
    v_mfma_f32_16x16x32_bf16 v[48:51], v[124:127], v[112:115], v[48:51]
    ds_read_b64_tr_b16 v[100:101], v236 offset:8192
    ds_read_b64_tr_b16 v[102:103], v236 offset:8704
    v_mfma_f32_16x16x32_bf16 v[28:31], v[128:131], v[108:111], v[28:31]
    ds_read_b64_tr_b16 v[104:105], v237 offset:8192
    ds_read_b64_tr_b16 v[106:107], v237 offset:8704
    v_mfma_f32_16x16x32_bf16 v[52:55], v[128:131], v[112:115], v[52:55]
    v_mfma_f32_16x16x32_bf16 v[32:35], v[132:135], v[108:111], v[32:35]
    v_mfma_f32_16x16x32_bf16 v[56:59], v[132:135], v[112:115], v[56:59]
    v_mfma_f32_16x16x32_bf16 v[36:39], v[136:139], v[108:111], v[36:39]
    v_mfma_f32_16x16x32_bf16 v[60:63], v[136:139], v[112:115], v[60:63]
    s_waitcnt lgkmcnt(0)
    v_mfma_f32_16x16x32_bf16 v[16:19], v[84:87], v[76:79], v[16:19]
    ds_read_b64_tr_b16 v[116:117], v236 offset:2048
    ds_read_b64_tr_b16 v[118:119], v236 offset:2560
    v_mfma_f32_16x16x32_bf16 v[40:43], v[84:87], v[80:83], v[40:43]
    ds_read_b128 v[108:111], v235 offset:0
    ds_read_b128 v[112:115], v235 offset:2048
    v_mfma_f32_16x16x32_bf16 v[20:23], v[88:91], v[76:79], v[20:23]
    ds_read_b64_tr_b16 v[120:121], v237 offset:2048
    ds_read_b64_tr_b16 v[122:123], v237 offset:2560
    v_mfma_f32_16x16x32_bf16 v[44:47], v[88:91], v[80:83], v[44:47]
    ds_read_b64_tr_b16 v[124:125], v236 offset:6144
    ds_read_b64_tr_b16 v[126:127], v236 offset:6656
    v_mfma_f32_16x16x32_bf16 v[24:27], v[92:95], v[76:79], v[24:27]
    ds_read_b64_tr_b16 v[128:129], v237 offset:6144
    ds_read_b64_tr_b16 v[130:131], v237 offset:6656
    v_mfma_f32_16x16x32_bf16 v[48:51], v[92:95], v[80:83], v[48:51]
    ds_read_b64_tr_b16 v[132:133], v236 offset:10240
    ds_read_b64_tr_b16 v[134:135], v236 offset:10752
    v_mfma_f32_16x16x32_bf16 v[28:31], v[96:99], v[76:79], v[28:31]
    ds_read_b64_tr_b16 v[136:137], v237 offset:10240
    ds_read_b64_tr_b16 v[138:139], v237 offset:10752
    v_mfma_f32_16x16x32_bf16 v[52:55], v[96:99], v[80:83], v[52:55]
    v_mfma_f32_16x16x32_bf16 v[32:35], v[100:103], v[76:79], v[32:35]
    v_mfma_f32_16x16x32_bf16 v[56:59], v[100:103], v[80:83], v[56:59]
    v_mfma_f32_16x16x32_bf16 v[36:39], v[104:107], v[76:79], v[36:39]
    v_mfma_f32_16x16x32_bf16 v[60:63], v[104:107], v[80:83], v[60:63]
    s_waitcnt lgkmcnt(0)
    s_barrier
    v_mfma_f32_16x16x32_bf16 v[16:19], v[116:119], v[108:111], v[16:19]
    ds_read_b64_tr_b16 v[84:85], v242 offset:0
    ds_read_b64_tr_b16 v[86:87], v242 offset:512
    v_mfma_f32_16x16x32_bf16 v[40:43], v[116:119], v[112:115], v[40:43]
    ds_read_b128 v[76:79], v240 offset:0
    ds_read_b128 v[80:83], v240 offset:2048
    v_mfma_f32_16x16x32_bf16 v[20:23], v[120:123], v[108:111], v[20:23]
    ds_read_b64_tr_b16 v[88:89], v243 offset:0
    ds_read_b64_tr_b16 v[90:91], v243 offset:512
    v_mfma_f32_16x16x32_bf16 v[44:47], v[120:123], v[112:115], v[44:47]
    ds_read_b64_tr_b16 v[92:93], v242 offset:4096
    ds_read_b64_tr_b16 v[94:95], v242 offset:4608
    v_mfma_f32_16x16x32_bf16 v[24:27], v[124:127], v[108:111], v[24:27]
    ds_read_b64_tr_b16 v[96:97], v243 offset:4096
    ds_read_b64_tr_b16 v[98:99], v243 offset:4608
    v_mfma_f32_16x16x32_bf16 v[48:51], v[124:127], v[112:115], v[48:51]
    ds_read_b64_tr_b16 v[100:101], v242 offset:8192
    ds_read_b64_tr_b16 v[102:103], v242 offset:8704
    v_mfma_f32_16x16x32_bf16 v[28:31], v[128:131], v[108:111], v[28:31]
    ds_read_b64_tr_b16 v[104:105], v243 offset:8192
    ds_read_b64_tr_b16 v[106:107], v243 offset:8704
    v_mfma_f32_16x16x32_bf16 v[52:55], v[128:131], v[112:115], v[52:55]
    v_mfma_f32_16x16x32_bf16 v[32:35], v[132:135], v[108:111], v[32:35]
    v_mfma_f32_16x16x32_bf16 v[56:59], v[132:135], v[112:115], v[56:59]
    v_mfma_f32_16x16x32_bf16 v[36:39], v[136:139], v[108:111], v[36:39]
    v_mfma_f32_16x16x32_bf16 v[60:63], v[136:139], v[112:115], v[60:63]
    s_waitcnt lgkmcnt(0)
    v_mfma_f32_16x16x32_bf16 v[16:19], v[84:87], v[76:79], v[16:19]
    ds_read_b64_tr_b16 v[116:117], v242 offset:2048
    ds_read_b64_tr_b16 v[118:119], v242 offset:2560
    v_mfma_f32_16x16x32_bf16 v[40:43], v[84:87], v[80:83], v[40:43]
    ds_read_b128 v[108:111], v241 offset:0
    ds_read_b128 v[112:115], v241 offset:2048
    v_mfma_f32_16x16x32_bf16 v[20:23], v[88:91], v[76:79], v[20:23]
    ds_read_b64_tr_b16 v[120:121], v243 offset:2048
    ds_read_b64_tr_b16 v[122:123], v243 offset:2560
    v_mfma_f32_16x16x32_bf16 v[44:47], v[88:91], v[80:83], v[44:47]
    ds_read_b64_tr_b16 v[124:125], v242 offset:6144
    ds_read_b64_tr_b16 v[126:127], v242 offset:6656
    v_mfma_f32_16x16x32_bf16 v[24:27], v[92:95], v[76:79], v[24:27]
    ds_read_b64_tr_b16 v[128:129], v243 offset:6144
    ds_read_b64_tr_b16 v[130:131], v243 offset:6656
    v_mfma_f32_16x16x32_bf16 v[48:51], v[92:95], v[80:83], v[48:51]
    ds_read_b64_tr_b16 v[132:133], v242 offset:10240
    ds_read_b64_tr_b16 v[134:135], v242 offset:10752
    v_mfma_f32_16x16x32_bf16 v[28:31], v[96:99], v[76:79], v[28:31]
    ds_read_b64_tr_b16 v[136:137], v243 offset:10240
    ds_read_b64_tr_b16 v[138:139], v243 offset:10752
    v_mfma_f32_16x16x32_bf16 v[52:55], v[96:99], v[80:83], v[52:55]
    v_mfma_f32_16x16x32_bf16 v[32:35], v[100:103], v[76:79], v[32:35]
    v_mfma_f32_16x16x32_bf16 v[56:59], v[100:103], v[80:83], v[56:59]
    v_mfma_f32_16x16x32_bf16 v[36:39], v[104:107], v[76:79], v[36:39]
    v_mfma_f32_16x16x32_bf16 v[60:63], v[104:107], v[80:83], v[60:63]
    s_waitcnt lgkmcnt(0)
    s_barrier
    v_mfma_f32_16x16x32_bf16 v[16:19], v[116:119], v[108:111], v[16:19]
    ds_read_b64_tr_b16 v[84:85], v248 offset:0
    ds_read_b64_tr_b16 v[86:87], v248 offset:512
    v_mfma_f32_16x16x32_bf16 v[40:43], v[116:119], v[112:115], v[40:43]
    ds_read_b128 v[76:79], v246 offset:0
    ds_read_b128 v[80:83], v246 offset:2048
    v_mfma_f32_16x16x32_bf16 v[20:23], v[120:123], v[108:111], v[20:23]
    ds_read_b64_tr_b16 v[88:89], v249 offset:0
    ds_read_b64_tr_b16 v[90:91], v249 offset:512
    v_mfma_f32_16x16x32_bf16 v[44:47], v[120:123], v[112:115], v[44:47]
    ds_read_b64_tr_b16 v[92:93], v248 offset:4096
    ds_read_b64_tr_b16 v[94:95], v248 offset:4608
    v_mfma_f32_16x16x32_bf16 v[24:27], v[124:127], v[108:111], v[24:27]
    ds_read_b64_tr_b16 v[96:97], v249 offset:4096
    ds_read_b64_tr_b16 v[98:99], v249 offset:4608
    v_mfma_f32_16x16x32_bf16 v[48:51], v[124:127], v[112:115], v[48:51]
    ds_read_b64_tr_b16 v[100:101], v248 offset:8192
    ds_read_b64_tr_b16 v[102:103], v248 offset:8704
    v_mfma_f32_16x16x32_bf16 v[28:31], v[128:131], v[108:111], v[28:31]
    ds_read_b64_tr_b16 v[104:105], v249 offset:8192
    ds_read_b64_tr_b16 v[106:107], v249 offset:8704
    v_mfma_f32_16x16x32_bf16 v[52:55], v[128:131], v[112:115], v[52:55]
    v_mfma_f32_16x16x32_bf16 v[32:35], v[132:135], v[108:111], v[32:35]
    v_mfma_f32_16x16x32_bf16 v[56:59], v[132:135], v[112:115], v[56:59]
    v_mfma_f32_16x16x32_bf16 v[36:39], v[136:139], v[108:111], v[36:39]
    v_mfma_f32_16x16x32_bf16 v[60:63], v[136:139], v[112:115], v[60:63]
    s_waitcnt lgkmcnt(0)
    v_mfma_f32_16x16x32_bf16 v[16:19], v[84:87], v[76:79], v[16:19]
    ds_read_b64_tr_b16 v[116:117], v248 offset:2048
    ds_read_b64_tr_b16 v[118:119], v248 offset:2560
    v_mfma_f32_16x16x32_bf16 v[40:43], v[84:87], v[80:83], v[40:43]
    ds_read_b128 v[108:111], v247 offset:0
    ds_read_b128 v[112:115], v247 offset:2048
    v_mfma_f32_16x16x32_bf16 v[20:23], v[88:91], v[76:79], v[20:23]
    ds_read_b64_tr_b16 v[120:121], v249 offset:2048
    ds_read_b64_tr_b16 v[122:123], v249 offset:2560
    v_mfma_f32_16x16x32_bf16 v[44:47], v[88:91], v[80:83], v[44:47]
    ds_read_b64_tr_b16 v[124:125], v248 offset:6144
    ds_read_b64_tr_b16 v[126:127], v248 offset:6656
    v_mfma_f32_16x16x32_bf16 v[24:27], v[92:95], v[76:79], v[24:27]
    ds_read_b64_tr_b16 v[128:129], v249 offset:6144
    ds_read_b64_tr_b16 v[130:131], v249 offset:6656
    v_mfma_f32_16x16x32_bf16 v[48:51], v[92:95], v[80:83], v[48:51]
    ds_read_b64_tr_b16 v[132:133], v248 offset:10240
    ds_read_b64_tr_b16 v[134:135], v248 offset:10752
    v_mfma_f32_16x16x32_bf16 v[28:31], v[96:99], v[76:79], v[28:31]
    ds_read_b64_tr_b16 v[136:137], v249 offset:10240
    ds_read_b64_tr_b16 v[138:139], v249 offset:10752
    v_mfma_f32_16x16x32_bf16 v[52:55], v[96:99], v[80:83], v[52:55]
    v_mfma_f32_16x16x32_bf16 v[32:35], v[100:103], v[76:79], v[32:35]
    v_mfma_f32_16x16x32_bf16 v[56:59], v[100:103], v[80:83], v[56:59]
    v_mfma_f32_16x16x32_bf16 v[36:39], v[104:107], v[76:79], v[36:39]
    v_mfma_f32_16x16x32_bf16 v[60:63], v[104:107], v[80:83], v[60:63]
    s_waitcnt lgkmcnt(0)
    s_barrier
    v_mfma_f32_16x16x32_bf16 v[16:19], v[116:119], v[108:111], v[16:19]
    ds_read_b64_tr_b16 v[84:85], v230 offset:0
    ds_read_b64_tr_b16 v[86:87], v230 offset:512
    v_mfma_f32_16x16x32_bf16 v[40:43], v[116:119], v[112:115], v[40:43]
    ds_read_b128 v[76:79], v228 offset:0
    ds_read_b128 v[80:83], v228 offset:2048
    v_mfma_f32_16x16x32_bf16 v[20:23], v[120:123], v[108:111], v[20:23]
    ds_read_b64_tr_b16 v[88:89], v231 offset:0
    ds_read_b64_tr_b16 v[90:91], v231 offset:512
    v_mfma_f32_16x16x32_bf16 v[44:47], v[120:123], v[112:115], v[44:47]
    ds_read_b64_tr_b16 v[92:93], v230 offset:4096
    ds_read_b64_tr_b16 v[94:95], v230 offset:4608
    v_mfma_f32_16x16x32_bf16 v[24:27], v[124:127], v[108:111], v[24:27]
    ds_read_b64_tr_b16 v[96:97], v231 offset:4096
    ds_read_b64_tr_b16 v[98:99], v231 offset:4608
    v_mfma_f32_16x16x32_bf16 v[48:51], v[124:127], v[112:115], v[48:51]
    ds_read_b64_tr_b16 v[100:101], v230 offset:8192
    ds_read_b64_tr_b16 v[102:103], v230 offset:8704
    v_mfma_f32_16x16x32_bf16 v[28:31], v[128:131], v[108:111], v[28:31]
    ds_read_b64_tr_b16 v[104:105], v231 offset:8192
    ds_read_b64_tr_b16 v[106:107], v231 offset:8704
    v_mfma_f32_16x16x32_bf16 v[52:55], v[128:131], v[112:115], v[52:55]
    v_mfma_f32_16x16x32_bf16 v[32:35], v[132:135], v[108:111], v[32:35]
    v_mfma_f32_16x16x32_bf16 v[56:59], v[132:135], v[112:115], v[56:59]
    v_mfma_f32_16x16x32_bf16 v[36:39], v[136:139], v[108:111], v[36:39]
    v_mfma_f32_16x16x32_bf16 v[60:63], v[136:139], v[112:115], v[60:63]
    s_waitcnt lgkmcnt(0)
    v_mfma_f32_16x16x32_bf16 v[16:19], v[84:87], v[76:79], v[16:19]
    ds_read_b64_tr_b16 v[116:117], v230 offset:2048
    ds_read_b64_tr_b16 v[118:119], v230 offset:2560
    v_mfma_f32_16x16x32_bf16 v[40:43], v[84:87], v[80:83], v[40:43]
    ds_read_b128 v[108:111], v229 offset:0
    ds_read_b128 v[112:115], v229 offset:2048
    v_mfma_f32_16x16x32_bf16 v[20:23], v[88:91], v[76:79], v[20:23]
    ds_read_b64_tr_b16 v[120:121], v231 offset:2048
    ds_read_b64_tr_b16 v[122:123], v231 offset:2560
    v_mfma_f32_16x16x32_bf16 v[44:47], v[88:91], v[80:83], v[44:47]
    ds_read_b64_tr_b16 v[124:125], v230 offset:6144
    ds_read_b64_tr_b16 v[126:127], v230 offset:6656
    v_mfma_f32_16x16x32_bf16 v[24:27], v[92:95], v[76:79], v[24:27]
    ds_read_b64_tr_b16 v[128:129], v231 offset:6144
    ds_read_b64_tr_b16 v[130:131], v231 offset:6656
    v_mfma_f32_16x16x32_bf16 v[48:51], v[92:95], v[80:83], v[48:51]
    ds_read_b64_tr_b16 v[132:133], v230 offset:10240
    ds_read_b64_tr_b16 v[134:135], v230 offset:10752
    v_mfma_f32_16x16x32_bf16 v[28:31], v[96:99], v[76:79], v[28:31]
    ds_read_b64_tr_b16 v[136:137], v231 offset:10240
    ds_read_b64_tr_b16 v[138:139], v231 offset:10752
    v_mfma_f32_16x16x32_bf16 v[52:55], v[96:99], v[80:83], v[52:55]
    v_mfma_f32_16x16x32_bf16 v[32:35], v[100:103], v[76:79], v[32:35]
    v_mfma_f32_16x16x32_bf16 v[56:59], v[100:103], v[80:83], v[56:59]
    v_mfma_f32_16x16x32_bf16 v[36:39], v[104:107], v[76:79], v[36:39]
    v_mfma_f32_16x16x32_bf16 v[60:63], v[104:107], v[80:83], v[60:63]
    s_waitcnt lgkmcnt(0)
    s_barrier
    v_mfma_f32_16x16x32_bf16 v[16:19], v[116:119], v[108:111], v[16:19]
    ds_read_b64_tr_b16 v[84:85], v236 offset:0
    ds_read_b64_tr_b16 v[86:87], v236 offset:512
    v_mfma_f32_16x16x32_bf16 v[40:43], v[116:119], v[112:115], v[40:43]
    ds_read_b128 v[76:79], v234 offset:0
    ds_read_b128 v[80:83], v234 offset:2048
    v_mfma_f32_16x16x32_bf16 v[20:23], v[120:123], v[108:111], v[20:23]
    ds_read_b64_tr_b16 v[88:89], v237 offset:0
    ds_read_b64_tr_b16 v[90:91], v237 offset:512
    v_mfma_f32_16x16x32_bf16 v[44:47], v[120:123], v[112:115], v[44:47]
    ds_read_b64_tr_b16 v[92:93], v236 offset:4096
    ds_read_b64_tr_b16 v[94:95], v236 offset:4608
    v_mfma_f32_16x16x32_bf16 v[24:27], v[124:127], v[108:111], v[24:27]
    ds_read_b64_tr_b16 v[96:97], v237 offset:4096
    ds_read_b64_tr_b16 v[98:99], v237 offset:4608
    v_mfma_f32_16x16x32_bf16 v[48:51], v[124:127], v[112:115], v[48:51]
    ds_read_b64_tr_b16 v[100:101], v236 offset:8192
    ds_read_b64_tr_b16 v[102:103], v236 offset:8704
    v_mfma_f32_16x16x32_bf16 v[28:31], v[128:131], v[108:111], v[28:31]
    ds_read_b64_tr_b16 v[104:105], v237 offset:8192
    ds_read_b64_tr_b16 v[106:107], v237 offset:8704
    v_mfma_f32_16x16x32_bf16 v[52:55], v[128:131], v[112:115], v[52:55]
    v_mfma_f32_16x16x32_bf16 v[32:35], v[132:135], v[108:111], v[32:35]
    v_mfma_f32_16x16x32_bf16 v[56:59], v[132:135], v[112:115], v[56:59]
    v_mfma_f32_16x16x32_bf16 v[36:39], v[136:139], v[108:111], v[36:39]
    v_mfma_f32_16x16x32_bf16 v[60:63], v[136:139], v[112:115], v[60:63]
    s_waitcnt lgkmcnt(0)
    v_mfma_f32_16x16x32_bf16 v[16:19], v[84:87], v[76:79], v[16:19]
    ds_read_b64_tr_b16 v[116:117], v236 offset:2048
    ds_read_b64_tr_b16 v[118:119], v236 offset:2560
    v_mfma_f32_16x16x32_bf16 v[40:43], v[84:87], v[80:83], v[40:43]
    ds_read_b128 v[108:111], v235 offset:0
    ds_read_b128 v[112:115], v235 offset:2048
    v_mfma_f32_16x16x32_bf16 v[20:23], v[88:91], v[76:79], v[20:23]
    ds_read_b64_tr_b16 v[120:121], v237 offset:2048
    ds_read_b64_tr_b16 v[122:123], v237 offset:2560
    v_mfma_f32_16x16x32_bf16 v[44:47], v[88:91], v[80:83], v[44:47]
    ds_read_b64_tr_b16 v[124:125], v236 offset:6144
    ds_read_b64_tr_b16 v[126:127], v236 offset:6656
    v_mfma_f32_16x16x32_bf16 v[24:27], v[92:95], v[76:79], v[24:27]
    ds_read_b64_tr_b16 v[128:129], v237 offset:6144
    ds_read_b64_tr_b16 v[130:131], v237 offset:6656
    v_mfma_f32_16x16x32_bf16 v[48:51], v[92:95], v[80:83], v[48:51]
    ds_read_b64_tr_b16 v[132:133], v236 offset:10240
    ds_read_b64_tr_b16 v[134:135], v236 offset:10752
    v_mfma_f32_16x16x32_bf16 v[28:31], v[96:99], v[76:79], v[28:31]
    ds_read_b64_tr_b16 v[136:137], v237 offset:10240
    ds_read_b64_tr_b16 v[138:139], v237 offset:10752
    v_mfma_f32_16x16x32_bf16 v[52:55], v[96:99], v[80:83], v[52:55]
    v_mfma_f32_16x16x32_bf16 v[32:35], v[100:103], v[76:79], v[32:35]
    v_mfma_f32_16x16x32_bf16 v[56:59], v[100:103], v[80:83], v[56:59]
    v_mfma_f32_16x16x32_bf16 v[36:39], v[104:107], v[76:79], v[36:39]
    v_mfma_f32_16x16x32_bf16 v[60:63], v[104:107], v[80:83], v[60:63]
    s_waitcnt lgkmcnt(0)
    s_barrier
    v_mfma_f32_16x16x32_bf16 v[16:19], v[116:119], v[108:111], v[16:19]
    ds_read_b128 v[84:87], v244 offset:0
    v_mfma_f32_16x16x32_bf16 v[40:43], v[116:119], v[112:115], v[40:43]
    ds_read_b128 v[76:79], v240 offset:0
    v_mfma_f32_16x16x32_bf16 v[20:23], v[120:123], v[108:111], v[20:23]
    ds_read_b128 v[80:83], v240 offset:2048
    v_mfma_f32_16x16x32_bf16 v[44:47], v[120:123], v[112:115], v[44:47]
    ds_read_b128 v[88:91], v244 offset:2048
    v_mfma_f32_16x16x32_bf16 v[24:27], v[124:127], v[108:111], v[24:27]
    ds_read_b128 v[92:95], v244 offset:4096
    v_mfma_f32_16x16x32_bf16 v[48:51], v[124:127], v[112:115], v[48:51]
    ds_read_b128 v[96:99], v244 offset:6144
    v_mfma_f32_16x16x32_bf16 v[28:31], v[128:131], v[108:111], v[28:31]
    ds_read_b128 v[100:103], v244 offset:8192
    v_mfma_f32_16x16x32_bf16 v[52:55], v[128:131], v[112:115], v[52:55]
    v_mfma_f32_16x16x32_bf16 v[32:35], v[132:135], v[108:111], v[32:35]
    v_mfma_f32_16x16x32_bf16 v[56:59], v[132:135], v[112:115], v[56:59]
    v_mfma_f32_16x16x32_bf16 v[36:39], v[136:139], v[108:111], v[36:39]
    v_mfma_f32_16x16x32_bf16 v[60:63], v[136:139], v[112:115], v[60:63]
    s_waitcnt lgkmcnt(0)
    v_mfma_f32_16x16x32_bf16 v[140:143], v[76:79], v[84:87], 0
    ds_read_b128 v[116:119], v245 offset:0
    s_waitcnt vmcnt(0)
    s_lshl_b32 s24, s13, 1
    s_add_u32 s24, s24, s19
    v_mfma_f32_16x16x32_bf16 v[144:147], v[80:83], v[84:87], 0
    ds_read_b128 v[108:111], v241 offset:0
    s_lshl_b32 s29, s24, 8
    s_add_u32 s29, s29, 4096
    s_mul_i32 s24, s24, 196608
    v_mfma_f32_16x16x32_bf16 v[148:151], v[76:79], v[88:91], 0
    ds_read_b128 v[112:115], v241 offset:2048
    s_mul_i32 s25, s14, 12288
    s_add_u32 s24, s24, s25
    s_lshl_b32 s25, s18, 11
    v_mfma_f32_16x16x32_bf16 v[152:155], v[80:83], v[88:91], 0
    ds_read_b128 v[120:123], v245 offset:2048
    s_add_u32 s24, s24, s25
    s_add_u32 s24, s24, 8388608
    s_add_u32 s20, s10, s24
    s_addc_u32 s21, s11, 0
    s_and_b32 s21, s21, 0xffff
    s_mov_b32 s22, 0x3000
    s_mov_b32 s23, 0x00020000
    v_mfma_f32_16x16x32_bf16 v[156:159], v[76:79], v[92:95], 0
    ds_read_b128 v[124:127], v245 offset:4096
    v_lshrrev_b32 v10, 2, v7
    v_and_b32 v11, 3, v7
    v_lshl_add_u32 v10, v10, 3, v11
    v_mfma_f32_16x16x32_bf16 v[160:163], v[80:83], v[92:95], 0
    ds_read_b128 v[128:131], v245 offset:6144
    v_lshlrev_b32 v10, 6, v10
    v_lshl_add_u32 v10, v6, 4, v10
    s_mov_b32 s24, 0xffff0000
    v_mfma_f32_16x16x32_bf16 v[164:167], v[76:79], v[96:99], 0
    ds_read_b128 v[132:135], v245 offset:8192
    s_mov_b32 s25, 0x00003f80
    s_mov_b32 s26, 0xbdd2d3e8
    s_mov_b32 s27, s26
    v_mfma_f32_16x16x32_bf16 v[168:171], v[80:83], v[96:99], 0
    s_mov_b32 s28, 0x3f800000
    v_mov_b32 v12, 0xc0135761
    v_mov_b32 v13, v12
    v_mfma_f32_16x16x32_bf16 v[172:175], v[76:79], v[100:103], 0
    v_lshlrev_b32 v180, 16, v64
    v_and_b32 v181, s24, v64
    v_lshlrev_b32 v182, 16, v65
    v_mfma_f32_16x16x32_bf16 v[176:179], v[80:83], v[100:103], 0
    v_and_b32 v183, s24, v65
    v_lshlrev_b32 v184, 16, v66
    v_and_b32 v185, s24, v66
    v_lshlrev_b32 v186, 16, v67
    v_and_b32 v187, s24, v67
    v_cvt_pk_bf16_f32 v188, v16, v17
    v_cvt_pk_bf16_f32 v189, v18, v19
    v_cvt_pk_bf16_f32 v190, v20, v21
    v_cvt_pk_bf16_f32 v191, v22, v23
    v_cvt_pk_bf16_f32 v192, v40, v41
    v_cvt_pk_bf16_f32 v193, v42, v43
    v_cvt_pk_bf16_f32 v194, v44, v45
    v_cvt_pk_bf16_f32 v195, v46, v47
    v_dot2_f32_bf16 v16, v188, s25, v180
    v_dot2_f32_bf16 v17, v188, s28, v181
    v_dot2_f32_bf16 v18, v189, s25, v182
    v_dot2_f32_bf16 v19, v189, s28, v183
    v_dot2_f32_bf16 v20, v190, s25, v184
    v_dot2_f32_bf16 v21, v190, s28, v185
    v_dot2_f32_bf16 v22, v191, s25, v186
    v_dot2_f32_bf16 v23, v191, s28, v187
    v_dot2_f32_bf16 v40, v192, s25, v180
    v_dot2_f32_bf16 v41, v192, s28, v181
    v_dot2_f32_bf16 v42, v193, s25, v182
    v_dot2_f32_bf16 v43, v193, s28, v183
    v_dot2_f32_bf16 v44, v194, s25, v184
    v_dot2_f32_bf16 v45, v194, s28, v185
    v_dot2_f32_bf16 v46, v195, s25, v186
    v_dot2_f32_bf16 v47, v195, s28, v187
    s_nop 1
    v_cvt_pk_bf16_f32 v188, v16, v17
    v_cvt_pk_bf16_f32 v189, v18, v19
    v_cvt_pk_bf16_f32 v190, v20, v21
    v_cvt_pk_bf16_f32 v191, v22, v23
    v_cvt_pk_bf16_f32 v192, v40, v41
    v_cvt_pk_bf16_f32 v193, v42, v43
    v_cvt_pk_bf16_f32 v194, v44, v45
    v_cvt_pk_bf16_f32 v195, v46, v47
    v_lshlrev_b32 v16, 16, v188
    v_and_b32 v17, s24, v188
    v_lshlrev_b32 v18, 16, v189
    v_and_b32 v19, s24, v189
    v_lshlrev_b32 v20, 16, v190
    v_and_b32 v21, s24, v190
    v_lshlrev_b32 v22, 16, v191
    v_and_b32 v23, s24, v191
    v_lshlrev_b32 v40, 16, v192
    v_and_b32 v41, s24, v192
    v_lshlrev_b32 v42, 16, v193
    v_and_b32 v43, s24, v193
    v_lshlrev_b32 v44, 16, v194
    v_and_b32 v45, s24, v194
    v_lshlrev_b32 v46, 16, v195
    s_waitcnt lgkmcnt(0)
    s_barrier
    v_mfma_f32_16x16x32_bf16 v[140:143], v[108:111], v[116:119], v[140:143]
    ds_read_b128 v[84:87], v250 offset:0
    v_and_b32 v47, s24, v195
    v_pk_mul_f32 v[212:213], v[16:17], v[16:17]
    v_pk_mul_f32 v[214:215], v[18:19], v[18:19]
    v_mfma_f32_16x16x32_bf16 v[144:147], v[112:115], v[116:119], v[144:147]
    ds_read_b128 v[76:79], v246 offset:0
    v_pk_mul_f32 v[216:217], v[20:21], v[20:21]
    v_pk_mul_f32 v[218:219], v[22:23], v[22:23]
    v_pk_mul_f32 v[220:221], v[40:41], v[40:41]
    v_mfma_f32_16x16x32_bf16 v[148:151], v[108:111], v[120:123], v[148:151]
    ds_read_b128 v[80:83], v246 offset:2048
    v_pk_mul_f32 v[222:223], v[42:43], v[42:43]
    v_pk_mul_f32 v[224:225], v[44:45], v[44:45]
    v_pk_mul_f32 v[226:227], v[46:47], v[46:47]
    v_mfma_f32_16x16x32_bf16 v[152:155], v[112:115], v[120:123], v[152:155]
    ds_read_b128 v[88:91], v250 offset:2048
    v_pk_fma_f32 v[212:213], v[212:213], s[26:27], v[12:13]
    v_pk_fma_f32 v[214:215], v[214:215], s[26:27], v[12:13]
    v_pk_fma_f32 v[216:217], v[216:217], s[26:27], v[12:13]
    v_mfma_f32_16x16x32_bf16 v[156:159], v[108:111], v[124:127], v[156:159]
    ds_read_b128 v[92:95], v250 offset:4096
    v_pk_fma_f32 v[218:219], v[218:219], s[26:27], v[12:13]
    v_pk_fma_f32 v[220:221], v[220:221], s[26:27], v[12:13]
    v_pk_fma_f32 v[222:223], v[222:223], s[26:27], v[12:13]
    v_mfma_f32_16x16x32_bf16 v[160:163], v[112:115], v[124:127], v[160:163]
    ds_read_b128 v[96:99], v250 offset:6144
    v_pk_fma_f32 v[224:225], v[224:225], s[26:27], v[12:13]
    v_pk_fma_f32 v[226:227], v[226:227], s[26:27], v[12:13]
    v_pk_mul_f32 v[212:213], v[212:213], v[16:17]
    v_mfma_f32_16x16x32_bf16 v[164:167], v[108:111], v[128:131], v[164:167]
    ds_read_b128 v[100:103], v250 offset:8192
    v_pk_mul_f32 v[214:215], v[214:215], v[18:19]
    v_pk_mul_f32 v[216:217], v[216:217], v[20:21]
    v_pk_mul_f32 v[218:219], v[218:219], v[22:23]
    v_mfma_f32_16x16x32_bf16 v[168:171], v[112:115], v[128:131], v[168:171]
    v_pk_mul_f32 v[220:221], v[220:221], v[40:41]
    v_pk_mul_f32 v[222:223], v[222:223], v[42:43]
    v_pk_mul_f32 v[224:225], v[224:225], v[44:45]
    v_mfma_f32_16x16x32_bf16 v[172:175], v[108:111], v[132:135], v[172:175]
    v_pk_mul_f32 v[226:227], v[226:227], v[46:47]
    v_exp_f32 v212, v212
    v_exp_f32 v213, v213
    v_mfma_f32_16x16x32_bf16 v[176:179], v[112:115], v[132:135], v[176:179]
    v_exp_f32 v214, v214
    v_exp_f32 v215, v215
    v_exp_f32 v216, v216
    v_exp_f32 v217, v217
    v_exp_f32 v218, v218
    v_exp_f32 v219, v219
    v_exp_f32 v220, v220
    v_exp_f32 v221, v221
    v_exp_f32 v222, v222
    v_exp_f32 v223, v223
    v_exp_f32 v224, v224
    v_exp_f32 v225, v225
    v_exp_f32 v226, v226
    v_exp_f32 v227, v227
    s_nop 0
    v_pk_add_f32 v[212:213], v[212:213], 1.0
    v_pk_add_f32 v[214:215], v[214:215], 1.0
    v_pk_add_f32 v[216:217], v[216:217], 1.0
    v_pk_add_f32 v[218:219], v[218:219], 1.0
    v_pk_add_f32 v[220:221], v[220:221], 1.0
    v_pk_add_f32 v[222:223], v[222:223], 1.0
    v_pk_add_f32 v[224:225], v[224:225], 1.0
    v_pk_add_f32 v[226:227], v[226:227], 1.0
    v_rcp_f32 v212, v212
    v_rcp_f32 v213, v213
    v_rcp_f32 v214, v214
    v_rcp_f32 v215, v215
    v_rcp_f32 v216, v216
    v_rcp_f32 v217, v217
    v_rcp_f32 v218, v218
    v_rcp_f32 v219, v219
    v_rcp_f32 v220, v220
    v_rcp_f32 v221, v221
    v_rcp_f32 v222, v222
    v_rcp_f32 v223, v223
    v_rcp_f32 v224, v224
    v_rcp_f32 v225, v225
    v_rcp_f32 v226, v226
    v_rcp_f32 v227, v227
    s_nop 0
    v_pk_mul_f32 v[16:17], v[16:17], v[212:213]
    v_pk_mul_f32 v[18:19], v[18:19], v[214:215]
    v_pk_mul_f32 v[20:21], v[20:21], v[216:217]
    v_pk_mul_f32 v[22:23], v[22:23], v[218:219]
    v_pk_mul_f32 v[40:41], v[40:41], v[220:221]
    v_pk_mul_f32 v[42:43], v[42:43], v[222:223]
    v_pk_mul_f32 v[44:45], v[44:45], v[224:225]
    v_pk_mul_f32 v[46:47], v[46:47], v[226:227]
    v_cvt_pk_bf16_f32 v188, v16, v17
    v_cvt_pk_bf16_f32 v189, v18, v19
    v_cvt_pk_bf16_f32 v190, v20, v21
    v_cvt_pk_bf16_f32 v191, v22, v23
    v_cvt_pk_bf16_f32 v192, v40, v41
    s_waitcnt lgkmcnt(0)
    v_mfma_f32_16x16x32_bf16 v[140:143], v[76:79], v[84:87], v[140:143]
    ds_read_b128 v[116:119], v251 offset:0
    v_cvt_pk_bf16_f32 v193, v42, v43
    v_cvt_pk_bf16_f32 v194, v44, v45
    v_cvt_pk_bf16_f32 v195, v46, v47
    v_mfma_f32_16x16x32_bf16 v[144:147], v[80:83], v[84:87], v[144:147]
    ds_read_b128 v[108:111], v247 offset:0
    s_mov_b32 s88, 0
    buffer_store_dwordx4 v[188:191], v10, s[20:23], s88 offen offset:0 sc1
    buffer_store_dwordx4 v[192:195], v10, s[20:23], s88 offen offset:256 sc1
    v_mfma_f32_16x16x32_bf16 v[148:151], v[76:79], v[88:91], v[148:151]
    ds_read_b128 v[112:115], v247 offset:2048
    v_lshlrev_b32 v180, 16, v68
    v_and_b32 v181, s24, v68
    v_lshlrev_b32 v182, 16, v69
    v_mfma_f32_16x16x32_bf16 v[152:155], v[80:83], v[88:91], v[152:155]
    ds_read_b128 v[120:123], v251 offset:2048
    v_and_b32 v183, s24, v69
    v_lshlrev_b32 v184, 16, v70
    v_and_b32 v185, s24, v70
    v_mfma_f32_16x16x32_bf16 v[156:159], v[76:79], v[92:95], v[156:159]
    ds_read_b128 v[124:127], v251 offset:4096
    v_lshlrev_b32 v186, 16, v71
    v_and_b32 v187, s24, v71
    v_cvt_pk_bf16_f32 v196, v24, v25
    v_mfma_f32_16x16x32_bf16 v[160:163], v[80:83], v[92:95], v[160:163]
    ds_read_b128 v[128:131], v251 offset:6144
    v_cvt_pk_bf16_f32 v197, v26, v27
    v_cvt_pk_bf16_f32 v198, v28, v29
    v_cvt_pk_bf16_f32 v199, v30, v31
    v_mfma_f32_16x16x32_bf16 v[164:167], v[76:79], v[96:99], v[164:167]
    ds_read_b128 v[132:135], v251 offset:8192
    v_cvt_pk_bf16_f32 v200, v48, v49
    v_cvt_pk_bf16_f32 v201, v50, v51
    v_cvt_pk_bf16_f32 v202, v52, v53
    v_mfma_f32_16x16x32_bf16 v[168:171], v[80:83], v[96:99], v[168:171]
    v_cvt_pk_bf16_f32 v203, v54, v55
    v_dot2_f32_bf16 v24, v196, s25, v180
    v_dot2_f32_bf16 v25, v196, s28, v181
    v_mfma_f32_16x16x32_bf16 v[172:175], v[76:79], v[100:103], v[172:175]
    v_dot2_f32_bf16 v26, v197, s25, v182
    v_dot2_f32_bf16 v27, v197, s28, v183
    v_dot2_f32_bf16 v28, v198, s25, v184
    v_mfma_f32_16x16x32_bf16 v[176:179], v[80:83], v[100:103], v[176:179]
    v_dot2_f32_bf16 v29, v198, s28, v185
    v_dot2_f32_bf16 v30, v199, s25, v186
    v_dot2_f32_bf16 v31, v199, s28, v187
    v_dot2_f32_bf16 v48, v200, s25, v180
    v_dot2_f32_bf16 v49, v200, s28, v181
    v_dot2_f32_bf16 v50, v201, s25, v182
    v_dot2_f32_bf16 v51, v201, s28, v183
    v_dot2_f32_bf16 v52, v202, s25, v184
    v_dot2_f32_bf16 v53, v202, s28, v185
    v_dot2_f32_bf16 v54, v203, s25, v186
    v_dot2_f32_bf16 v55, v203, s28, v187
    s_nop 1
    v_cvt_pk_bf16_f32 v196, v24, v25
    v_cvt_pk_bf16_f32 v197, v26, v27
    v_cvt_pk_bf16_f32 v198, v28, v29
    v_cvt_pk_bf16_f32 v199, v30, v31
    v_cvt_pk_bf16_f32 v200, v48, v49
    v_cvt_pk_bf16_f32 v201, v50, v51
    v_cvt_pk_bf16_f32 v202, v52, v53
    v_cvt_pk_bf16_f32 v203, v54, v55
    v_lshlrev_b32 v24, 16, v196
    v_and_b32 v25, s24, v196
    v_lshlrev_b32 v26, 16, v197
    v_and_b32 v27, s24, v197
    v_lshlrev_b32 v28, 16, v198
    v_and_b32 v29, s24, v198
    v_lshlrev_b32 v30, 16, v199
    v_and_b32 v31, s24, v199
    v_lshlrev_b32 v48, 16, v200
    v_and_b32 v49, s24, v200
    v_lshlrev_b32 v50, 16, v201
    v_and_b32 v51, s24, v201
    v_lshlrev_b32 v52, 16, v202
    v_and_b32 v53, s24, v202
    v_lshlrev_b32 v54, 16, v203
    v_and_b32 v55, s24, v203
    v_pk_mul_f32 v[212:213], v[24:25], v[24:25]
    v_pk_mul_f32 v[214:215], v[26:27], v[26:27]
    v_pk_mul_f32 v[216:217], v[28:29], v[28:29]
    v_pk_mul_f32 v[218:219], v[30:31], v[30:31]
    v_pk_mul_f32 v[220:221], v[48:49], v[48:49]
    v_pk_mul_f32 v[222:223], v[50:51], v[50:51]
    v_pk_mul_f32 v[224:225], v[52:53], v[52:53]
    v_pk_mul_f32 v[226:227], v[54:55], v[54:55]
    v_pk_fma_f32 v[212:213], v[212:213], s[26:27], v[12:13]
    v_pk_fma_f32 v[214:215], v[214:215], s[26:27], v[12:13]
    v_pk_fma_f32 v[216:217], v[216:217], s[26:27], v[12:13]
    v_pk_fma_f32 v[218:219], v[218:219], s[26:27], v[12:13]
    v_pk_fma_f32 v[220:221], v[220:221], s[26:27], v[12:13]
    v_pk_fma_f32 v[222:223], v[222:223], s[26:27], v[12:13]
    v_pk_fma_f32 v[224:225], v[224:225], s[26:27], v[12:13]
    v_pk_fma_f32 v[226:227], v[226:227], s[26:27], v[12:13]
    v_pk_mul_f32 v[212:213], v[212:213], v[24:25]
    s_waitcnt lgkmcnt(0)
    s_barrier
    v_mfma_f32_16x16x32_bf16 v[140:143], v[108:111], v[116:119], v[140:143]
    ds_read_b128 v[84:87], v232 offset:0
    v_pk_mul_f32 v[214:215], v[214:215], v[26:27]
    v_pk_mul_f32 v[216:217], v[216:217], v[28:29]
    v_pk_mul_f32 v[218:219], v[218:219], v[30:31]
    v_mfma_f32_16x16x32_bf16 v[144:147], v[112:115], v[116:119], v[144:147]
    ds_read_b128 v[76:79], v228 offset:0
    v_pk_mul_f32 v[220:221], v[220:221], v[48:49]
    v_pk_mul_f32 v[222:223], v[222:223], v[50:51]
    v_pk_mul_f32 v[224:225], v[224:225], v[52:53]
    v_mfma_f32_16x16x32_bf16 v[148:151], v[108:111], v[120:123], v[148:151]
    ds_read_b128 v[80:83], v228 offset:2048
    v_pk_mul_f32 v[226:227], v[226:227], v[54:55]
    v_exp_f32 v212, v212
    v_exp_f32 v213, v213
    v_mfma_f32_16x16x32_bf16 v[152:155], v[112:115], v[120:123], v[152:155]
    ds_read_b128 v[88:91], v232 offset:2048
    v_exp_f32 v214, v214
    v_exp_f32 v215, v215
    v_exp_f32 v216, v216
    v_mfma_f32_16x16x32_bf16 v[156:159], v[108:111], v[124:127], v[156:159]
    ds_read_b128 v[92:95], v232 offset:4096
    v_exp_f32 v217, v217
    v_exp_f32 v218, v218
    v_exp_f32 v219, v219
    v_mfma_f32_16x16x32_bf16 v[160:163], v[112:115], v[124:127], v[160:163]
    ds_read_b128 v[96:99], v232 offset:6144
    v_exp_f32 v220, v220
    v_exp_f32 v221, v221
    v_exp_f32 v222, v222
    v_mfma_f32_16x16x32_bf16 v[164:167], v[108:111], v[128:131], v[164:167]
    ds_read_b128 v[100:103], v232 offset:8192
    v_exp_f32 v223, v223
    v_exp_f32 v224, v224
    v_exp_f32 v225, v225
    v_mfma_f32_16x16x32_bf16 v[168:171], v[112:115], v[128:131], v[168:171]
    v_exp_f32 v226, v226
    v_exp_f32 v227, v227
    s_nop 0
    v_mfma_f32_16x16x32_bf16 v[172:175], v[108:111], v[132:135], v[172:175]
    v_pk_add_f32 v[212:213], v[212:213], 1.0
    v_pk_add_f32 v[214:215], v[214:215], 1.0
    v_pk_add_f32 v[216:217], v[216:217], 1.0
    v_mfma_f32_16x16x32_bf16 v[176:179], v[112:115], v[132:135], v[176:179]
    v_pk_add_f32 v[218:219], v[218:219], 1.0
    v_pk_add_f32 v[220:221], v[220:221], 1.0
    v_pk_add_f32 v[222:223], v[222:223], 1.0
    v_pk_add_f32 v[224:225], v[224:225], 1.0
    v_pk_add_f32 v[226:227], v[226:227], 1.0
    v_rcp_f32 v212, v212
    v_rcp_f32 v213, v213
    v_rcp_f32 v214, v214
    v_rcp_f32 v215, v215
    v_rcp_f32 v216, v216
    v_rcp_f32 v217, v217
    v_rcp_f32 v218, v218
    v_rcp_f32 v219, v219
    v_rcp_f32 v220, v220
    v_rcp_f32 v221, v221
    v_rcp_f32 v222, v222
    v_rcp_f32 v223, v223
    v_rcp_f32 v224, v224
    v_rcp_f32 v225, v225
    v_rcp_f32 v226, v226
    v_rcp_f32 v227, v227
    s_nop 0
    v_pk_mul_f32 v[24:25], v[24:25], v[212:213]
    v_pk_mul_f32 v[26:27], v[26:27], v[214:215]
    v_pk_mul_f32 v[28:29], v[28:29], v[216:217]
    v_pk_mul_f32 v[30:31], v[30:31], v[218:219]
    v_pk_mul_f32 v[48:49], v[48:49], v[220:221]
    v_pk_mul_f32 v[50:51], v[50:51], v[222:223]
    v_pk_mul_f32 v[52:53], v[52:53], v[224:225]
    v_pk_mul_f32 v[54:55], v[54:55], v[226:227]
    v_cvt_pk_bf16_f32 v196, v24, v25
    v_cvt_pk_bf16_f32 v197, v26, v27
    v_cvt_pk_bf16_f32 v198, v28, v29
    v_cvt_pk_bf16_f32 v199, v30, v31
    v_cvt_pk_bf16_f32 v200, v48, v49
    v_cvt_pk_bf16_f32 v201, v50, v51
    v_cvt_pk_bf16_f32 v202, v52, v53
    v_cvt_pk_bf16_f32 v203, v54, v55
    s_mov_b32 s88, 4096
    buffer_store_dwordx4 v[196:199], v10, s[20:23], s88 offen offset:0 sc1
    buffer_store_dwordx4 v[200:203], v10, s[20:23], s88 offen offset:256 sc1
    v_lshlrev_b32 v180, 16, v72
    v_and_b32 v181, s24, v72
    v_lshlrev_b32 v182, 16, v73
    v_and_b32 v183, s24, v73
    v_lshlrev_b32 v184, 16, v74
    v_and_b32 v185, s24, v74
    v_lshlrev_b32 v186, 16, v75
    v_and_b32 v187, s24, v75
    v_cvt_pk_bf16_f32 v204, v32, v33
    v_cvt_pk_bf16_f32 v205, v34, v35
    v_cvt_pk_bf16_f32 v206, v36, v37
    v_cvt_pk_bf16_f32 v207, v38, v39
    s_waitcnt lgkmcnt(0)
    v_mfma_f32_16x16x32_bf16 v[140:143], v[76:79], v[84:87], v[140:143]
    ds_read_b128 v[116:119], v233 offset:0
    v_cvt_pk_bf16_f32 v208, v56, v57
    v_cvt_pk_bf16_f32 v209, v58, v59
    v_cvt_pk_bf16_f32 v210, v60, v61
    v_mfma_f32_16x16x32_bf16 v[144:147], v[80:83], v[84:87], v[144:147]
    ds_read_b128 v[108:111], v229 offset:0
    v_cvt_pk_bf16_f32 v211, v62, v63
    v_dot2_f32_bf16 v32, v204, s25, v180
    v_dot2_f32_bf16 v33, v204, s28, v181
    v_mfma_f32_16x16x32_bf16 v[148:151], v[76:79], v[88:91], v[148:151]
    ds_read_b128 v[112:115], v229 offset:2048
    v_dot2_f32_bf16 v34, v205, s25, v182
    v_dot2_f32_bf16 v35, v205, s28, v183
    v_dot2_f32_bf16 v36, v206, s25, v184
    v_mfma_f32_16x16x32_bf16 v[152:155], v[80:83], v[88:91], v[152:155]
    ds_read_b128 v[120:123], v233 offset:2048
    v_dot2_f32_bf16 v37, v206, s28, v185
    v_dot2_f32_bf16 v38, v207, s25, v186
    v_dot2_f32_bf16 v39, v207, s28, v187
    v_mfma_f32_16x16x32_bf16 v[156:159], v[76:79], v[92:95], v[156:159]
    ds_read_b128 v[124:127], v233 offset:4096
    v_dot2_f32_bf16 v56, v208, s25, v180
    v_dot2_f32_bf16 v57, v208, s28, v181
    v_dot2_f32_bf16 v58, v209, s25, v182
    v_mfma_f32_16x16x32_bf16 v[160:163], v[80:83], v[92:95], v[160:163]
    ds_read_b128 v[128:131], v233 offset:6144
    v_dot2_f32_bf16 v59, v209, s28, v183
    v_dot2_f32_bf16 v60, v210, s25, v184
    v_dot2_f32_bf16 v61, v210, s28, v185
    v_mfma_f32_16x16x32_bf16 v[164:167], v[76:79], v[96:99], v[164:167]
    ds_read_b128 v[132:135], v233 offset:8192
    v_dot2_f32_bf16 v62, v211, s25, v186
    v_dot2_f32_bf16 v63, v211, s28, v187
    s_nop 1
    v_mfma_f32_16x16x32_bf16 v[168:171], v[80:83], v[96:99], v[168:171]
    v_cvt_pk_bf16_f32 v204, v32, v33
    v_cvt_pk_bf16_f32 v205, v34, v35
    v_cvt_pk_bf16_f32 v206, v36, v37
    v_mfma_f32_16x16x32_bf16 v[172:175], v[76:79], v[100:103], v[172:175]
    v_cvt_pk_bf16_f32 v207, v38, v39
    v_cvt_pk_bf16_f32 v208, v56, v57
    v_cvt_pk_bf16_f32 v209, v58, v59
    v_mfma_f32_16x16x32_bf16 v[176:179], v[80:83], v[100:103], v[176:179]
    v_cvt_pk_bf16_f32 v210, v60, v61
    v_cvt_pk_bf16_f32 v211, v62, v63
    v_lshlrev_b32 v32, 16, v204
    v_and_b32 v33, s24, v204
    v_lshlrev_b32 v34, 16, v205
    v_and_b32 v35, s24, v205
    v_lshlrev_b32 v36, 16, v206
    v_and_b32 v37, s24, v206
    v_lshlrev_b32 v38, 16, v207
    v_and_b32 v39, s24, v207
    v_lshlrev_b32 v56, 16, v208
    v_and_b32 v57, s24, v208
    v_lshlrev_b32 v58, 16, v209
    v_and_b32 v59, s24, v209
    v_lshlrev_b32 v60, 16, v210
    v_and_b32 v61, s24, v210
    v_lshlrev_b32 v62, 16, v211
    v_and_b32 v63, s24, v211
    v_pk_mul_f32 v[212:213], v[32:33], v[32:33]
    v_pk_mul_f32 v[214:215], v[34:35], v[34:35]
    v_pk_mul_f32 v[216:217], v[36:37], v[36:37]
    v_pk_mul_f32 v[218:219], v[38:39], v[38:39]
    v_pk_mul_f32 v[220:221], v[56:57], v[56:57]
    v_pk_mul_f32 v[222:223], v[58:59], v[58:59]
    v_pk_mul_f32 v[224:225], v[60:61], v[60:61]
    v_pk_mul_f32 v[226:227], v[62:63], v[62:63]
    v_pk_fma_f32 v[212:213], v[212:213], s[26:27], v[12:13]
    v_pk_fma_f32 v[214:215], v[214:215], s[26:27], v[12:13]
    v_pk_fma_f32 v[216:217], v[216:217], s[26:27], v[12:13]
    v_pk_fma_f32 v[218:219], v[218:219], s[26:27], v[12:13]
    v_pk_fma_f32 v[220:221], v[220:221], s[26:27], v[12:13]
    v_pk_fma_f32 v[222:223], v[222:223], s[26:27], v[12:13]
    v_pk_fma_f32 v[224:225], v[224:225], s[26:27], v[12:13]
    v_pk_fma_f32 v[226:227], v[226:227], s[26:27], v[12:13]
    v_pk_mul_f32 v[212:213], v[212:213], v[32:33]
    v_pk_mul_f32 v[214:215], v[214:215], v[34:35]
    v_pk_mul_f32 v[216:217], v[216:217], v[36:37]
    v_pk_mul_f32 v[218:219], v[218:219], v[38:39]
    v_pk_mul_f32 v[220:221], v[220:221], v[56:57]
    v_pk_mul_f32 v[222:223], v[222:223], v[58:59]
    v_pk_mul_f32 v[224:225], v[224:225], v[60:61]
    v_pk_mul_f32 v[226:227], v[226:227], v[62:63]
    v_exp_f32 v212, v212
    v_exp_f32 v213, v213
    v_exp_f32 v214, v214
    v_exp_f32 v215, v215
    v_exp_f32 v216, v216
    v_exp_f32 v217, v217
    v_exp_f32 v218, v218
    v_exp_f32 v219, v219
    v_exp_f32 v220, v220
    v_exp_f32 v221, v221
    v_exp_f32 v222, v222
    s_waitcnt lgkmcnt(0)
    s_barrier
    v_mfma_f32_16x16x32_bf16 v[140:143], v[108:111], v[116:119], v[140:143]
    ds_read_b128 v[84:87], v238 offset:0
    v_exp_f32 v223, v223
    v_exp_f32 v224, v224
    v_exp_f32 v225, v225
    v_mfma_f32_16x16x32_bf16 v[144:147], v[112:115], v[116:119], v[144:147]
    ds_read_b128 v[76:79], v234 offset:0
    v_exp_f32 v226, v226
    v_exp_f32 v227, v227
    s_nop 0
    v_mfma_f32_16x16x32_bf16 v[148:151], v[108:111], v[120:123], v[148:151]
    ds_read_b128 v[80:83], v234 offset:2048
    v_pk_add_f32 v[212:213], v[212:213], 1.0
    v_pk_add_f32 v[214:215], v[214:215], 1.0
    v_pk_add_f32 v[216:217], v[216:217], 1.0
    v_mfma_f32_16x16x32_bf16 v[152:155], v[112:115], v[120:123], v[152:155]
    ds_read_b128 v[88:91], v238 offset:2048
    v_pk_add_f32 v[218:219], v[218:219], 1.0
    v_pk_add_f32 v[220:221], v[220:221], 1.0
    v_pk_add_f32 v[222:223], v[222:223], 1.0
    v_mfma_f32_16x16x32_bf16 v[156:159], v[108:111], v[124:127], v[156:159]
    ds_read_b128 v[92:95], v238 offset:4096
    v_pk_add_f32 v[224:225], v[224:225], 1.0
    v_pk_add_f32 v[226:227], v[226:227], 1.0
    v_rcp_f32 v212, v212
    v_mfma_f32_16x16x32_bf16 v[160:163], v[112:115], v[124:127], v[160:163]
    ds_read_b128 v[96:99], v238 offset:6144
    v_rcp_f32 v213, v213
    v_rcp_f32 v214, v214
    v_rcp_f32 v215, v215
    v_mfma_f32_16x16x32_bf16 v[164:167], v[108:111], v[128:131], v[164:167]
    ds_read_b128 v[100:103], v238 offset:8192
    v_rcp_f32 v216, v216
    v_rcp_f32 v217, v217
    v_rcp_f32 v218, v218
    v_mfma_f32_16x16x32_bf16 v[168:171], v[112:115], v[128:131], v[168:171]
    v_rcp_f32 v219, v219
    v_rcp_f32 v220, v220
    v_rcp_f32 v221, v221
    v_mfma_f32_16x16x32_bf16 v[172:175], v[108:111], v[132:135], v[172:175]
    v_rcp_f32 v222, v222
    v_rcp_f32 v223, v223
    v_rcp_f32 v224, v224
    v_mfma_f32_16x16x32_bf16 v[176:179], v[112:115], v[132:135], v[176:179]
    v_rcp_f32 v225, v225
    v_rcp_f32 v226, v226
    v_rcp_f32 v227, v227
    s_nop 0
    v_pk_mul_f32 v[32:33], v[32:33], v[212:213]
    v_pk_mul_f32 v[34:35], v[34:35], v[214:215]
    v_pk_mul_f32 v[36:37], v[36:37], v[216:217]
    v_pk_mul_f32 v[38:39], v[38:39], v[218:219]
    v_pk_mul_f32 v[56:57], v[56:57], v[220:221]
    v_pk_mul_f32 v[58:59], v[58:59], v[222:223]
    v_pk_mul_f32 v[60:61], v[60:61], v[224:225]
    v_pk_mul_f32 v[62:63], v[62:63], v[226:227]
    v_cvt_pk_bf16_f32 v204, v32, v33
    v_cvt_pk_bf16_f32 v205, v34, v35
    v_cvt_pk_bf16_f32 v206, v36, v37
    v_cvt_pk_bf16_f32 v207, v38, v39
    v_cvt_pk_bf16_f32 v208, v56, v57
    v_cvt_pk_bf16_f32 v209, v58, v59
    v_cvt_pk_bf16_f32 v210, v60, v61
    v_cvt_pk_bf16_f32 v211, v62, v63
    s_mov_b32 s88, 8192
    buffer_store_dwordx4 v[204:207], v10, s[20:23], s88 offen offset:0 sc1
    buffer_store_dwordx4 v[208:211], v10, s[20:23], s88 offen offset:256 sc1
    v_mul_u32_u24 v14, 48, v7
    v_add_u32 v14, 149504, v14
    s_mul_i32 s20, s17, 2560
    s_add_u32 s20, s20, 153600
    v_lshl_add_u32 v13, v1, 3, s20
    ds_read_b32 v16, v14 offset:0
    ds_read_b32 v17, v14 offset:4
    ds_read_b32 v18, v14 offset:8
    ds_read_b32 v19, v14 offset:12
    ds_read_b32 v20, v14 offset:16
    ds_read_b32 v21, v14 offset:20
    ds_read_b32 v22, v14 offset:24
    ds_read_b32 v23, v14 offset:28
    ds_read_b32 v24, v13 offset:0
    ds_read_b32 v25, v13 offset:4
    ds_read_b32 v27, v14 offset:768
    ds_read_b32 v28, v14 offset:772
    ds_read_b32 v29, v14 offset:776
    ds_read_b32 v30, v14 offset:780
    ds_read_b32 v31, v14 offset:784
    ds_read_b32 v32, v14 offset:788
    ds_read_b32 v33, v14 offset:792
    ds_read_b32 v34, v14 offset:796
    ds_read_b32 v35, v13 offset:512
    ds_read_b32 v36, v13 offset:516
    ds_read_b32 v38, v14 offset:1536
    ds_read_b32 v39, v14 offset:1540
    ds_read_b32 v40, v14 offset:1544
    ds_read_b32 v41, v14 offset:1548
    ds_read_b32 v42, v14 offset:1552
    s_waitcnt lgkmcnt(0)
    v_mfma_f32_16x16x32_bf16 v[140:143], v[76:79], v[84:87], v[140:143]
    ds_read_b128 v[116:119], v239 offset:0
    ds_read_b32 v43, v14 offset:1556
    ds_read_b32 v44, v14 offset:1560
    ds_read_b32 v45, v14 offset:1564
    v_mfma_f32_16x16x32_bf16 v[144:147], v[80:83], v[84:87], v[144:147]
    ds_read_b128 v[108:111], v235 offset:0
    ds_read_b32 v46, v13 offset:1024
    ds_read_b32 v47, v13 offset:1028
    ds_read_b32 v49, v14 offset:2304
    v_mfma_f32_16x16x32_bf16 v[148:151], v[76:79], v[88:91], v[148:151]
    ds_read_b128 v[112:115], v235 offset:2048
    ds_read_b32 v50, v14 offset:2308
    ds_read_b32 v51, v14 offset:2312
    ds_read_b32 v52, v14 offset:2316
    v_mfma_f32_16x16x32_bf16 v[152:155], v[80:83], v[88:91], v[152:155]
    ds_read_b128 v[120:123], v239 offset:2048
    ds_read_b32 v53, v14 offset:2320
    ds_read_b32 v54, v14 offset:2324
    ds_read_b32 v55, v14 offset:2328
    v_mfma_f32_16x16x32_bf16 v[156:159], v[76:79], v[92:95], v[156:159]
    ds_read_b128 v[124:127], v239 offset:4096
    ds_read_b32 v56, v14 offset:2332
    ds_read_b32 v57, v13 offset:1536
    ds_read_b32 v58, v13 offset:1540
    v_mfma_f32_16x16x32_bf16 v[160:163], v[80:83], v[92:95], v[160:163]
    ds_read_b128 v[128:131], v239 offset:6144
    ds_read_b32 v60, v14 offset:3072
    ds_read_b32 v61, v14 offset:3076
    ds_read_b32 v62, v14 offset:3080
    v_mfma_f32_16x16x32_bf16 v[164:167], v[76:79], v[96:99], v[164:167]
    ds_read_b128 v[132:135], v239 offset:8192
    ds_read_b32 v63, v14 offset:3084
    ds_read_b32 v64, v14 offset:3088
    ds_read_b32 v65, v14 offset:3092
    v_mfma_f32_16x16x32_bf16 v[168:171], v[80:83], v[96:99], v[168:171]
    ds_read_b32 v66, v14 offset:3096
    ds_read_b32 v67, v14 offset:3100
    ds_read_b32 v68, v13 offset:2048
    v_mfma_f32_16x16x32_bf16 v[172:175], v[76:79], v[100:103], v[172:175]
    ds_read_b32 v69, v13 offset:2052
    v_mfma_f32_16x16x32_bf16 v[176:179], v[80:83], v[100:103], v[176:179]
    s_waitcnt lgkmcnt(0)
    s_barrier
    v_mfma_f32_16x16x32_bf16 v[140:143], v[108:111], v[116:119], v[140:143]
    ds_read_b128 v[84:87], v244 offset:0
    v_mfma_f32_16x16x32_bf16 v[144:147], v[112:115], v[116:119], v[144:147]
    ds_read_b128 v[76:79], v240 offset:0
    v_mfma_f32_16x16x32_bf16 v[148:151], v[108:111], v[120:123], v[148:151]
    ds_read_b128 v[80:83], v240 offset:2048
    v_mfma_f32_16x16x32_bf16 v[152:155], v[112:115], v[120:123], v[152:155]
    ds_read_b128 v[88:91], v244 offset:2048
    v_mfma_f32_16x16x32_bf16 v[156:159], v[108:111], v[124:127], v[156:159]
    ds_read_b128 v[92:95], v244 offset:4096
    v_mfma_f32_16x16x32_bf16 v[160:163], v[112:115], v[124:127], v[160:163]
    ds_read_b128 v[96:99], v244 offset:6144
    v_mfma_f32_16x16x32_bf16 v[164:167], v[108:111], v[128:131], v[164:167]
    ds_read_b128 v[100:103], v244 offset:8192
    v_mfma_f32_16x16x32_bf16 v[168:171], v[112:115], v[128:131], v[168:171]
    v_mfma_f32_16x16x32_bf16 v[172:175], v[108:111], v[132:135], v[172:175]
    v_mfma_f32_16x16x32_bf16 v[176:179], v[112:115], v[132:135], v[176:179]
    s_waitcnt lgkmcnt(0)
    v_mfma_f32_16x16x32_bf16 v[140:143], v[76:79], v[84:87], v[140:143]
    ds_read_b128 v[116:119], v245 offset:0
    v_mfma_f32_16x16x32_bf16 v[144:147], v[80:83], v[84:87], v[144:147]
    ds_read_b128 v[108:111], v241 offset:0
    v_mfma_f32_16x16x32_bf16 v[148:151], v[76:79], v[88:91], v[148:151]
    ds_read_b128 v[112:115], v241 offset:2048
    v_mfma_f32_16x16x32_bf16 v[152:155], v[80:83], v[88:91], v[152:155]
    ds_read_b128 v[120:123], v245 offset:2048
    v_mfma_f32_16x16x32_bf16 v[156:159], v[76:79], v[92:95], v[156:159]
    ds_read_b128 v[124:127], v245 offset:4096
    v_mfma_f32_16x16x32_bf16 v[160:163], v[80:83], v[92:95], v[160:163]
    ds_read_b128 v[128:131], v245 offset:6144
    v_mfma_f32_16x16x32_bf16 v[164:167], v[76:79], v[96:99], v[164:167]
    ds_read_b128 v[132:135], v245 offset:8192
    v_mfma_f32_16x16x32_bf16 v[168:171], v[80:83], v[96:99], v[168:171]
    v_mfma_f32_16x16x32_bf16 v[172:175], v[76:79], v[100:103], v[172:175]
    v_mfma_f32_16x16x32_bf16 v[176:179], v[80:83], v[100:103], v[176:179]
    s_waitcnt lgkmcnt(0)
    s_barrier
    v_mfma_f32_16x16x32_bf16 v[140:143], v[108:111], v[116:119], v[140:143]
    ds_read_b128 v[84:87], v250 offset:0
    s_waitcnt vmcnt(0)
    v_cmp_eq_u32 vcc, 0, v1
    s_and_saveexec_b64 s[30:31], vcc
    v_mov_b32 v10, 1
    v_mov_b32 v11, 0
    buffer_atomic_add v10, v11, s[76:79], s29 offen
    s_mov_b64 exec, -1
    s_nop 3
    v_mfma_f32_16x16x32_bf16 v[144:147], v[112:115], v[116:119], v[144:147]
    ds_read_b128 v[76:79], v246 offset:0
    v_mfma_f32_16x16x32_bf16 v[148:151], v[108:111], v[120:123], v[148:151]
    ds_read_b128 v[80:83], v246 offset:2048
    v_mfma_f32_16x16x32_bf16 v[152:155], v[112:115], v[120:123], v[152:155]
    ds_read_b128 v[88:91], v250 offset:2048
    v_mfma_f32_16x16x32_bf16 v[156:159], v[108:111], v[124:127], v[156:159]
    ds_read_b128 v[92:95], v250 offset:4096
    v_mfma_f32_16x16x32_bf16 v[160:163], v[112:115], v[124:127], v[160:163]
    ds_read_b128 v[96:99], v250 offset:6144
    v_mfma_f32_16x16x32_bf16 v[164:167], v[108:111], v[128:131], v[164:167]
    ds_read_b128 v[100:103], v250 offset:8192
    v_mfma_f32_16x16x32_bf16 v[168:171], v[112:115], v[128:131], v[168:171]
    v_mfma_f32_16x16x32_bf16 v[172:175], v[108:111], v[132:135], v[172:175]
    v_mfma_f32_16x16x32_bf16 v[176:179], v[112:115], v[132:135], v[176:179]
    s_waitcnt lgkmcnt(0)
    v_mfma_f32_16x16x32_bf16 v[140:143], v[76:79], v[84:87], v[140:143]
    ds_read_b128 v[116:119], v251 offset:0
    v_mfma_f32_16x16x32_bf16 v[144:147], v[80:83], v[84:87], v[144:147]
    ds_read_b128 v[108:111], v247 offset:0
    v_mfma_f32_16x16x32_bf16 v[148:151], v[76:79], v[88:91], v[148:151]
    ds_read_b128 v[112:115], v247 offset:2048
    v_mfma_f32_16x16x32_bf16 v[152:155], v[80:83], v[88:91], v[152:155]
    ds_read_b128 v[120:123], v251 offset:2048
    v_mfma_f32_16x16x32_bf16 v[156:159], v[76:79], v[92:95], v[156:159]
    ds_read_b128 v[124:127], v251 offset:4096
    v_mfma_f32_16x16x32_bf16 v[160:163], v[80:83], v[92:95], v[160:163]
    ds_read_b128 v[128:131], v251 offset:6144
    v_mfma_f32_16x16x32_bf16 v[164:167], v[76:79], v[96:99], v[164:167]
    ds_read_b128 v[132:135], v251 offset:8192
    v_mfma_f32_16x16x32_bf16 v[168:171], v[80:83], v[96:99], v[168:171]
    v_mfma_f32_16x16x32_bf16 v[172:175], v[76:79], v[100:103], v[172:175]
    v_mfma_f32_16x16x32_bf16 v[176:179], v[80:83], v[100:103], v[176:179]
    s_waitcnt lgkmcnt(0)
    s_barrier
    v_mfma_f32_16x16x32_bf16 v[140:143], v[108:111], v[116:119], v[140:143]
    ds_read_b128 v[84:87], v232 offset:0
    s_mul_i32 s20, s17, 1280
    s_add_u32 s20, s20, 153600
    v_lshl_add_u32 v13, v1, 2, s20
    v_mfma_f32_16x16x32_bf16 v[144:147], v[112:115], v[116:119], v[144:147]
    ds_read_b128 v[76:79], v228 offset:0
    v_mov_b32 v12, 0
    ds_write_b32 v13, v12 offset:0
    ds_write_b32 v13, v12 offset:256
    v_mfma_f32_16x16x32_bf16 v[148:151], v[108:111], v[120:123], v[148:151]
    ds_read_b128 v[80:83], v228 offset:2048
    ds_write_b32 v13, v12 offset:512
    ds_write_b32 v13, v12 offset:768
    ds_write_b32 v13, v12 offset:1024
    v_mfma_f32_16x16x32_bf16 v[152:155], v[112:115], v[120:123], v[152:155]
    ds_read_b128 v[88:91], v232 offset:2048
    v_mfma_f32_16x16x32_bf16 v[156:159], v[108:111], v[124:127], v[156:159]
    ds_read_b128 v[92:95], v232 offset:4096
    v_mfma_f32_16x16x32_bf16 v[160:163], v[112:115], v[124:127], v[160:163]
    ds_read_b128 v[96:99], v232 offset:6144
    v_mfma_f32_16x16x32_bf16 v[164:167], v[108:111], v[128:131], v[164:167]
    ds_read_b128 v[100:103], v232 offset:8192
    v_mfma_f32_16x16x32_bf16 v[168:171], v[112:115], v[128:131], v[168:171]
    v_mfma_f32_16x16x32_bf16 v[172:175], v[108:111], v[132:135], v[172:175]
    v_mfma_f32_16x16x32_bf16 v[176:179], v[112:115], v[132:135], v[176:179]
    s_waitcnt lgkmcnt(0)
    v_mfma_f32_16x16x32_bf16 v[140:143], v[76:79], v[84:87], v[140:143]
    ds_read_b128 v[116:119], v233 offset:0
    v_mfma_f32_16x16x32_bf16 v[144:147], v[80:83], v[84:87], v[144:147]
    ds_read_b128 v[108:111], v229 offset:0
    v_mfma_f32_16x16x32_bf16 v[148:151], v[76:79], v[88:91], v[148:151]
    ds_read_b128 v[112:115], v229 offset:2048
    v_mfma_f32_16x16x32_bf16 v[152:155], v[80:83], v[88:91], v[152:155]
    ds_read_b128 v[120:123], v233 offset:2048
    v_mfma_f32_16x16x32_bf16 v[156:159], v[76:79], v[92:95], v[156:159]
    ds_read_b128 v[124:127], v233 offset:4096
    v_mfma_f32_16x16x32_bf16 v[160:163], v[80:83], v[92:95], v[160:163]
    ds_read_b128 v[128:131], v233 offset:6144
    v_mfma_f32_16x16x32_bf16 v[164:167], v[76:79], v[96:99], v[164:167]
    ds_read_b128 v[132:135], v233 offset:8192
    v_mfma_f32_16x16x32_bf16 v[168:171], v[80:83], v[96:99], v[168:171]
    v_mfma_f32_16x16x32_bf16 v[172:175], v[76:79], v[100:103], v[172:175]
    v_mfma_f32_16x16x32_bf16 v[176:179], v[80:83], v[100:103], v[176:179]
    s_waitcnt lgkmcnt(0)
    s_barrier
    v_mfma_f32_16x16x32_bf16 v[140:143], v[108:111], v[116:119], v[140:143]
    ds_read_b128 v[84:87], v238 offset:0
    v_mfma_f32_16x16x32_bf16 v[144:147], v[112:115], v[116:119], v[144:147]
    ds_read_b128 v[76:79], v234 offset:0
    v_mfma_f32_16x16x32_bf16 v[148:151], v[108:111], v[120:123], v[148:151]
    ds_read_b128 v[80:83], v234 offset:2048
    v_mfma_f32_16x16x32_bf16 v[152:155], v[112:115], v[120:123], v[152:155]
    ds_read_b128 v[88:91], v238 offset:2048
    v_mfma_f32_16x16x32_bf16 v[156:159], v[108:111], v[124:127], v[156:159]
    ds_read_b128 v[92:95], v238 offset:4096
    v_mfma_f32_16x16x32_bf16 v[160:163], v[112:115], v[124:127], v[160:163]
    ds_read_b128 v[96:99], v238 offset:6144
    v_mfma_f32_16x16x32_bf16 v[164:167], v[108:111], v[128:131], v[164:167]
    ds_read_b128 v[100:103], v238 offset:8192
    v_mfma_f32_16x16x32_bf16 v[168:171], v[112:115], v[128:131], v[168:171]
    v_mfma_f32_16x16x32_bf16 v[172:175], v[108:111], v[132:135], v[172:175]
    v_mfma_f32_16x16x32_bf16 v[176:179], v[112:115], v[132:135], v[176:179]
    s_waitcnt lgkmcnt(0)
    v_mfma_f32_16x16x32_bf16 v[140:143], v[76:79], v[84:87], v[140:143]
    ds_read_b128 v[116:119], v239 offset:0
    v_mfma_f32_16x16x32_bf16 v[144:147], v[80:83], v[84:87], v[144:147]
    ds_read_b128 v[108:111], v235 offset:0
    v_mfma_f32_16x16x32_bf16 v[148:151], v[76:79], v[88:91], v[148:151]
    ds_read_b128 v[112:115], v235 offset:2048
    v_mfma_f32_16x16x32_bf16 v[152:155], v[80:83], v[88:91], v[152:155]
    ds_read_b128 v[120:123], v239 offset:2048
    v_mfma_f32_16x16x32_bf16 v[156:159], v[76:79], v[92:95], v[156:159]
    ds_read_b128 v[124:127], v239 offset:4096
    v_mfma_f32_16x16x32_bf16 v[160:163], v[80:83], v[92:95], v[160:163]
    ds_read_b128 v[128:131], v239 offset:6144
    v_mfma_f32_16x16x32_bf16 v[164:167], v[76:79], v[96:99], v[164:167]
    ds_read_b128 v[132:135], v239 offset:8192
    v_mfma_f32_16x16x32_bf16 v[168:171], v[80:83], v[96:99], v[168:171]
    v_mfma_f32_16x16x32_bf16 v[172:175], v[76:79], v[100:103], v[172:175]
    v_mfma_f32_16x16x32_bf16 v[176:179], v[80:83], v[100:103], v[176:179]
    s_waitcnt lgkmcnt(0)
    s_barrier
    v_mfma_f32_16x16x32_bf16 v[140:143], v[108:111], v[116:119], v[140:143]
    ds_read_b128 v[84:87], v244 offset:0
    v_mfma_f32_16x16x32_bf16 v[144:147], v[112:115], v[116:119], v[144:147]
    ds_read_b128 v[76:79], v240 offset:0
    v_mfma_f32_16x16x32_bf16 v[148:151], v[108:111], v[120:123], v[148:151]
    ds_read_b128 v[80:83], v240 offset:2048
    v_mfma_f32_16x16x32_bf16 v[152:155], v[112:115], v[120:123], v[152:155]
    ds_read_b128 v[88:91], v244 offset:2048
    v_mfma_f32_16x16x32_bf16 v[156:159], v[108:111], v[124:127], v[156:159]
    ds_read_b128 v[92:95], v244 offset:4096
    v_mfma_f32_16x16x32_bf16 v[160:163], v[112:115], v[124:127], v[160:163]
    ds_read_b128 v[96:99], v244 offset:6144
    v_mfma_f32_16x16x32_bf16 v[164:167], v[108:111], v[128:131], v[164:167]
    ds_read_b128 v[100:103], v244 offset:8192
    v_mfma_f32_16x16x32_bf16 v[168:171], v[112:115], v[128:131], v[168:171]
    v_mfma_f32_16x16x32_bf16 v[172:175], v[108:111], v[132:135], v[172:175]
    v_mfma_f32_16x16x32_bf16 v[176:179], v[112:115], v[132:135], v[176:179]
    s_waitcnt lgkmcnt(0)
    v_mfma_f32_16x16x32_bf16 v[140:143], v[76:79], v[84:87], v[140:143]
    ds_read_b128 v[116:119], v245 offset:0
    v_mfma_f32_16x16x32_bf16 v[144:147], v[80:83], v[84:87], v[144:147]
    ds_read_b128 v[108:111], v241 offset:0
    v_mfma_f32_16x16x32_bf16 v[148:151], v[76:79], v[88:91], v[148:151]
    ds_read_b128 v[112:115], v241 offset:2048
    v_mfma_f32_16x16x32_bf16 v[152:155], v[80:83], v[88:91], v[152:155]
    ds_read_b128 v[120:123], v245 offset:2048
    v_mfma_f32_16x16x32_bf16 v[156:159], v[76:79], v[92:95], v[156:159]
    ds_read_b128 v[124:127], v245 offset:4096
    v_mfma_f32_16x16x32_bf16 v[160:163], v[80:83], v[92:95], v[160:163]
    ds_read_b128 v[128:131], v245 offset:6144
    v_mfma_f32_16x16x32_bf16 v[164:167], v[76:79], v[96:99], v[164:167]
    ds_read_b128 v[132:135], v245 offset:8192
    v_mfma_f32_16x16x32_bf16 v[168:171], v[80:83], v[96:99], v[168:171]
    v_mfma_f32_16x16x32_bf16 v[172:175], v[76:79], v[100:103], v[172:175]
    v_mfma_f32_16x16x32_bf16 v[176:179], v[80:83], v[100:103], v[176:179]
    s_waitcnt lgkmcnt(0)
    s_barrier
    v_mfma_f32_16x16x32_bf16 v[140:143], v[108:111], v[116:119], v[140:143]
    ds_read_b128 v[84:87], v250 offset:0
    v_mfma_f32_16x16x32_bf16 v[144:147], v[112:115], v[116:119], v[144:147]
    ds_read_b128 v[76:79], v246 offset:0
    v_mfma_f32_16x16x32_bf16 v[148:151], v[108:111], v[120:123], v[148:151]
    ds_read_b128 v[80:83], v246 offset:2048
    v_mfma_f32_16x16x32_bf16 v[152:155], v[112:115], v[120:123], v[152:155]
    ds_read_b128 v[88:91], v250 offset:2048
    v_mfma_f32_16x16x32_bf16 v[156:159], v[108:111], v[124:127], v[156:159]
    ds_read_b128 v[92:95], v250 offset:4096
    v_mfma_f32_16x16x32_bf16 v[160:163], v[112:115], v[124:127], v[160:163]
    ds_read_b128 v[96:99], v250 offset:6144
    v_mfma_f32_16x16x32_bf16 v[164:167], v[108:111], v[128:131], v[164:167]
    ds_read_b128 v[100:103], v250 offset:8192
    v_mfma_f32_16x16x32_bf16 v[168:171], v[112:115], v[128:131], v[168:171]
    v_mfma_f32_16x16x32_bf16 v[172:175], v[108:111], v[132:135], v[172:175]
    v_mfma_f32_16x16x32_bf16 v[176:179], v[112:115], v[132:135], v[176:179]
    s_waitcnt lgkmcnt(0)
    v_mfma_f32_16x16x32_bf16 v[140:143], v[76:79], v[84:87], v[140:143]
    ds_read_b128 v[116:119], v251 offset:0
    v_mfma_f32_16x16x32_bf16 v[144:147], v[80:83], v[84:87], v[144:147]
    ds_read_b128 v[108:111], v247 offset:0
    v_mfma_f32_16x16x32_bf16 v[148:151], v[76:79], v[88:91], v[148:151]
    ds_read_b128 v[112:115], v247 offset:2048
    v_mfma_f32_16x16x32_bf16 v[152:155], v[80:83], v[88:91], v[152:155]
    ds_read_b128 v[120:123], v251 offset:2048
    v_mfma_f32_16x16x32_bf16 v[156:159], v[76:79], v[92:95], v[156:159]
    ds_read_b128 v[124:127], v251 offset:4096
    v_mfma_f32_16x16x32_bf16 v[160:163], v[80:83], v[92:95], v[160:163]
    ds_read_b128 v[128:131], v251 offset:6144
    v_mfma_f32_16x16x32_bf16 v[164:167], v[76:79], v[96:99], v[164:167]
    ds_read_b128 v[132:135], v251 offset:8192
    v_mfma_f32_16x16x32_bf16 v[168:171], v[80:83], v[96:99], v[168:171]
    v_mfma_f32_16x16x32_bf16 v[172:175], v[76:79], v[100:103], v[172:175]
    v_mfma_f32_16x16x32_bf16 v[176:179], v[80:83], v[100:103], v[176:179]
    s_waitcnt lgkmcnt(0)
    s_barrier
    v_mfma_f32_16x16x32_bf16 v[140:143], v[108:111], v[116:119], v[140:143]
    v_mfma_f32_16x16x32_bf16 v[144:147], v[112:115], v[116:119], v[144:147]
    v_mfma_f32_16x16x32_bf16 v[148:151], v[108:111], v[120:123], v[148:151]
    v_mfma_f32_16x16x32_bf16 v[152:155], v[112:115], v[120:123], v[152:155]
    v_mfma_f32_16x16x32_bf16 v[156:159], v[108:111], v[124:127], v[156:159]
    v_mfma_f32_16x16x32_bf16 v[160:163], v[112:115], v[124:127], v[160:163]
    v_mfma_f32_16x16x32_bf16 v[164:167], v[108:111], v[128:131], v[164:167]
    v_mfma_f32_16x16x32_bf16 v[168:171], v[112:115], v[128:131], v[168:171]
    v_mfma_f32_16x16x32_bf16 v[172:175], v[108:111], v[132:135], v[172:175]
    v_mfma_f32_16x16x32_bf16 v[176:179], v[112:115], v[132:135], v[176:179]
    v_lshrrev_b32 v10, 2, v7
    v_and_b32 v11, 3, v7
    v_lshl_add_u32 v12, v6, 3, v10
    v_lshlrev_b32 v12, 7, v12
    v_lshl_add_u32 v12, v11, 3, v12
    v_lshrrev_b32 v10, 1, v10
    v_and_b32 v11, 1, v6
    v_lshl_add_u32 v10, v11, 1, v10
    v_xor_b32 v10, s17, v10
    v_lshl_add_u32 v12, v10, 5, v12
    s_lshl_b32 s20, s17, 11
    s_add_u32 s21, s20, 0
    v_add_u32 v228, s21, v8
    v_add_u32 v229, s21, v9
    v_add_u32 v230, 0, v12
    v_add_u32 v232, 8192, v8
    v_add_u32 v233, 8192, v9
    s_add_u32 s21, s20, 36864
    v_add_u32 v234, s21, v8
    v_add_u32 v235, s21, v9
    v_add_u32 v236, 36864, v12
    v_add_u32 v238, 45056, v8
    v_add_u32 v239, 45056, v9
    s_add_u32 s21, s20, 73728
    v_add_u32 v240, s21, v8
    v_add_u32 v241, s21, v9
    v_add_u32 v242, 73728, v12
    v_add_u32 v244, 81920, v8
    v_add_u32 v245, 81920, v9
    s_add_u32 s21, s20, 110592
    v_add_u32 v246, s21, v8
    v_add_u32 v247, s21, v9
    v_add_u32 v248, 110592, v12
    v_add_u32 v250, 118784, v8
    v_add_u32 v251, 118784, v9
    s_nop 4
    v_mul_f32 v71, v18, v140
    v_mul_f32 v72, v29, v148
    v_mul_f32 v73, v40, v156
    v_mul_f32 v74, v51, v164
    v_mul_f32 v75, v62, v172
    v_fmac_f32_dpp v71, v140, v19 row_ror:8 row_mask:0xf bank_mask:0xf
    v_fmac_f32_dpp v72, v148, v30 row_ror:8 row_mask:0xf bank_mask:0xf
    v_fmac_f32_dpp v73, v156, v41 row_ror:8 row_mask:0xf bank_mask:0xf
    v_fmac_f32_dpp v74, v164, v52 row_ror:8 row_mask:0xf bank_mask:0xf
    v_fmac_f32_dpp v75, v172, v63 row_ror:8 row_mask:0xf bank_mask:0xf
    v_mov_b32 v140, v71
    v_mov_b32 v148, v72
    v_mov_b32 v156, v73
    v_mov_b32 v164, v74
    v_mov_b32 v172, v75
    v_mul_f32 v71, v18, v141
    v_mul_f32 v72, v29, v149
    v_mul_f32 v73, v40, v157
    v_mul_f32 v74, v51, v165
    v_mul_f32 v75, v62, v173
    v_fmac_f32_dpp v71, v141, v19 row_ror:8 row_mask:0xf bank_mask:0xf
    v_fmac_f32_dpp v72, v149, v30 row_ror:8 row_mask:0xf bank_mask:0xf
    v_fmac_f32_dpp v73, v157, v41 row_ror:8 row_mask:0xf bank_mask:0xf
    v_fmac_f32_dpp v74, v165, v52 row_ror:8 row_mask:0xf bank_mask:0xf
    v_fmac_f32_dpp v75, v173, v63 row_ror:8 row_mask:0xf bank_mask:0xf
    v_fma_f32 v141, v16, v140, v71
    v_fma_f32 v149, v27, v148, v72
    v_fma_f32 v157, v38, v156, v73
    v_fma_f32 v165, v49, v164, v74
    v_fma_f32 v173, v60, v172, v75
    v_fmac_f32_dpp v141, v140, v17 row_ror:8 row_mask:0xf bank_mask:0xf
    v_fmac_f32_dpp v149, v148, v28 row_ror:8 row_mask:0xf bank_mask:0xf
    v_fmac_f32_dpp v157, v156, v39 row_ror:8 row_mask:0xf bank_mask:0xf
    v_fmac_f32_dpp v165, v164, v50 row_ror:8 row_mask:0xf bank_mask:0xf
    v_fmac_f32_dpp v173, v172, v61 row_ror:8 row_mask:0xf bank_mask:0xf
    v_mul_f32 v71, v18, v142
    v_mul_f32 v72, v29, v150
    v_mul_f32 v73, v40, v158
    v_mul_f32 v74, v51, v166
    v_mul_f32 v75, v62, v174
    v_fmac_f32_dpp v71, v142, v19 row_ror:8 row_mask:0xf bank_mask:0xf
    v_fmac_f32_dpp v72, v150, v30 row_ror:8 row_mask:0xf bank_mask:0xf
    v_fmac_f32_dpp v73, v158, v41 row_ror:8 row_mask:0xf bank_mask:0xf
    v_fmac_f32_dpp v74, v166, v52 row_ror:8 row_mask:0xf bank_mask:0xf
    v_fmac_f32_dpp v75, v174, v63 row_ror:8 row_mask:0xf bank_mask:0xf
    v_fma_f32 v142, v16, v141, v71
    v_fma_f32 v150, v27, v149, v72
    v_fma_f32 v158, v38, v157, v73
    v_fma_f32 v166, v49, v165, v74
    v_fma_f32 v174, v60, v173, v75
    v_fmac_f32_dpp v142, v141, v17 row_ror:8 row_mask:0xf bank_mask:0xf
    v_fmac_f32_dpp v150, v149, v28 row_ror:8 row_mask:0xf bank_mask:0xf
    v_fmac_f32_dpp v158, v157, v39 row_ror:8 row_mask:0xf bank_mask:0xf
    v_fmac_f32_dpp v166, v165, v50 row_ror:8 row_mask:0xf bank_mask:0xf
    v_fmac_f32_dpp v174, v173, v61 row_ror:8 row_mask:0xf bank_mask:0xf
    v_mul_f32 v71, v18, v143
    v_mul_f32 v72, v29, v151
    v_mul_f32 v73, v40, v159
    v_mul_f32 v74, v51, v167
    v_mul_f32 v75, v62, v175
    v_fmac_f32_dpp v71, v143, v19 row_ror:8 row_mask:0xf bank_mask:0xf
    v_fmac_f32_dpp v72, v151, v30 row_ror:8 row_mask:0xf bank_mask:0xf
    v_fmac_f32_dpp v73, v159, v41 row_ror:8 row_mask:0xf bank_mask:0xf
    v_fmac_f32_dpp v74, v167, v52 row_ror:8 row_mask:0xf bank_mask:0xf
    v_fmac_f32_dpp v75, v175, v63 row_ror:8 row_mask:0xf bank_mask:0xf
    v_fma_f32 v143, v16, v142, v71
    v_fma_f32 v151, v27, v150, v72
    v_fma_f32 v159, v38, v158, v73
    v_fma_f32 v167, v49, v166, v74
    v_fma_f32 v175, v60, v174, v75
    v_fmac_f32_dpp v143, v142, v17 row_ror:8 row_mask:0xf bank_mask:0xf
    v_fmac_f32_dpp v151, v150, v28 row_ror:8 row_mask:0xf bank_mask:0xf
    v_fmac_f32_dpp v159, v158, v39 row_ror:8 row_mask:0xf bank_mask:0xf
    v_fmac_f32_dpp v167, v166, v50 row_ror:8 row_mask:0xf bank_mask:0xf
    v_fmac_f32_dpp v175, v174, v61 row_ror:8 row_mask:0xf bank_mask:0xf
    v_mul_f32 v71, v18, v144
    v_mul_f32 v72, v29, v152
    v_mul_f32 v73, v40, v160
    v_mul_f32 v74, v51, v168
    v_mul_f32 v75, v62, v176
    v_fmac_f32_dpp v71, v144, v19 row_ror:8 row_mask:0xf bank_mask:0xf
    v_fmac_f32_dpp v72, v152, v30 row_ror:8 row_mask:0xf bank_mask:0xf
    v_fmac_f32_dpp v73, v160, v41 row_ror:8 row_mask:0xf bank_mask:0xf
    v_fmac_f32_dpp v74, v168, v52 row_ror:8 row_mask:0xf bank_mask:0xf
    v_fmac_f32_dpp v75, v176, v63 row_ror:8 row_mask:0xf bank_mask:0xf
    v_fma_f32 v144, v16, v143, v71
    v_fma_f32 v152, v27, v151, v72
    v_fma_f32 v160, v38, v159, v73
    v_fma_f32 v168, v49, v167, v74
    v_fma_f32 v176, v60, v175, v75
    v_fmac_f32_dpp v144, v143, v17 row_ror:8 row_mask:0xf bank_mask:0xf
    v_fmac_f32_dpp v152, v151, v28 row_ror:8 row_mask:0xf bank_mask:0xf
    v_fmac_f32_dpp v160, v159, v39 row_ror:8 row_mask:0xf bank_mask:0xf
    v_fmac_f32_dpp v168, v167, v50 row_ror:8 row_mask:0xf bank_mask:0xf
    v_fmac_f32_dpp v176, v175, v61 row_ror:8 row_mask:0xf bank_mask:0xf
    v_mul_f32 v71, v18, v145
    v_mul_f32 v72, v29, v153
    v_mul_f32 v73, v40, v161
    v_mul_f32 v74, v51, v169
    v_mul_f32 v75, v62, v177
    v_fmac_f32_dpp v71, v145, v19 row_ror:8 row_mask:0xf bank_mask:0xf
    v_fmac_f32_dpp v72, v153, v30 row_ror:8 row_mask:0xf bank_mask:0xf
    v_fmac_f32_dpp v73, v161, v41 row_ror:8 row_mask:0xf bank_mask:0xf
    v_fmac_f32_dpp v74, v169, v52 row_ror:8 row_mask:0xf bank_mask:0xf
    v_fmac_f32_dpp v75, v177, v63 row_ror:8 row_mask:0xf bank_mask:0xf
    v_fma_f32 v145, v16, v144, v71
    v_fma_f32 v153, v27, v152, v72
    v_fma_f32 v161, v38, v160, v73
    v_fma_f32 v169, v49, v168, v74
    v_fma_f32 v177, v60, v176, v75
    v_fmac_f32_dpp v145, v144, v17 row_ror:8 row_mask:0xf bank_mask:0xf
    v_fmac_f32_dpp v153, v152, v28 row_ror:8 row_mask:0xf bank_mask:0xf
    v_fmac_f32_dpp v161, v160, v39 row_ror:8 row_mask:0xf bank_mask:0xf
    v_fmac_f32_dpp v169, v168, v50 row_ror:8 row_mask:0xf bank_mask:0xf
    v_fmac_f32_dpp v177, v176, v61 row_ror:8 row_mask:0xf bank_mask:0xf
    v_mul_f32 v71, v18, v146
    v_mul_f32 v72, v29, v154
    v_mul_f32 v73, v40, v162
    v_mul_f32 v74, v51, v170
    v_mul_f32 v75, v62, v178
    v_fmac_f32_dpp v71, v146, v19 row_ror:8 row_mask:0xf bank_mask:0xf
    v_fmac_f32_dpp v72, v154, v30 row_ror:8 row_mask:0xf bank_mask:0xf
    v_fmac_f32_dpp v73, v162, v41 row_ror:8 row_mask:0xf bank_mask:0xf
    v_fmac_f32_dpp v74, v170, v52 row_ror:8 row_mask:0xf bank_mask:0xf
    v_fmac_f32_dpp v75, v178, v63 row_ror:8 row_mask:0xf bank_mask:0xf
    v_fma_f32 v146, v16, v145, v71
    v_fma_f32 v154, v27, v153, v72
    v_fma_f32 v162, v38, v161, v73
    v_fma_f32 v170, v49, v169, v74
    v_fma_f32 v178, v60, v177, v75
    v_fmac_f32_dpp v146, v145, v17 row_ror:8 row_mask:0xf bank_mask:0xf
    v_fmac_f32_dpp v154, v153, v28 row_ror:8 row_mask:0xf bank_mask:0xf
    v_fmac_f32_dpp v162, v161, v39 row_ror:8 row_mask:0xf bank_mask:0xf
    v_fmac_f32_dpp v170, v169, v50 row_ror:8 row_mask:0xf bank_mask:0xf
    v_fmac_f32_dpp v178, v177, v61 row_ror:8 row_mask:0xf bank_mask:0xf
    v_mul_f32 v71, v18, v147
    v_mul_f32 v72, v29, v155
    v_mul_f32 v73, v40, v163
    v_mul_f32 v74, v51, v171
    v_mul_f32 v75, v62, v179
    v_fmac_f32_dpp v71, v147, v19 row_ror:8 row_mask:0xf bank_mask:0xf
    v_fmac_f32_dpp v72, v155, v30 row_ror:8 row_mask:0xf bank_mask:0xf
    v_fmac_f32_dpp v73, v163, v41 row_ror:8 row_mask:0xf bank_mask:0xf
    v_fmac_f32_dpp v74, v171, v52 row_ror:8 row_mask:0xf bank_mask:0xf
    v_fmac_f32_dpp v75, v179, v63 row_ror:8 row_mask:0xf bank_mask:0xf
    v_fma_f32 v147, v16, v146, v71
    v_fma_f32 v155, v27, v154, v72
    v_fma_f32 v163, v38, v162, v73
    v_fma_f32 v171, v49, v170, v74
    v_fma_f32 v179, v60, v178, v75
    v_fmac_f32_dpp v147, v146, v17 row_ror:8 row_mask:0xf bank_mask:0xf
    v_fmac_f32_dpp v155, v154, v28 row_ror:8 row_mask:0xf bank_mask:0xf
    v_fmac_f32_dpp v163, v162, v39 row_ror:8 row_mask:0xf bank_mask:0xf
    v_fmac_f32_dpp v171, v170, v50 row_ror:8 row_mask:0xf bank_mask:0xf
    v_fmac_f32_dpp v179, v178, v61 row_ror:8 row_mask:0xf bank_mask:0xf
    v_add_u32 v10, 0, v5
    v_add_u32 v11, 64, v5
    v_add_u32 v12, 128, v5
    v_add_u32 v13, 192, v5
    ds_bpermute_b32 v200, v10, v147
    ds_bpermute_b32 v204, v10, v155
    ds_bpermute_b32 v208, v10, v163
    ds_bpermute_b32 v212, v10, v171
    ds_bpermute_b32 v216, v10, v179
    ds_bpermute_b32 v201, v11, v147
    ds_bpermute_b32 v205, v11, v155
    ds_bpermute_b32 v209, v11, v163
    ds_bpermute_b32 v213, v11, v171
    ds_bpermute_b32 v217, v11, v179
    ds_bpermute_b32 v202, v12, v147
    ds_bpermute_b32 v206, v12, v155
    ds_bpermute_b32 v210, v12, v163
    ds_bpermute_b32 v214, v12, v171
    ds_bpermute_b32 v218, v12, v179
    ds_bpermute_b32 v203, v13, v147
    ds_bpermute_b32 v207, v13, v155
    ds_bpermute_b32 v211, v13, v163
    ds_bpermute_b32 v215, v13, v171
    ds_bpermute_b32 v219, v13, v179
    s_waitcnt lgkmcnt(0)
    v_fma_f32 v125, v20, v200, v201
    v_fma_f32 v129, v31, v204, v205
    v_fma_f32 v133, v42, v208, v209
    v_fma_f32 v137, v53, v212, v213
    v_fma_f32 v221, v64, v216, v217
    v_fmac_f32_dpp v125, v200, v21 row_ror:8 row_mask:0xf bank_mask:0xf
    v_fmac_f32_dpp v129, v204, v32 row_ror:8 row_mask:0xf bank_mask:0xf
    v_fmac_f32_dpp v133, v208, v43 row_ror:8 row_mask:0xf bank_mask:0xf
    v_fmac_f32_dpp v137, v212, v54 row_ror:8 row_mask:0xf bank_mask:0xf
    v_fmac_f32_dpp v221, v216, v65 row_ror:8 row_mask:0xf bank_mask:0xf
    v_fma_f32 v126, v20, v125, v202
    v_fma_f32 v130, v31, v129, v206
    v_fma_f32 v134, v42, v133, v210
    v_fma_f32 v138, v53, v137, v214
    v_fma_f32 v222, v64, v221, v218
    v_fmac_f32_dpp v126, v125, v21 row_ror:8 row_mask:0xf bank_mask:0xf
    v_fmac_f32_dpp v130, v129, v32 row_ror:8 row_mask:0xf bank_mask:0xf
    v_fmac_f32_dpp v134, v133, v43 row_ror:8 row_mask:0xf bank_mask:0xf
    v_fmac_f32_dpp v138, v137, v54 row_ror:8 row_mask:0xf bank_mask:0xf
    v_fmac_f32_dpp v222, v221, v65 row_ror:8 row_mask:0xf bank_mask:0xf
    v_fma_f32 v127, v20, v126, v203
    v_fma_f32 v131, v31, v130, v207
    v_fma_f32 v135, v42, v134, v211
    v_fma_f32 v139, v53, v138, v215
    v_fma_f32 v223, v64, v222, v219
    v_fmac_f32_dpp v127, v126, v21 row_ror:8 row_mask:0xf bank_mask:0xf
    v_fmac_f32_dpp v131, v130, v32 row_ror:8 row_mask:0xf bank_mask:0xf
    v_fmac_f32_dpp v135, v134, v43 row_ror:8 row_mask:0xf bank_mask:0xf
    v_fmac_f32_dpp v139, v138, v54 row_ror:8 row_mask:0xf bank_mask:0xf
    v_fmac_f32_dpp v223, v222, v65 row_ror:8 row_mask:0xf bank_mask:0xf
    s_mul_i32 s20, s17, 320
    s_add_u32 s20, s20, 147712
    v_add_u32 v71, s20, v5
    ds_write_b32 v71, v127 offset:0
    ds_write_b32 v71, v131 offset:64
    ds_write_b32 v71, v135 offset:128
    ds_write_b32 v71, v139 offset:192
    ds_write_b32 v71, v223 offset:256
    s_waitcnt lgkmcnt(0)
    s_barrier
    ds_read_b128 v[80:83], v232 offset:0
    ds_read_b128 v[76:79], v228 offset:0
    ds_read_b128 v[84:87], v232 offset:2048
    ds_read_b128 v[88:91], v232 offset:4096
    ds_read_b128 v[92:95], v232 offset:6144
    ds_read_b128 v[96:99], v232 offset:8192
    s_waitcnt lgkmcnt(0)
    v_mfma_f32_16x16x32_bf16 v[180:183], v[80:83], v[76:79], 0
    ds_read_b128 v[104:107], v233 offset:0
    ds_read_b128 v[100:103], v229 offset:0
    v_add_u32 v71, 147712, v5
    ds_read_b32 v124, v71 offset:0
    ds_read_b32 v128, v71 offset:64
    ds_read_b32 v132, v71 offset:128
    v_mfma_f32_16x16x32_bf16 v[184:187], v[84:87], v[76:79], 0
    ds_read_b128 v[108:111], v233 offset:2048
    ds_read_b128 v[112:115], v233 offset:4096
    ds_read_b32 v136, v71 offset:192
    ds_read_b32 v220, v71 offset:256
    ds_read_b32 v125, v71 offset:320
    ds_read_b32 v129, v71 offset:384
    v_mfma_f32_16x16x32_bf16 v[188:191], v[88:91], v[76:79], 0
    ds_read_b128 v[116:119], v233 offset:6144
    ds_read_b128 v[120:123], v233 offset:8192
    ds_read_b32 v133, v71 offset:448
    ds_read_b32 v137, v71 offset:512
    ds_read_b32 v221, v71 offset:576
    ds_read_b32 v126, v71 offset:640
    v_mfma_f32_16x16x32_bf16 v[192:195], v[92:95], v[76:79], 0
    ds_read_b32 v130, v71 offset:704
    ds_read_b32 v134, v71 offset:768
    ds_read_b32 v138, v71 offset:832
    ds_read_b32 v222, v71 offset:896
    v_mfma_f32_16x16x32_bf16 v[196:199], v[96:99], v[76:79], 0
    ds_read_b32 v127, v71 offset:960
    ds_read_b32 v131, v71 offset:1024
    ds_read_b32 v135, v71 offset:1088
    ds_read_b32 v139, v71 offset:1152
    ds_read_b32 v223, v71 offset:1216
    s_mul_i32 s20, s14, 5120
    s_add_u32 s20, s20, 15728640
    s_add_u32 s68, s10, s20
    s_addc_u32 s69, s11, 0
    s_and_b32 s69, s69, 0xffff
    s_mov_b32 s70, 0x1400
    s_mov_b32 s71, 0x00020000
    s_waitcnt lgkmcnt(0)
    v_fma_f32 v125, v22, v124, v125
    v_fma_f32 v129, v33, v128, v129
    v_fma_f32 v133, v44, v132, v133
    v_fma_f32 v137, v55, v136, v137
    v_fma_f32 v221, v66, v220, v221
    v_fmac_f32_dpp v125, v124, v23 row_ror:8 row_mask:0xf bank_mask:0xf
    v_fmac_f32_dpp v129, v128, v34 row_ror:8 row_mask:0xf bank_mask:0xf
    v_fmac_f32_dpp v133, v132, v45 row_ror:8 row_mask:0xf bank_mask:0xf
    v_fmac_f32_dpp v137, v136, v56 row_ror:8 row_mask:0xf bank_mask:0xf
    v_fmac_f32_dpp v221, v220, v67 row_ror:8 row_mask:0xf bank_mask:0xf
    v_fma_f32 v126, v22, v125, v126
    v_fma_f32 v130, v33, v129, v130
    v_fma_f32 v134, v44, v133, v134
    v_fma_f32 v138, v55, v137, v138
    v_fma_f32 v222, v66, v221, v222
    v_fmac_f32_dpp v126, v125, v23 row_ror:8 row_mask:0xf bank_mask:0xf
    v_fmac_f32_dpp v130, v129, v34 row_ror:8 row_mask:0xf bank_mask:0xf
    v_fmac_f32_dpp v134, v133, v45 row_ror:8 row_mask:0xf bank_mask:0xf
    v_fmac_f32_dpp v138, v137, v56 row_ror:8 row_mask:0xf bank_mask:0xf
    v_fmac_f32_dpp v222, v221, v67 row_ror:8 row_mask:0xf bank_mask:0xf
    v_fma_f32 v127, v22, v126, v127
    v_fma_f32 v131, v33, v130, v131
    v_fma_f32 v135, v44, v134, v135
    v_fma_f32 v139, v55, v138, v139
    v_fma_f32 v223, v66, v222, v223
    v_fmac_f32_dpp v127, v126, v23 row_ror:8 row_mask:0xf bank_mask:0xf
    v_fmac_f32_dpp v131, v130, v34 row_ror:8 row_mask:0xf bank_mask:0xf
    v_fmac_f32_dpp v135, v134, v45 row_ror:8 row_mask:0xf bank_mask:0xf
    v_fmac_f32_dpp v139, v138, v56 row_ror:8 row_mask:0xf bank_mask:0xf
    v_fmac_f32_dpp v223, v222, v67 row_ror:8 row_mask:0xf bank_mask:0xf
    s_cmp_lg_u32 s17, 0
    s_cbranch_scc1 U_nopub_14
    s_mul_i32 s20, s13, 320
    v_cmp_gt_u32 vcc, 16, v1
    s_and_saveexec_b64 s[30:31], vcc
    buffer_store_dword v127, v5, s[68:71], s20 offen offset:0 sc1
    buffer_store_dword v131, v5, s[68:71], s20 offen offset:64 sc1
    buffer_store_dword v135, v5, s[68:71], s20 offen offset:128 sc1
    buffer_store_dword v139, v5, s[68:71], s20 offen offset:192 sc1
    buffer_store_dword v223, v5, s[68:71], s20 offen offset:256 sc1
    s_mov_b64 exec, -1
    s_nop 3
U_nopub_14:
    s_cmp_eq_u32 s17, 1
    s_cselect_b64 s[82:83], -1, 0
    s_cmp_eq_u32 s17, 2
    s_cselect_b64 s[84:85], -1, 0
    s_cmp_eq_u32 s17, 3
    s_cselect_b64 s[86:87], -1, 0
    v_cndmask_b32 v26, 0, v124, s[82:83]
    v_cndmask_b32 v37, 0, v128, s[82:83]
    v_cndmask_b32 v48, 0, v132, s[82:83]
    v_cndmask_b32 v59, 0, v136, s[82:83]
    v_cndmask_b32 v70, 0, v220, s[82:83]
    v_cndmask_b32 v26, v26, v125, s[84:85]
    v_cndmask_b32 v37, v37, v129, s[84:85]
    v_cndmask_b32 v48, v48, v133, s[84:85]
    v_cndmask_b32 v59, v59, v137, s[84:85]
    v_cndmask_b32 v70, v70, v221, s[84:85]
    v_cndmask_b32 v26, v26, v126, s[86:87]
    v_cndmask_b32 v37, v37, v130, s[86:87]
    v_cndmask_b32 v48, v48, v134, s[86:87]
    v_cndmask_b32 v59, v59, v138, s[86:87]
    v_cndmask_b32 v70, v70, v222, s[86:87]
    v_fma_f32 v124, v20, v26, v200
    v_fma_f32 v128, v31, v37, v204
    v_fma_f32 v132, v42, v48, v208
    v_fma_f32 v136, v53, v59, v212
    v_fma_f32 v220, v64, v70, v216
    v_fmac_f32_dpp v124, v26, v21 row_ror:8 row_mask:0xf bank_mask:0xf
    v_fmac_f32_dpp v128, v37, v32 row_ror:8 row_mask:0xf bank_mask:0xf
    v_fmac_f32_dpp v132, v48, v43 row_ror:8 row_mask:0xf bank_mask:0xf
    v_fmac_f32_dpp v136, v59, v54 row_ror:8 row_mask:0xf bank_mask:0xf
    v_fmac_f32_dpp v220, v70, v65 row_ror:8 row_mask:0xf bank_mask:0xf
    v_fma_f32 v125, v20, v124, v201
    v_fma_f32 v129, v31, v128, v205
    v_fma_f32 v133, v42, v132, v209
    v_fma_f32 v137, v53, v136, v213
    v_fma_f32 v221, v64, v220, v217
    v_fmac_f32_dpp v125, v124, v21 row_ror:8 row_mask:0xf bank_mask:0xf
    v_fmac_f32_dpp v129, v128, v32 row_ror:8 row_mask:0xf bank_mask:0xf
    v_fmac_f32_dpp v133, v132, v43 row_ror:8 row_mask:0xf bank_mask:0xf
    v_fmac_f32_dpp v137, v136, v54 row_ror:8 row_mask:0xf bank_mask:0xf
    v_fmac_f32_dpp v221, v220, v65 row_ror:8 row_mask:0xf bank_mask:0xf
    v_fma_f32 v126, v20, v125, v202
    v_fma_f32 v130, v31, v129, v206
    v_fma_f32 v134, v42, v133, v210
    v_fma_f32 v138, v53, v137, v214
    v_fma_f32 v222, v64, v221, v218
    v_fmac_f32_dpp v126, v125, v21 row_ror:8 row_mask:0xf bank_mask:0xf
    v_fmac_f32_dpp v130, v129, v32 row_ror:8 row_mask:0xf bank_mask:0xf
    s_waitcnt lgkmcnt(0)
    v_mfma_f32_16x16x32_bf16 v[180:183], v[104:107], v[100:103], v[180:183]
    ds_read_b128 v[80:83], v232 offset:18432
    ds_read_b128 v[76:79], v228 offset:18432
    v_fmac_f32_dpp v134, v133, v43 row_ror:8 row_mask:0xf bank_mask:0xf
    v_fmac_f32_dpp v138, v137, v54 row_ror:8 row_mask:0xf bank_mask:0xf
    v_fmac_f32_dpp v222, v221, v65 row_ror:8 row_mask:0xf bank_mask:0xf
    s_cmp_lg_u32 s17, 0
    s_cbranch_scc1 U_nosig_15
    s_waitcnt vmcnt(0)
    s_lshl_b32 s20, 1, s13
    s_lshl_b32 s21, s14, 8
    s_add_u32 s21, s21, 12288
    v_cmp_eq_u32 vcc, 0, v1
    s_and_saveexec_b64 s[30:31], vcc
    v_mov_b32 v71, s20
    v_mov_b32 v72, 0
    buffer_atomic_or v71, v72, s[76:79], s21 offen
    s_mov_b64 exec, -1
    s_nop 3
U_nosig_15:
    v_mfma_f32_16x16x32_bf16 v[184:187], v[108:111], v[100:103], v[184:187]
    ds_read_b128 v[84:87], v232 offset:20480
    ds_read_b128 v[88:91], v232 offset:22528
    v_cmp_eq_u32 s[82:83], 1, v6
    v_cmp_eq_u32 s[84:85], 2, v6
    v_cmp_eq_u32 s[86:87], 3, v6
    s_nop 1
    v_mfma_f32_16x16x32_bf16 v[188:191], v[112:115], v[100:103], v[188:191]
    ds_read_b128 v[92:95], v232 offset:24576
    ds_read_b128 v[96:99], v232 offset:26624
    v_cndmask_b32 v26, v26, v124, s[82:83]
    v_cndmask_b32 v37, v37, v128, s[82:83]
    v_cndmask_b32 v48, v48, v132, s[82:83]
    v_cndmask_b32 v59, v59, v136, s[82:83]
    v_mfma_f32_16x16x32_bf16 v[192:195], v[116:119], v[100:103], v[192:195]
    v_cndmask_b32 v70, v70, v220, s[82:83]
    v_cndmask_b32 v26, v26, v125, s[84:85]
    v_cndmask_b32 v37, v37, v129, s[84:85]
    v_cndmask_b32 v48, v48, v133, s[84:85]
    v_mfma_f32_16x16x32_bf16 v[196:199], v[120:123], v[100:103], v[196:199]
    v_cndmask_b32 v59, v59, v137, s[84:85]
    v_cndmask_b32 v70, v70, v221, s[84:85]
    v_cndmask_b32 v26, v26, v126, s[86:87]
    v_cndmask_b32 v37, v37, v130, s[86:87]
    v_cndmask_b32 v48, v48, v134, s[86:87]
    v_cndmask_b32 v59, v59, v138, s[86:87]
    v_cndmask_b32 v70, v70, v222, s[86:87]
    ds_read_b32 v20, v14 offset:32
    ds_read_b32 v21, v14 offset:36
    ds_read_b32 v22, v14 offset:40
    ds_read_b32 v23, v14 offset:44
    ds_read_b32 v31, v14 offset:800
    ds_read_b32 v32, v14 offset:804
    ds_read_b32 v33, v14 offset:808
    ds_read_b32 v34, v14 offset:812
    ds_read_b32 v42, v14 offset:1568
    ds_read_b32 v43, v14 offset:1572
    ds_read_b32 v44, v14 offset:1576
    ds_read_b32 v45, v14 offset:1580
    ds_read_b32 v53, v14 offset:2336
    ds_read_b32 v54, v14 offset:2340
    ds_read_b32 v55, v14 offset:2344
    ds_read_b32 v56, v14 offset:2348
    ds_read_b32 v64, v14 offset:3104
    ds_read_b32 v65, v14 offset:3108
    ds_read_b32 v66, v14 offset:3112
    ds_read_b32 v67, v14 offset:3116
    s_lshl_b32 s20, s13, 1
    s_add_u32 s20, s20, s19
    s_lshl_b32 s29, s20, 8
    s_add_u32 s29, s29, 16384
    s_mul_i32 s20, s20, 163840
    s_mul_i32 s21, s18, 81920
    s_add_u32 s20, s20, s21
    s_add_u32 s20, s20, 33554432
    s_add_u32 s72, s10, s20
    s_addc_u32 s73, s11, 0
    s_and_b32 s73, s73, 0xffff
    s_mov_b32 s74, 0x14000
    s_mov_b32 s75, 0x00020000
    v_lshrrev_b32 v71, 3, v7
    v_mul_u32_u24 v72, 640, v71
    v_add_u32 v72, v72, v3
    v_lshlrev_b32 v72, 6, v72
    v_lshl_add_u32 v72, v6, 4, v72
    v_mul_u32_u24 v71, 0x8000, v71
    v_lshl_add_u32 v71, v71, 16, v71
    s_mul_i32 s20, s14, 2560
    v_lshl_add_u32 v73, v6, 2, s13
    v_mul_u32_u24 v73, 320, v73
    v_add_u32 v73, v73, v5
    v_add_u32 v73, 153600, v73
    s_waitcnt lgkmcnt(0)
    v_mfma_f32_16x16x32_bf16 v[180:183], v[80:83], v[76:79], v[180:183]
    ds_read_b128 v[104:107], v233 offset:18432
    ds_read_b128 v[100:103], v229 offset:18432
    v_mfma_f32_16x16x32_bf16 v[184:187], v[84:87], v[76:79], v[184:187]
    ds_read_b128 v[108:111], v233 offset:20480
    ds_read_b128 v[112:115], v233 offset:22528
    v_mfma_f32_16x16x32_bf16 v[188:191], v[88:91], v[76:79], v[188:191]
    ds_read_b128 v[116:119], v233 offset:24576
    ds_read_b128 v[120:123], v233 offset:26624
    v_mfma_f32_16x16x32_bf16 v[192:195], v[92:95], v[76:79], v[192:195]
    v_mfma_f32_16x16x32_bf16 v[196:199], v[96:99], v[76:79], v[196:199]
    s_waitcnt lgkmcnt(0)
    s_barrier
    v_mfma_f32_16x16x32_bf16 v[180:183], v[104:107], v[100:103], v[180:183]
    ds_read_b128 v[80:83], v238 offset:0
    ds_read_b128 v[76:79], v234 offset:0
    v_mfma_f32_16x16x32_bf16 v[184:187], v[108:111], v[100:103], v[184:187]
    ds_read_b128 v[84:87], v238 offset:2048
    ds_read_b128 v[88:91], v238 offset:4096
    v_mfma_f32_16x16x32_bf16 v[188:191], v[112:115], v[100:103], v[188:191]
    ds_read_b128 v[92:95], v238 offset:6144
    ds_read_b128 v[96:99], v238 offset:8192
    v_mfma_f32_16x16x32_bf16 v[192:195], v[116:119], v[100:103], v[192:195]
    v_mfma_f32_16x16x32_bf16 v[196:199], v[120:123], v[100:103], v[196:199]
    s_waitcnt lgkmcnt(0)
    v_mfma_f32_16x16x32_bf16 v[180:183], v[80:83], v[76:79], v[180:183]
    ds_read_b128 v[104:107], v239 offset:0
    ds_read_b128 v[100:103], v235 offset:0
    v_mfma_f32_16x16x32_bf16 v[184:187], v[84:87], v[76:79], v[184:187]
    ds_read_b128 v[108:111], v239 offset:2048
    ds_read_b128 v[112:115], v239 offset:4096
    v_mfma_f32_16x16x32_bf16 v[188:191], v[88:91], v[76:79], v[188:191]
    ds_read_b128 v[116:119], v239 offset:6144
    ds_read_b128 v[120:123], v239 offset:8192
    v_mfma_f32_16x16x32_bf16 v[192:195], v[92:95], v[76:79], v[192:195]
    v_mfma_f32_16x16x32_bf16 v[196:199], v[96:99], v[76:79], v[196:199]
    s_waitcnt lgkmcnt(0)
    v_mfma_f32_16x16x32_bf16 v[180:183], v[104:107], v[100:103], v[180:183]
    ds_read_b128 v[80:83], v238 offset:18432
    ds_read_b128 v[76:79], v234 offset:18432
    v_mfma_f32_16x16x32_bf16 v[184:187], v[108:111], v[100:103], v[184:187]
    ds_read_b128 v[84:87], v238 offset:20480
    ds_read_b128 v[88:91], v238 offset:22528
    v_mfma_f32_16x16x32_bf16 v[188:191], v[112:115], v[100:103], v[188:191]
    ds_read_b128 v[92:95], v238 offset:24576
    ds_read_b128 v[96:99], v238 offset:26624
    v_mfma_f32_16x16x32_bf16 v[192:195], v[116:119], v[100:103], v[192:195]
    v_mfma_f32_16x16x32_bf16 v[196:199], v[120:123], v[100:103], v[196:199]
    s_waitcnt lgkmcnt(0)
    v_mfma_f32_16x16x32_bf16 v[180:183], v[80:83], v[76:79], v[180:183]
    ds_read_b128 v[104:107], v239 offset:18432
    ds_read_b128 v[100:103], v235 offset:18432
    v_mfma_f32_16x16x32_bf16 v[184:187], v[84:87], v[76:79], v[184:187]
    ds_read_b128 v[108:111], v239 offset:20480
    ds_read_b128 v[112:115], v239 offset:22528
    v_mfma_f32_16x16x32_bf16 v[188:191], v[88:91], v[76:79], v[188:191]
    ds_read_b128 v[116:119], v239 offset:24576
    ds_read_b128 v[120:123], v239 offset:26624
    v_mfma_f32_16x16x32_bf16 v[192:195], v[92:95], v[76:79], v[192:195]
    v_mfma_f32_16x16x32_bf16 v[196:199], v[96:99], v[76:79], v[196:199]
    s_waitcnt lgkmcnt(0)
    s_barrier
    v_mfma_f32_16x16x32_bf16 v[180:183], v[104:107], v[100:103], v[180:183]
    ds_read_b128 v[80:83], v244 offset:0
    ds_read_b128 v[76:79], v240 offset:0
    v_mfma_f32_16x16x32_bf16 v[184:187], v[108:111], v[100:103], v[184:187]
    ds_read_b128 v[84:87], v244 offset:2048
    ds_read_b128 v[88:91], v244 offset:4096
    v_mfma_f32_16x16x32_bf16 v[188:191], v[112:115], v[100:103], v[188:191]
    ds_read_b128 v[92:95], v244 offset:6144
    ds_read_b128 v[96:99], v244 offset:8192
    v_mfma_f32_16x16x32_bf16 v[192:195], v[116:119], v[100:103], v[192:195]
    v_mfma_f32_16x16x32_bf16 v[196:199], v[120:123], v[100:103], v[196:199]
    s_waitcnt lgkmcnt(0)
    v_mfma_f32_16x16x32_bf16 v[180:183], v[80:83], v[76:79], v[180:183]
    ds_read_b128 v[104:107], v245 offset:0
    ds_read_b128 v[100:103], v241 offset:0
    v_mfma_f32_16x16x32_bf16 v[184:187], v[84:87], v[76:79], v[184:187]
    ds_read_b128 v[108:111], v245 offset:2048
    ds_read_b128 v[112:115], v245 offset:4096
    v_mfma_f32_16x16x32_bf16 v[188:191], v[88:91], v[76:79], v[188:191]
    ds_read_b128 v[116:119], v245 offset:6144
    ds_read_b128 v[120:123], v245 offset:8192
    v_mfma_f32_16x16x32_bf16 v[192:195], v[92:95], v[76:79], v[192:195]
    v_mfma_f32_16x16x32_bf16 v[196:199], v[96:99], v[76:79], v[196:199]
    s_waitcnt lgkmcnt(0)
    v_mfma_f32_16x16x32_bf16 v[180:183], v[104:107], v[100:103], v[180:183]
    ds_read_b128 v[80:83], v244 offset:18432
    ds_read_b128 v[76:79], v240 offset:18432
    v_mfma_f32_16x16x32_bf16 v[184:187], v[108:111], v[100:103], v[184:187]
    ds_read_b128 v[84:87], v244 offset:20480
    ds_read_b128 v[88:91], v244 offset:22528
    v_mfma_f32_16x16x32_bf16 v[188:191], v[112:115], v[100:103], v[188:191]
    ds_read_b128 v[92:95], v244 offset:24576
    ds_read_b128 v[96:99], v244 offset:26624
    v_mfma_f32_16x16x32_bf16 v[192:195], v[116:119], v[100:103], v[192:195]
    v_mfma_f32_16x16x32_bf16 v[196:199], v[120:123], v[100:103], v[196:199]
    s_waitcnt lgkmcnt(0)
    v_mfma_f32_16x16x32_bf16 v[180:183], v[80:83], v[76:79], v[180:183]
    ds_read_b128 v[104:107], v245 offset:18432
    ds_read_b128 v[100:103], v241 offset:18432
    v_mfma_f32_16x16x32_bf16 v[184:187], v[84:87], v[76:79], v[184:187]
    ds_read_b128 v[108:111], v245 offset:20480
    ds_read_b128 v[112:115], v245 offset:22528
    v_mfma_f32_16x16x32_bf16 v[188:191], v[88:91], v[76:79], v[188:191]
    ds_read_b128 v[116:119], v245 offset:24576
    ds_read_b128 v[120:123], v245 offset:26624
    v_mfma_f32_16x16x32_bf16 v[192:195], v[92:95], v[76:79], v[192:195]
    v_mfma_f32_16x16x32_bf16 v[196:199], v[96:99], v[76:79], v[196:199]
    s_waitcnt lgkmcnt(0)
    s_barrier
    v_mfma_f32_16x16x32_bf16 v[180:183], v[104:107], v[100:103], v[180:183]
    ds_read_b128 v[80:83], v250 offset:0
    ds_read_b128 v[76:79], v246 offset:0
    v_mfma_f32_16x16x32_bf16 v[184:187], v[108:111], v[100:103], v[184:187]
    ds_read_b128 v[84:87], v250 offset:2048
    ds_read_b128 v[88:91], v250 offset:4096
    v_mfma_f32_16x16x32_bf16 v[188:191], v[112:115], v[100:103], v[188:191]
    ds_read_b128 v[92:95], v250 offset:6144
    ds_read_b128 v[96:99], v250 offset:8192
    v_mfma_f32_16x16x32_bf16 v[192:195], v[116:119], v[100:103], v[192:195]
    v_mfma_f32_16x16x32_bf16 v[196:199], v[120:123], v[100:103], v[196:199]
    s_waitcnt lgkmcnt(0)
    v_mfma_f32_16x16x32_bf16 v[180:183], v[80:83], v[76:79], v[180:183]
    ds_read_b128 v[104:107], v251 offset:0
    ds_read_b128 v[100:103], v247 offset:0
    v_mfma_f32_16x16x32_bf16 v[184:187], v[84:87], v[76:79], v[184:187]
    ds_read_b128 v[108:111], v251 offset:2048
    ds_read_b128 v[112:115], v251 offset:4096
    v_mfma_f32_16x16x32_bf16 v[188:191], v[88:91], v[76:79], v[188:191]
    ds_read_b128 v[116:119], v251 offset:6144
    ds_read_b128 v[120:123], v251 offset:8192
    v_mfma_f32_16x16x32_bf16 v[192:195], v[92:95], v[76:79], v[192:195]
    v_mfma_f32_16x16x32_bf16 v[196:199], v[96:99], v[76:79], v[196:199]
    s_waitcnt lgkmcnt(0)
    v_mfma_f32_16x16x32_bf16 v[180:183], v[104:107], v[100:103], v[180:183]
    ds_read_b128 v[80:83], v250 offset:18432
    ds_read_b128 v[76:79], v246 offset:18432
    v_mfma_f32_16x16x32_bf16 v[184:187], v[108:111], v[100:103], v[184:187]
    ds_read_b128 v[84:87], v250 offset:20480
    ds_read_b128 v[88:91], v250 offset:22528
    v_mfma_f32_16x16x32_bf16 v[188:191], v[112:115], v[100:103], v[188:191]
    ds_read_b128 v[92:95], v250 offset:24576
    ds_read_b128 v[96:99], v250 offset:26624
    v_mfma_f32_16x16x32_bf16 v[192:195], v[116:119], v[100:103], v[192:195]
    v_mfma_f32_16x16x32_bf16 v[196:199], v[120:123], v[100:103], v[196:199]
    s_waitcnt lgkmcnt(0)
    v_mfma_f32_16x16x32_bf16 v[180:183], v[80:83], v[76:79], v[180:183]
    ds_read_b128 v[104:107], v251 offset:18432
    ds_read_b128 v[100:103], v247 offset:18432
    v_mfma_f32_16x16x32_bf16 v[184:187], v[84:87], v[76:79], v[184:187]
    ds_read_b128 v[108:111], v251 offset:20480
    ds_read_b128 v[112:115], v251 offset:22528
    v_mfma_f32_16x16x32_bf16 v[188:191], v[88:91], v[76:79], v[188:191]
    ds_read_b128 v[116:119], v251 offset:24576
    ds_read_b128 v[120:123], v251 offset:26624
    v_mfma_f32_16x16x32_bf16 v[192:195], v[92:95], v[76:79], v[192:195]
    v_mfma_f32_16x16x32_bf16 v[196:199], v[96:99], v[76:79], v[196:199]
    s_waitcnt lgkmcnt(0)
    s_barrier
    v_mfma_f32_16x16x32_bf16 v[180:183], v[104:107], v[100:103], v[180:183]
    ds_read_b128 v[80:83], v232 offset:0
    ds_read_b128 v[76:79], v228 offset:0
    v_mfma_f32_16x16x32_bf16 v[184:187], v[108:111], v[100:103], v[184:187]
    ds_read_b128 v[84:87], v232 offset:2048
    ds_read_b128 v[88:91], v232 offset:4096
    v_mfma_f32_16x16x32_bf16 v[188:191], v[112:115], v[100:103], v[188:191]
    ds_read_b128 v[92:95], v232 offset:6144
    ds_read_b128 v[96:99], v232 offset:8192
    v_mfma_f32_16x16x32_bf16 v[192:195], v[116:119], v[100:103], v[192:195]
    v_mfma_f32_16x16x32_bf16 v[196:199], v[120:123], v[100:103], v[196:199]
    s_waitcnt lgkmcnt(0)
    v_mfma_f32_16x16x32_bf16 v[180:183], v[80:83], v[76:79], v[180:183]
    ds_read_b128 v[104:107], v233 offset:0
    ds_read_b128 v[100:103], v229 offset:0
    v_mfma_f32_16x16x32_bf16 v[184:187], v[84:87], v[76:79], v[184:187]
    ds_read_b128 v[108:111], v233 offset:2048
    ds_read_b128 v[112:115], v233 offset:4096
    v_mfma_f32_16x16x32_bf16 v[188:191], v[88:91], v[76:79], v[188:191]
    ds_read_b128 v[116:119], v233 offset:6144
    ds_read_b128 v[120:123], v233 offset:8192
    v_mfma_f32_16x16x32_bf16 v[192:195], v[92:95], v[76:79], v[192:195]
    v_mfma_f32_16x16x32_bf16 v[196:199], v[96:99], v[76:79], v[196:199]
    s_waitcnt lgkmcnt(0)
    v_mfma_f32_16x16x32_bf16 v[180:183], v[104:107], v[100:103], v[180:183]
    ds_read_b128 v[80:83], v232 offset:18432
    ds_read_b128 v[76:79], v228 offset:18432
    v_mfma_f32_16x16x32_bf16 v[184:187], v[108:111], v[100:103], v[184:187]
    ds_read_b128 v[84:87], v232 offset:20480
    ds_read_b128 v[88:91], v232 offset:22528
    v_mfma_f32_16x16x32_bf16 v[188:191], v[112:115], v[100:103], v[188:191]
    ds_read_b128 v[92:95], v232 offset:24576
    ds_read_b128 v[96:99], v232 offset:26624
    v_mfma_f32_16x16x32_bf16 v[192:195], v[116:119], v[100:103], v[192:195]
    v_mfma_f32_16x16x32_bf16 v[196:199], v[120:123], v[100:103], v[196:199]
    s_waitcnt lgkmcnt(0)
    v_mfma_f32_16x16x32_bf16 v[180:183], v[80:83], v[76:79], v[180:183]
    ds_read_b128 v[104:107], v233 offset:18432
    ds_read_b128 v[100:103], v229 offset:18432
    v_mfma_f32_16x16x32_bf16 v[184:187], v[84:87], v[76:79], v[184:187]
    ds_read_b128 v[108:111], v233 offset:20480
    ds_read_b128 v[112:115], v233 offset:22528
    v_mfma_f32_16x16x32_bf16 v[188:191], v[88:91], v[76:79], v[188:191]
    ds_read_b128 v[116:119], v233 offset:24576
    ds_read_b128 v[120:123], v233 offset:26624
    v_mfma_f32_16x16x32_bf16 v[192:195], v[92:95], v[76:79], v[192:195]
    v_mfma_f32_16x16x32_bf16 v[196:199], v[96:99], v[76:79], v[196:199]
    s_waitcnt lgkmcnt(0)
    s_barrier
    v_mfma_f32_16x16x32_bf16 v[180:183], v[104:107], v[100:103], v[180:183]
    ds_read_b128 v[80:83], v238 offset:0
    ds_read_b128 v[76:79], v234 offset:0
    ds_read_b32 v124, v73 offset:0
    ds_read_b32 v128, v73 offset:64
    ds_read_b32 v132, v73 offset:128
    ds_read_b32 v136, v73 offset:192
    v_mfma_f32_16x16x32_bf16 v[184:187], v[108:111], v[100:103], v[184:187]
    ds_read_b128 v[84:87], v238 offset:2048
    ds_read_b128 v[88:91], v238 offset:4096
    ds_read_b32 v220, v73 offset:256
    ds_read_b32 v125, v73 offset:320
    ds_read_b32 v129, v73 offset:384
    ds_read_b32 v133, v73 offset:448
    v_mfma_f32_16x16x32_bf16 v[188:191], v[112:115], v[100:103], v[188:191]
    ds_read_b128 v[92:95], v238 offset:6144
    ds_read_b128 v[96:99], v238 offset:8192
    ds_read_b32 v137, v73 offset:512
    ds_read_b32 v221, v73 offset:576
    ds_read_b32 v126, v73 offset:640
    ds_read_b32 v130, v73 offset:704
    v_mfma_f32_16x16x32_bf16 v[192:195], v[116:119], v[100:103], v[192:195]
    ds_read_b32 v134, v73 offset:768
    ds_read_b32 v138, v73 offset:832
    ds_read_b32 v222, v73 offset:896
    ds_read_b32 v127, v73 offset:960
    v_mfma_f32_16x16x32_bf16 v[196:199], v[120:123], v[100:103], v[196:199]
    ds_read_b32 v131, v73 offset:1024
    ds_read_b32 v135, v73 offset:1088
    ds_read_b32 v139, v73 offset:1152
    ds_read_b32 v223, v73 offset:1216
    s_waitcnt lgkmcnt(0)
    v_fma_f32 v125, v20, v124, v125
    v_fma_f32 v129, v31, v128, v129
    v_fma_f32 v133, v42, v132, v133
    v_fma_f32 v137, v53, v136, v137
    v_fma_f32 v221, v64, v220, v221
    v_fmac_f32_dpp v125, v124, v21 row_ror:8 row_mask:0xf bank_mask:0xf
    v_fmac_f32_dpp v129, v128, v32 row_ror:8 row_mask:0xf bank_mask:0xf
    v_fmac_f32_dpp v133, v132, v43 row_ror:8 row_mask:0xf bank_mask:0xf
    v_fmac_f32_dpp v137, v136, v54 row_ror:8 row_mask:0xf bank_mask:0xf
    v_fmac_f32_dpp v221, v220, v65 row_ror:8 row_mask:0xf bank_mask:0xf
    v_fma_f32 v126, v20, v125, v126
    v_fma_f32 v130, v31, v129, v130
    v_fma_f32 v134, v42, v133, v134
    v_fma_f32 v138, v53, v137, v138
    v_fma_f32 v222, v64, v221, v222
    v_fmac_f32_dpp v126, v125, v21 row_ror:8 row_mask:0xf bank_mask:0xf
    v_fmac_f32_dpp v130, v129, v32 row_ror:8 row_mask:0xf bank_mask:0xf
    v_fmac_f32_dpp v134, v133, v43 row_ror:8 row_mask:0xf bank_mask:0xf
    v_fmac_f32_dpp v138, v137, v54 row_ror:8 row_mask:0xf bank_mask:0xf
    v_fmac_f32_dpp v222, v221, v65 row_ror:8 row_mask:0xf bank_mask:0xf
    v_fma_f32 v127, v20, v126, v127
    v_fma_f32 v131, v31, v130, v131
    v_fma_f32 v135, v42, v134, v135
    v_fma_f32 v139, v53, v138, v139
    v_fma_f32 v223, v64, v222, v223
    v_fmac_f32_dpp v127, v126, v21 row_ror:8 row_mask:0xf bank_mask:0xf
    v_fmac_f32_dpp v131, v130, v32 row_ror:8 row_mask:0xf bank_mask:0xf
    v_fmac_f32_dpp v135, v134, v43 row_ror:8 row_mask:0xf bank_mask:0xf
    v_fmac_f32_dpp v139, v138, v54 row_ror:8 row_mask:0xf bank_mask:0xf
    v_fmac_f32_dpp v223, v222, v65 row_ror:8 row_mask:0xf bank_mask:0xf
    s_nop 0
    ds_bpermute_b32 v200, v10, v127
    ds_bpermute_b32 v201, v11, v127
    ds_bpermute_b32 v202, v12, v127
    ds_bpermute_b32 v203, v13, v127
    ds_bpermute_b32 v204, v10, v131
    ds_bpermute_b32 v205, v11, v131
    ds_bpermute_b32 v206, v12, v131
    ds_bpermute_b32 v207, v13, v131
    ds_bpermute_b32 v208, v10, v135
    ds_bpermute_b32 v209, v11, v135
    ds_bpermute_b32 v210, v12, v135
    ds_bpermute_b32 v211, v13, v135
    ds_bpermute_b32 v212, v10, v139
    ds_bpermute_b32 v213, v11, v139
    ds_bpermute_b32 v214, v12, v139
    ds_bpermute_b32 v215, v13, v139
    ds_bpermute_b32 v216, v10, v223
    ds_bpermute_b32 v217, v11, v223
    ds_bpermute_b32 v218, v12, v223
    ds_bpermute_b32 v219, v13, v223
    s_waitcnt lgkmcnt(0)
    v_fma_f32 v201, v22, v200, v201
    v_fma_f32 v205, v33, v204, v205
    v_fma_f32 v209, v44, v208, v209
    v_fma_f32 v213, v55, v212, v213
    v_fma_f32 v217, v66, v216, v217
    v_fmac_f32_dpp v201, v200, v23 row_ror:8 row_mask:0xf bank_mask:0xf
    v_fmac_f32_dpp v205, v204, v34 row_ror:8 row_mask:0xf bank_mask:0xf
    v_fmac_f32_dpp v209, v208, v45 row_ror:8 row_mask:0xf bank_mask:0xf
    v_fmac_f32_dpp v213, v212, v56 row_ror:8 row_mask:0xf bank_mask:0xf
    v_fmac_f32_dpp v217, v216, v67 row_ror:8 row_mask:0xf bank_mask:0xf
    v_fma_f32 v202, v22, v201, v202
    v_fma_f32 v206, v33, v205, v206
    v_fma_f32 v210, v44, v209, v210
    v_fma_f32 v214, v55, v213, v214
    v_fma_f32 v218, v66, v217, v218
    v_fmac_f32_dpp v202, v201, v23 row_ror:8 row_mask:0xf bank_mask:0xf
    v_fmac_f32_dpp v206, v205, v34 row_ror:8 row_mask:0xf bank_mask:0xf
    v_fmac_f32_dpp v210, v209, v45 row_ror:8 row_mask:0xf bank_mask:0xf
    v_fmac_f32_dpp v214, v213, v56 row_ror:8 row_mask:0xf bank_mask:0xf
    v_fmac_f32_dpp v218, v217, v67 row_ror:8 row_mask:0xf bank_mask:0xf
    v_fma_f32 v203, v22, v202, v203
    v_fma_f32 v207, v33, v206, v207
    v_fma_f32 v211, v44, v210, v211
    v_fma_f32 v215, v55, v214, v215
    v_fma_f32 v219, v66, v218, v219
    v_fmac_f32_dpp v203, v202, v23 row_ror:8 row_mask:0xf bank_mask:0xf
    v_fmac_f32_dpp v207, v206, v34 row_ror:8 row_mask:0xf bank_mask:0xf
    v_fmac_f32_dpp v211, v210, v45 row_ror:8 row_mask:0xf bank_mask:0xf
    v_fmac_f32_dpp v215, v214, v56 row_ror:8 row_mask:0xf bank_mask:0xf
    v_fmac_f32_dpp v219, v218, v67 row_ror:8 row_mask:0xf bank_mask:0xf
    v_fma_f32 v26, v24, v203, v26
    v_fma_f32 v37, v35, v207, v37
    v_fma_f32 v48, v46, v211, v48
    v_fma_f32 v59, v57, v215, v59
    v_fma_f32 v70, v68, v219, v70
    v_fmac_f32_dpp v26, v203, v25 row_ror:8 row_mask:0xf bank_mask:0xf
    v_fmac_f32_dpp v37, v207, v36 row_ror:8 row_mask:0xf bank_mask:0xf
    v_fmac_f32_dpp v48, v211, v47 row_ror:8 row_mask:0xf bank_mask:0xf
    v_fmac_f32_dpp v59, v215, v58 row_ror:8 row_mask:0xf bank_mask:0xf
    v_fmac_f32_dpp v70, v219, v69 row_ror:8 row_mask:0xf bank_mask:0xf
    v_mul_f32 v124, v16, v26
    v_mul_f32 v126, v27, v37
    v_mul_f32 v128, v38, v48
    v_mul_f32 v130, v49, v59
    v_mul_f32 v132, v60, v70
    v_fmac_f32_dpp v124, v26, v17 row_ror:8 row_mask:0xf bank_mask:0xf
    v_fmac_f32_dpp v126, v37, v28 row_ror:8 row_mask:0xf bank_mask:0xf
    s_waitcnt lgkmcnt(0)
    v_mfma_f32_16x16x32_bf16 v[180:183], v[80:83], v[76:79], v[180:183]
    ds_read_b128 v[104:107], v239 offset:0
    ds_read_b128 v[100:103], v235 offset:0
    v_fmac_f32_dpp v128, v48, v39 row_ror:8 row_mask:0xf bank_mask:0xf
    v_fmac_f32_dpp v130, v59, v50 row_ror:8 row_mask:0xf bank_mask:0xf
    v_fmac_f32_dpp v132, v70, v61 row_ror:8 row_mask:0xf bank_mask:0xf
    v_mul_f32 v125, v16, v124
    v_mfma_f32_16x16x32_bf16 v[184:187], v[84:87], v[76:79], v[184:187]
    ds_read_b128 v[108:111], v239 offset:2048
    ds_read_b128 v[112:115], v239 offset:4096
    v_mul_f32 v127, v27, v126
    v_mul_f32 v129, v38, v128
    v_mul_f32 v131, v49, v130
    v_mul_f32 v133, v60, v132
    v_mfma_f32_16x16x32_bf16 v[188:191], v[88:91], v[76:79], v[188:191]
    ds_read_b128 v[116:119], v239 offset:6144
    ds_read_b128 v[120:123], v239 offset:8192
    v_fmac_f32_dpp v125, v124, v17 row_ror:8 row_mask:0xf bank_mask:0xf
    v_fmac_f32_dpp v127, v126, v28 row_ror:8 row_mask:0xf bank_mask:0xf
    v_fmac_f32_dpp v129, v128, v39 row_ror:8 row_mask:0xf bank_mask:0xf
    v_fmac_f32_dpp v131, v130, v50 row_ror:8 row_mask:0xf bank_mask:0xf
    v_mfma_f32_16x16x32_bf16 v[192:195], v[92:95], v[76:79], v[192:195]
    v_fmac_f32_dpp v133, v132, v61 row_ror:8 row_mask:0xf bank_mask:0xf
    v_pk_add_f32 v[140:141], v[140:141], v[124:125]
    v_pk_add_f32 v[148:149], v[148:149], v[126:127]
    v_pk_add_f32 v[156:157], v[156:157], v[128:129]
    v_mfma_f32_16x16x32_bf16 v[196:199], v[96:99], v[76:79], v[196:199]
    v_pk_add_f32 v[164:165], v[164:165], v[130:131]
    v_pk_add_f32 v[172:173], v[172:173], v[132:133]
    v_mul_f32 v124, v16, v125
    v_mul_f32 v126, v27, v127
    v_mul_f32 v128, v38, v129
    v_mul_f32 v130, v49, v131
    v_mul_f32 v132, v60, v133
    v_fmac_f32_dpp v124, v125, v17 row_ror:8 row_mask:0xf bank_mask:0xf
    v_fmac_f32_dpp v126, v127, v28 row_ror:8 row_mask:0xf bank_mask:0xf
    v_fmac_f32_dpp v128, v129, v39 row_ror:8 row_mask:0xf bank_mask:0xf
    v_fmac_f32_dpp v130, v131, v50 row_ror:8 row_mask:0xf bank_mask:0xf
    v_fmac_f32_dpp v132, v133, v61 row_ror:8 row_mask:0xf bank_mask:0xf
    v_mul_f32 v125, v16, v124
    v_mul_f32 v127, v27, v126
    v_mul_f32 v129, v38, v128
    v_mul_f32 v131, v49, v130
    v_mul_f32 v133, v60, v132
    v_fmac_f32_dpp v125, v124, v17 row_ror:8 row_mask:0xf bank_mask:0xf
    v_fmac_f32_dpp v127, v126, v28 row_ror:8 row_mask:0xf bank_mask:0xf
    v_fmac_f32_dpp v129, v128, v39 row_ror:8 row_mask:0xf bank_mask:0xf
    v_fmac_f32_dpp v131, v130, v50 row_ror:8 row_mask:0xf bank_mask:0xf
    v_fmac_f32_dpp v133, v132, v61 row_ror:8 row_mask:0xf bank_mask:0xf
    v_pk_add_f32 v[142:143], v[142:143], v[124:125]
    v_pk_add_f32 v[150:151], v[150:151], v[126:127]
    v_pk_add_f32 v[158:159], v[158:159], v[128:129]
    v_pk_add_f32 v[166:167], v[166:167], v[130:131]
    v_pk_add_f32 v[174:175], v[174:175], v[132:133]
    v_mul_f32 v124, v16, v125
    v_mul_f32 v126, v27, v127
    v_mul_f32 v128, v38, v129
    v_mul_f32 v130, v49, v131
    v_mul_f32 v132, v60, v133
    v_fmac_f32_dpp v124, v125, v17 row_ror:8 row_mask:0xf bank_mask:0xf
    v_fmac_f32_dpp v126, v127, v28 row_ror:8 row_mask:0xf bank_mask:0xf
    v_fmac_f32_dpp v128, v129, v39 row_ror:8 row_mask:0xf bank_mask:0xf
    v_fmac_f32_dpp v130, v131, v50 row_ror:8 row_mask:0xf bank_mask:0xf
    v_fmac_f32_dpp v132, v133, v61 row_ror:8 row_mask:0xf bank_mask:0xf
    v_mul_f32 v125, v16, v124
    v_mul_f32 v127, v27, v126
    v_mul_f32 v129, v38, v128
    v_mul_f32 v131, v49, v130
    v_mul_f32 v133, v60, v132
    v_fmac_f32_dpp v125, v124, v17 row_ror:8 row_mask:0xf bank_mask:0xf
    v_fmac_f32_dpp v127, v126, v28 row_ror:8 row_mask:0xf bank_mask:0xf
    v_fmac_f32_dpp v129, v128, v39 row_ror:8 row_mask:0xf bank_mask:0xf
    v_fmac_f32_dpp v131, v130, v50 row_ror:8 row_mask:0xf bank_mask:0xf
    v_fmac_f32_dpp v133, v132, v61 row_ror:8 row_mask:0xf bank_mask:0xf
    v_pk_add_f32 v[144:145], v[144:145], v[124:125]
    v_pk_add_f32 v[152:153], v[152:153], v[126:127]
    v_pk_add_f32 v[160:161], v[160:161], v[128:129]
    v_pk_add_f32 v[168:169], v[168:169], v[130:131]
    v_pk_add_f32 v[176:177], v[176:177], v[132:133]
    v_mul_f32 v124, v16, v125
    v_mul_f32 v126, v27, v127
    v_mul_f32 v128, v38, v129
    v_mul_f32 v130, v49, v131
    v_mul_f32 v132, v60, v133
    v_fmac_f32_dpp v124, v125, v17 row_ror:8 row_mask:0xf bank_mask:0xf
    v_fmac_f32_dpp v126, v127, v28 row_ror:8 row_mask:0xf bank_mask:0xf
    v_fmac_f32_dpp v128, v129, v39 row_ror:8 row_mask:0xf bank_mask:0xf
    v_fmac_f32_dpp v130, v131, v50 row_ror:8 row_mask:0xf bank_mask:0xf
    v_fmac_f32_dpp v132, v133, v61 row_ror:8 row_mask:0xf bank_mask:0xf
    v_mul_f32 v125, v16, v124
    v_mul_f32 v127, v27, v126
    v_mul_f32 v129, v38, v128
    v_mul_f32 v131, v49, v130
    v_mul_f32 v133, v60, v132
    v_fmac_f32_dpp v125, v124, v17 row_ror:8 row_mask:0xf bank_mask:0xf
    v_fmac_f32_dpp v127, v126, v28 row_ror:8 row_mask:0xf bank_mask:0xf
    v_fmac_f32_dpp v129, v128, v39 row_ror:8 row_mask:0xf bank_mask:0xf
    v_fmac_f32_dpp v131, v130, v50 row_ror:8 row_mask:0xf bank_mask:0xf
    v_fmac_f32_dpp v133, v132, v61 row_ror:8 row_mask:0xf bank_mask:0xf
    v_pk_add_f32 v[146:147], v[146:147], v[124:125]
    v_pk_add_f32 v[154:155], v[154:155], v[126:127]
    v_pk_add_f32 v[162:163], v[162:163], v[128:129]
    v_pk_add_f32 v[170:171], v[170:171], v[130:131]
    v_pk_add_f32 v[178:179], v[178:179], v[132:133]
    v_cvt_pk_bf16_f32 v200, v140, v141
    v_cvt_pk_bf16_f32 v201, v142, v143
    v_cvt_pk_bf16_f32 v202, v144, v145
    v_cvt_pk_bf16_f32 v203, v146, v147
    v_cvt_pk_bf16_f32 v204, v148, v149
    v_cvt_pk_bf16_f32 v205, v150, v151
    v_cvt_pk_bf16_f32 v206, v152, v153
    v_cvt_pk_bf16_f32 v207, v154, v155
    v_cvt_pk_bf16_f32 v208, v156, v157
    v_cvt_pk_bf16_f32 v209, v158, v159
    v_cvt_pk_bf16_f32 v210, v160, v161
    v_cvt_pk_bf16_f32 v211, v162, v163
    v_cvt_pk_bf16_f32 v212, v164, v165
    v_cvt_pk_bf16_f32 v213, v166, v167
    v_cvt_pk_bf16_f32 v214, v168, v169
    v_cvt_pk_bf16_f32 v215, v170, v171
    v_cvt_pk_bf16_f32 v216, v172, v173
    v_cvt_pk_bf16_f32 v217, v174, v175
    v_cvt_pk_bf16_f32 v218, v176, v177
    v_cvt_pk_bf16_f32 v219, v178, v179
    v_xor_b32 v200, v71, v200
    v_xor_b32 v201, v71, v201
    v_xor_b32 v202, v71, v202
    v_xor_b32 v203, v71, v203
    buffer_store_dwordx4 v[200:203], v72, s[72:75], s20 offen offset:0 sc1
    v_xor_b32 v204, v71, v204
    v_xor_b32 v205, v71, v205
    s_waitcnt lgkmcnt(0)
    v_mfma_f32_16x16x32_bf16 v[180:183], v[104:107], v[100:103], v[180:183]
    ds_read_b128 v[80:83], v238 offset:18432
    ds_read_b128 v[76:79], v234 offset:18432
    v_xor_b32 v206, v71, v206
    v_xor_b32 v207, v71, v207
    buffer_store_dwordx4 v[204:207], v72, s[72:75], s20 offen offset:512 sc1
    v_xor_b32 v208, v71, v208
    v_mfma_f32_16x16x32_bf16 v[184:187], v[108:111], v[100:103], v[184:187]
    ds_read_b128 v[84:87], v238 offset:20480
    ds_read_b128 v[88:91], v238 offset:22528
    v_xor_b32 v209, v71, v209
    v_xor_b32 v210, v71, v210
    v_xor_b32 v211, v71, v211
    buffer_store_dwordx4 v[208:211], v72, s[72:75], s20 offen offset:1024 sc1
    v_mfma_f32_16x16x32_bf16 v[188:191], v[112:115], v[100:103], v[188:191]
    ds_read_b128 v[92:95], v238 offset:24576
    ds_read_b128 v[96:99], v238 offset:26624
    v_xor_b32 v212, v71, v212
    v_xor_b32 v213, v71, v213
    v_xor_b32 v214, v71, v214
    v_xor_b32 v215, v71, v215
    v_mfma_f32_16x16x32_bf16 v[192:195], v[116:119], v[100:103], v[192:195]
    buffer_store_dwordx4 v[212:215], v72, s[72:75], s20 offen offset:1536 sc1
    v_xor_b32 v216, v71, v216
    v_xor_b32 v217, v71, v217
    v_xor_b32 v218, v71, v218
    v_mfma_f32_16x16x32_bf16 v[196:199], v[120:123], v[100:103], v[196:199]
    v_xor_b32 v219, v71, v219
    buffer_store_dwordx4 v[216:219], v72, s[72:75], s20 offen offset:2048 sc1
    s_lshl_b32 s21, s15, 6
    s_lshl_b32 s22, s17, 4
    s_add_u32 s21, s21, s22
    s_mul_i32 s22, s21, 1280
    s_mul_i32 s23, s16, 160
    s_add_u32 s22, s22, s23
    s_mov_b32 s80, s60
    s_and_b32 s81, s61, 0xffff
    s_mov_b32 s82, 0x500000
    s_mov_b32 s83, 0x00020000
    v_mul_u32_u24 v15, 2560, v7
    v_lshl_add_u32 v15, v6, 4, v15
    s_lshl_b32 s27, s22, 1
    s_mov_b32 s20, 0xffff0000
    s_mov_b32 s21, 0x00003f80
    s_mov_b32 s26, 0x3f800000
    s_mov_b32 s88, 0xbfb8aa3b
    s_mov_b32 s89, s88
    v_lshlrev_b32 v14, 3, v6
    v_add_u32 v14, 148992, v14
    s_mul_i32 s22, s17, 2560
    s_add_u32 s22, s22, 73728
    v_mul_u32_u24 v10, 160, v7
    v_lshl_add_u32 v10, v6, 3, v10
    v_add_u32 v10, s22, v10
    s_waitcnt lgkmcnt(0)
    v_mfma_f32_16x16x32_bf16 v[180:183], v[80:83], v[76:79], v[180:183]
    ds_read_b128 v[104:107], v239 offset:18432
    ds_read_b128 v[100:103], v235 offset:18432
    v_mfma_f32_16x16x32_bf16 v[184:187], v[84:87], v[76:79], v[184:187]
    ds_read_b128 v[108:111], v239 offset:20480
    ds_read_b128 v[112:115], v239 offset:22528
    v_mfma_f32_16x16x32_bf16 v[188:191], v[88:91], v[76:79], v[188:191]
    ds_read_b128 v[116:119], v239 offset:24576
    ds_read_b128 v[120:123], v239 offset:26624
    v_mfma_f32_16x16x32_bf16 v[192:195], v[92:95], v[76:79], v[192:195]
    v_mfma_f32_16x16x32_bf16 v[196:199], v[96:99], v[76:79], v[196:199]
    s_waitcnt lgkmcnt(0)
    s_barrier
    v_mfma_f32_16x16x32_bf16 v[180:183], v[104:107], v[100:103], v[180:183]
    ds_read_b128 v[80:83], v244 offset:0
    ds_read_b128 v[76:79], v240 offset:0
    s_waitcnt vmcnt(0)
    v_cmp_eq_u32 vcc, 0, v1
    s_and_saveexec_b64 s[30:31], vcc
    v_mov_b32 v12, 1
    v_mov_b32 v13, 0
    buffer_atomic_add v12, v13, s[76:79], s29 offen
    s_mov_b64 exec, -1
    s_nop 3
    v_mfma_f32_16x16x32_bf16 v[184:187], v[108:111], v[100:103], v[184:187]
    ds_read_b128 v[84:87], v244 offset:2048
    ds_read_b128 v[88:91], v244 offset:4096
    v_mfma_f32_16x16x32_bf16 v[188:191], v[112:115], v[100:103], v[188:191]
    ds_read_b128 v[92:95], v244 offset:6144
    ds_read_b128 v[96:99], v244 offset:8192
    v_mfma_f32_16x16x32_bf16 v[192:195], v[116:119], v[100:103], v[192:195]
    v_mfma_f32_16x16x32_bf16 v[196:199], v[120:123], v[100:103], v[196:199]
    s_waitcnt lgkmcnt(0)
    v_mfma_f32_16x16x32_bf16 v[180:183], v[80:83], v[76:79], v[180:183]
    ds_read_b128 v[104:107], v245 offset:0
    ds_read_b128 v[100:103], v241 offset:0
    v_mfma_f32_16x16x32_bf16 v[184:187], v[84:87], v[76:79], v[184:187]
    ds_read_b128 v[108:111], v245 offset:2048
    ds_read_b128 v[112:115], v245 offset:4096
    v_mfma_f32_16x16x32_bf16 v[188:191], v[88:91], v[76:79], v[188:191]
    ds_read_b128 v[116:119], v245 offset:6144
    ds_read_b128 v[120:123], v245 offset:8192
    v_mfma_f32_16x16x32_bf16 v[192:195], v[92:95], v[76:79], v[192:195]
    v_mfma_f32_16x16x32_bf16 v[196:199], v[96:99], v[76:79], v[196:199]
    s_waitcnt lgkmcnt(0)
    v_mfma_f32_16x16x32_bf16 v[180:183], v[104:107], v[100:103], v[180:183]
    ds_read_b128 v[80:83], v244 offset:18432
    ds_read_b128 v[76:79], v240 offset:18432
    v_mfma_f32_16x16x32_bf16 v[184:187], v[108:111], v[100:103], v[184:187]
    ds_read_b128 v[84:87], v244 offset:20480
    ds_read_b128 v[88:91], v244 offset:22528
    v_mfma_f32_16x16x32_bf16 v[188:191], v[112:115], v[100:103], v[188:191]
    ds_read_b128 v[92:95], v244 offset:24576
    ds_read_b128 v[96:99], v244 offset:26624
    v_mfma_f32_16x16x32_bf16 v[192:195], v[116:119], v[100:103], v[192:195]
    v_mfma_f32_16x16x32_bf16 v[196:199], v[120:123], v[100:103], v[196:199]
    s_waitcnt lgkmcnt(0)
    v_mfma_f32_16x16x32_bf16 v[180:183], v[80:83], v[76:79], v[180:183]
    ds_read_b128 v[104:107], v245 offset:18432
    ds_read_b128 v[100:103], v241 offset:18432
    v_mfma_f32_16x16x32_bf16 v[184:187], v[84:87], v[76:79], v[184:187]
    ds_read_b128 v[108:111], v245 offset:20480
    ds_read_b128 v[112:115], v245 offset:22528
    v_mfma_f32_16x16x32_bf16 v[188:191], v[88:91], v[76:79], v[188:191]
    ds_read_b128 v[116:119], v245 offset:24576
    ds_read_b128 v[120:123], v245 offset:26624
    v_mfma_f32_16x16x32_bf16 v[192:195], v[92:95], v[76:79], v[192:195]
    v_mfma_f32_16x16x32_bf16 v[196:199], v[96:99], v[76:79], v[196:199]
    s_waitcnt lgkmcnt(0)
    s_barrier
    v_mfma_f32_16x16x32_bf16 v[180:183], v[104:107], v[100:103], v[180:183]
    ds_read_b128 v[80:83], v250 offset:0
    ds_read_b128 v[76:79], v246 offset:0
    v_mfma_f32_16x16x32_bf16 v[184:187], v[108:111], v[100:103], v[184:187]
    ds_read_b128 v[84:87], v250 offset:2048
    ds_read_b128 v[88:91], v250 offset:4096
    v_mfma_f32_16x16x32_bf16 v[188:191], v[112:115], v[100:103], v[188:191]
    ds_read_b128 v[92:95], v250 offset:6144
    ds_read_b128 v[96:99], v250 offset:8192
    v_mfma_f32_16x16x32_bf16 v[192:195], v[116:119], v[100:103], v[192:195]
    v_mfma_f32_16x16x32_bf16 v[196:199], v[120:123], v[100:103], v[196:199]
    s_waitcnt lgkmcnt(0)
    v_mfma_f32_16x16x32_bf16 v[180:183], v[80:83], v[76:79], v[180:183]
    ds_read_b128 v[104:107], v251 offset:0
    ds_read_b128 v[100:103], v247 offset:0
    v_mfma_f32_16x16x32_bf16 v[184:187], v[84:87], v[76:79], v[184:187]
    ds_read_b128 v[108:111], v251 offset:2048
    ds_read_b128 v[112:115], v251 offset:4096
    v_mfma_f32_16x16x32_bf16 v[188:191], v[88:91], v[76:79], v[188:191]
    ds_read_b128 v[116:119], v251 offset:6144
    ds_read_b128 v[120:123], v251 offset:8192
    v_mfma_f32_16x16x32_bf16 v[192:195], v[92:95], v[76:79], v[192:195]
    v_mfma_f32_16x16x32_bf16 v[196:199], v[96:99], v[76:79], v[196:199]
    s_waitcnt lgkmcnt(0)
    v_mfma_f32_16x16x32_bf16 v[180:183], v[104:107], v[100:103], v[180:183]
    ds_read_b128 v[80:83], v250 offset:18432
    ds_read_b128 v[76:79], v246 offset:18432
    v_mfma_f32_16x16x32_bf16 v[184:187], v[108:111], v[100:103], v[184:187]
    ds_read_b128 v[84:87], v250 offset:20480
    ds_read_b128 v[88:91], v250 offset:22528
    v_mfma_f32_16x16x32_bf16 v[188:191], v[112:115], v[100:103], v[188:191]
    ds_read_b128 v[92:95], v250 offset:24576
    ds_read_b128 v[96:99], v250 offset:26624
    v_mfma_f32_16x16x32_bf16 v[192:195], v[116:119], v[100:103], v[192:195]
    v_mfma_f32_16x16x32_bf16 v[196:199], v[120:123], v[100:103], v[196:199]
    s_waitcnt lgkmcnt(0)
    v_mfma_f32_16x16x32_bf16 v[180:183], v[80:83], v[76:79], v[180:183]
    ds_read_b128 v[104:107], v251 offset:18432
    ds_read_b128 v[100:103], v247 offset:18432
    v_mfma_f32_16x16x32_bf16 v[184:187], v[84:87], v[76:79], v[184:187]
    ds_read_b128 v[108:111], v251 offset:20480
    ds_read_b128 v[112:115], v251 offset:22528
    v_mfma_f32_16x16x32_bf16 v[188:191], v[88:91], v[76:79], v[188:191]
    ds_read_b128 v[116:119], v251 offset:24576
    ds_read_b128 v[120:123], v251 offset:26624
    v_mfma_f32_16x16x32_bf16 v[192:195], v[92:95], v[76:79], v[192:195]
    v_mfma_f32_16x16x32_bf16 v[196:199], v[96:99], v[76:79], v[196:199]
    s_waitcnt lgkmcnt(0)
    s_barrier
    v_mfma_f32_16x16x32_bf16 v[180:183], v[104:107], v[100:103], v[180:183]
    ds_read_b128 v[80:83], v232 offset:0
    ds_read_b128 v[76:79], v228 offset:0
    v_mfma_f32_16x16x32_bf16 v[184:187], v[108:111], v[100:103], v[184:187]
    ds_read_b128 v[84:87], v232 offset:2048
    ds_read_b128 v[88:91], v232 offset:4096
    v_mfma_f32_16x16x32_bf16 v[188:191], v[112:115], v[100:103], v[188:191]
    ds_read_b128 v[92:95], v232 offset:6144
    ds_read_b128 v[96:99], v232 offset:8192
    v_mfma_f32_16x16x32_bf16 v[192:195], v[116:119], v[100:103], v[192:195]
    v_mfma_f32_16x16x32_bf16 v[196:199], v[120:123], v[100:103], v[196:199]
    s_waitcnt lgkmcnt(0)
    v_mfma_f32_16x16x32_bf16 v[180:183], v[80:83], v[76:79], v[180:183]
    ds_read_b128 v[104:107], v233 offset:0
    ds_read_b128 v[100:103], v229 offset:0
    v_mfma_f32_16x16x32_bf16 v[184:187], v[84:87], v[76:79], v[184:187]
    ds_read_b128 v[108:111], v233 offset:2048
    ds_read_b128 v[112:115], v233 offset:4096
    v_mfma_f32_16x16x32_bf16 v[188:191], v[88:91], v[76:79], v[188:191]
    ds_read_b128 v[116:119], v233 offset:6144
    ds_read_b128 v[120:123], v233 offset:8192
    v_mfma_f32_16x16x32_bf16 v[192:195], v[92:95], v[76:79], v[192:195]
    v_mfma_f32_16x16x32_bf16 v[196:199], v[96:99], v[76:79], v[196:199]
    s_waitcnt lgkmcnt(0)
    v_mfma_f32_16x16x32_bf16 v[180:183], v[104:107], v[100:103], v[180:183]
    ds_read_b128 v[80:83], v232 offset:18432
    ds_read_b128 v[76:79], v228 offset:18432
    v_mfma_f32_16x16x32_bf16 v[184:187], v[108:111], v[100:103], v[184:187]
    ds_read_b128 v[84:87], v232 offset:20480
    ds_read_b128 v[88:91], v232 offset:22528
    v_mfma_f32_16x16x32_bf16 v[188:191], v[112:115], v[100:103], v[188:191]
    ds_read_b128 v[92:95], v232 offset:24576
    ds_read_b128 v[96:99], v232 offset:26624
    v_mfma_f32_16x16x32_bf16 v[192:195], v[116:119], v[100:103], v[192:195]
    v_mfma_f32_16x16x32_bf16 v[196:199], v[120:123], v[100:103], v[196:199]
    s_waitcnt lgkmcnt(0)
    v_mfma_f32_16x16x32_bf16 v[180:183], v[80:83], v[76:79], v[180:183]
    ds_read_b128 v[104:107], v233 offset:18432
    ds_read_b128 v[100:103], v229 offset:18432
    v_mfma_f32_16x16x32_bf16 v[184:187], v[84:87], v[76:79], v[184:187]
    ds_read_b128 v[108:111], v233 offset:20480
    ds_read_b128 v[112:115], v233 offset:22528
    v_mfma_f32_16x16x32_bf16 v[188:191], v[88:91], v[76:79], v[188:191]
    ds_read_b128 v[116:119], v233 offset:24576
    ds_read_b128 v[120:123], v233 offset:26624
    v_mfma_f32_16x16x32_bf16 v[192:195], v[92:95], v[76:79], v[192:195]
    v_mfma_f32_16x16x32_bf16 v[196:199], v[96:99], v[76:79], v[196:199]
    s_waitcnt lgkmcnt(0)
    s_barrier
    v_mfma_f32_16x16x32_bf16 v[180:183], v[104:107], v[100:103], v[180:183]
    ds_read_b128 v[80:83], v238 offset:0
    ds_read_b128 v[76:79], v234 offset:0
    v_mfma_f32_16x16x32_bf16 v[184:187], v[108:111], v[100:103], v[184:187]
    ds_read_b128 v[84:87], v238 offset:2048
    ds_read_b128 v[88:91], v238 offset:4096
    v_mfma_f32_16x16x32_bf16 v[188:191], v[112:115], v[100:103], v[188:191]
    ds_read_b128 v[92:95], v238 offset:6144
    ds_read_b128 v[96:99], v238 offset:8192
    v_mfma_f32_16x16x32_bf16 v[192:195], v[116:119], v[100:103], v[192:195]
    v_mfma_f32_16x16x32_bf16 v[196:199], v[120:123], v[100:103], v[196:199]
    s_waitcnt lgkmcnt(0)
    v_mfma_f32_16x16x32_bf16 v[180:183], v[80:83], v[76:79], v[180:183]
    ds_read_b128 v[104:107], v239 offset:0
    ds_read_b128 v[100:103], v235 offset:0
    v_mfma_f32_16x16x32_bf16 v[184:187], v[84:87], v[76:79], v[184:187]
    ds_read_b128 v[108:111], v239 offset:2048
    ds_read_b128 v[112:115], v239 offset:4096
    v_mfma_f32_16x16x32_bf16 v[188:191], v[88:91], v[76:79], v[188:191]
    ds_read_b128 v[116:119], v239 offset:6144
    ds_read_b128 v[120:123], v239 offset:8192
    v_mfma_f32_16x16x32_bf16 v[192:195], v[92:95], v[76:79], v[192:195]
    v_mfma_f32_16x16x32_bf16 v[196:199], v[96:99], v[76:79], v[196:199]
    s_waitcnt lgkmcnt(0)
    v_mfma_f32_16x16x32_bf16 v[180:183], v[104:107], v[100:103], v[180:183]
    ds_read_b128 v[80:83], v238 offset:18432
    ds_read_b128 v[76:79], v234 offset:18432
    v_mfma_f32_16x16x32_bf16 v[184:187], v[108:111], v[100:103], v[184:187]
    ds_read_b128 v[84:87], v238 offset:20480
    ds_read_b128 v[88:91], v238 offset:22528
    v_mfma_f32_16x16x32_bf16 v[188:191], v[112:115], v[100:103], v[188:191]
    ds_read_b128 v[92:95], v238 offset:24576
    ds_read_b128 v[96:99], v238 offset:26624
    v_mfma_f32_16x16x32_bf16 v[192:195], v[116:119], v[100:103], v[192:195]
    v_mfma_f32_16x16x32_bf16 v[196:199], v[120:123], v[100:103], v[196:199]
    s_waitcnt lgkmcnt(0)
    v_mfma_f32_16x16x32_bf16 v[180:183], v[80:83], v[76:79], v[180:183]
    ds_read_b128 v[104:107], v239 offset:18432
    ds_read_b128 v[100:103], v235 offset:18432
    v_mfma_f32_16x16x32_bf16 v[184:187], v[84:87], v[76:79], v[184:187]
    ds_read_b128 v[108:111], v239 offset:20480
    ds_read_b128 v[112:115], v239 offset:22528
    v_mfma_f32_16x16x32_bf16 v[188:191], v[88:91], v[76:79], v[188:191]
    ds_read_b128 v[116:119], v239 offset:24576
    ds_read_b128 v[120:123], v239 offset:26624
    v_mfma_f32_16x16x32_bf16 v[192:195], v[92:95], v[76:79], v[192:195]
    v_mfma_f32_16x16x32_bf16 v[196:199], v[96:99], v[76:79], v[196:199]
    s_waitcnt lgkmcnt(0)
    s_barrier
    v_mfma_f32_16x16x32_bf16 v[180:183], v[104:107], v[100:103], v[180:183]
    ds_read_b128 v[80:83], v244 offset:0
    ds_read_b128 v[76:79], v240 offset:0
    v_mfma_f32_16x16x32_bf16 v[184:187], v[108:111], v[100:103], v[184:187]
    ds_read_b128 v[84:87], v244 offset:2048
    ds_read_b128 v[88:91], v244 offset:4096
    v_mfma_f32_16x16x32_bf16 v[188:191], v[112:115], v[100:103], v[188:191]
    ds_read_b128 v[92:95], v244 offset:6144
    ds_read_b128 v[96:99], v244 offset:8192
    v_mfma_f32_16x16x32_bf16 v[192:195], v[116:119], v[100:103], v[192:195]
    v_mfma_f32_16x16x32_bf16 v[196:199], v[120:123], v[100:103], v[196:199]
    s_waitcnt lgkmcnt(0)
    v_mfma_f32_16x16x32_bf16 v[180:183], v[80:83], v[76:79], v[180:183]
    ds_read_b128 v[104:107], v245 offset:0
    ds_read_b128 v[100:103], v241 offset:0
    v_mfma_f32_16x16x32_bf16 v[184:187], v[84:87], v[76:79], v[184:187]
    ds_read_b128 v[108:111], v245 offset:2048
    ds_read_b128 v[112:115], v245 offset:4096
    v_mfma_f32_16x16x32_bf16 v[188:191], v[88:91], v[76:79], v[188:191]
    ds_read_b128 v[116:119], v245 offset:6144
    ds_read_b128 v[120:123], v245 offset:8192
    v_mfma_f32_16x16x32_bf16 v[192:195], v[92:95], v[76:79], v[192:195]
    v_mfma_f32_16x16x32_bf16 v[196:199], v[96:99], v[76:79], v[196:199]
    s_waitcnt lgkmcnt(0)
    v_mfma_f32_16x16x32_bf16 v[180:183], v[104:107], v[100:103], v[180:183]
    ds_read_b128 v[80:83], v244 offset:18432
    ds_read_b128 v[76:79], v240 offset:18432
    v_mfma_f32_16x16x32_bf16 v[184:187], v[108:111], v[100:103], v[184:187]
    ds_read_b128 v[84:87], v244 offset:20480
    ds_read_b128 v[88:91], v244 offset:22528
    v_mfma_f32_16x16x32_bf16 v[188:191], v[112:115], v[100:103], v[188:191]
    ds_read_b128 v[92:95], v244 offset:24576
    ds_read_b128 v[96:99], v244 offset:26624
    v_mfma_f32_16x16x32_bf16 v[192:195], v[116:119], v[100:103], v[192:195]
    v_mfma_f32_16x16x32_bf16 v[196:199], v[120:123], v[100:103], v[196:199]
    s_waitcnt lgkmcnt(0)
    v_mfma_f32_16x16x32_bf16 v[180:183], v[80:83], v[76:79], v[180:183]
    ds_read_b128 v[104:107], v245 offset:18432
    ds_read_b128 v[100:103], v241 offset:18432
    v_mfma_f32_16x16x32_bf16 v[184:187], v[84:87], v[76:79], v[184:187]
    ds_read_b128 v[108:111], v245 offset:20480
    ds_read_b128 v[112:115], v245 offset:22528
    v_mfma_f32_16x16x32_bf16 v[188:191], v[88:91], v[76:79], v[188:191]
    ds_read_b128 v[116:119], v245 offset:24576
    ds_read_b128 v[120:123], v245 offset:26624
    v_mfma_f32_16x16x32_bf16 v[192:195], v[92:95], v[76:79], v[192:195]
    v_mfma_f32_16x16x32_bf16 v[196:199], v[96:99], v[76:79], v[196:199]
    s_waitcnt lgkmcnt(0)
    s_barrier
    v_mfma_f32_16x16x32_bf16 v[180:183], v[104:107], v[100:103], v[180:183]
    ds_read_b128 v[80:83], v250 offset:0
    ds_read_b128 v[76:79], v246 offset:0
    v_mfma_f32_16x16x32_bf16 v[184:187], v[108:111], v[100:103], v[184:187]
    ds_read_b128 v[84:87], v250 offset:2048
    ds_read_b128 v[88:91], v250 offset:4096
    v_mfma_f32_16x16x32_bf16 v[188:191], v[112:115], v[100:103], v[188:191]
    ds_read_b128 v[92:95], v250 offset:6144
    ds_read_b128 v[96:99], v250 offset:8192
    v_mfma_f32_16x16x32_bf16 v[192:195], v[116:119], v[100:103], v[192:195]
    v_mfma_f32_16x16x32_bf16 v[196:199], v[120:123], v[100:103], v[196:199]
    s_waitcnt lgkmcnt(0)
    v_mfma_f32_16x16x32_bf16 v[180:183], v[80:83], v[76:79], v[180:183]
    ds_read_b128 v[104:107], v251 offset:0
    ds_read_b128 v[100:103], v247 offset:0
    v_mfma_f32_16x16x32_bf16 v[184:187], v[84:87], v[76:79], v[184:187]
    ds_read_b128 v[108:111], v251 offset:2048
    ds_read_b128 v[112:115], v251 offset:4096
    v_mfma_f32_16x16x32_bf16 v[188:191], v[88:91], v[76:79], v[188:191]
    ds_read_b128 v[116:119], v251 offset:6144
    ds_read_b128 v[120:123], v251 offset:8192
    v_mfma_f32_16x16x32_bf16 v[192:195], v[92:95], v[76:79], v[192:195]
    v_mfma_f32_16x16x32_bf16 v[196:199], v[96:99], v[76:79], v[196:199]
    s_waitcnt lgkmcnt(0)
    v_mfma_f32_16x16x32_bf16 v[180:183], v[104:107], v[100:103], v[180:183]
    ds_read_b128 v[80:83], v250 offset:18432
    ds_read_b128 v[76:79], v246 offset:18432
    v_mfma_f32_16x16x32_bf16 v[184:187], v[108:111], v[100:103], v[184:187]
    ds_read_b128 v[84:87], v250 offset:20480
    ds_read_b128 v[88:91], v250 offset:22528
    v_mfma_f32_16x16x32_bf16 v[188:191], v[112:115], v[100:103], v[188:191]
    ds_read_b128 v[92:95], v250 offset:24576
    ds_read_b128 v[96:99], v250 offset:26624
    v_mfma_f32_16x16x32_bf16 v[192:195], v[116:119], v[100:103], v[192:195]
    v_mfma_f32_16x16x32_bf16 v[196:199], v[120:123], v[100:103], v[196:199]
    s_waitcnt lgkmcnt(0)
    v_mfma_f32_16x16x32_bf16 v[180:183], v[80:83], v[76:79], v[180:183]
    ds_read_b128 v[104:107], v251 offset:18432
    ds_read_b128 v[100:103], v247 offset:18432
    v_mfma_f32_16x16x32_bf16 v[184:187], v[84:87], v[76:79], v[184:187]
    ds_read_b128 v[108:111], v251 offset:20480
    ds_read_b128 v[112:115], v251 offset:22528
    v_mfma_f32_16x16x32_bf16 v[188:191], v[88:91], v[76:79], v[188:191]
    ds_read_b128 v[116:119], v251 offset:24576
    ds_read_b128 v[120:123], v251 offset:26624
    v_mfma_f32_16x16x32_bf16 v[192:195], v[92:95], v[76:79], v[192:195]
    v_mfma_f32_16x16x32_bf16 v[196:199], v[96:99], v[76:79], v[196:199]
    s_waitcnt lgkmcnt(0)
    s_barrier
    v_mfma_f32_16x16x32_bf16 v[180:183], v[104:107], v[100:103], v[180:183]
    ds_read_b128 v[20:23], v232 offset:0
    ds_read_b64_tr_b16 v[16:17], v230 offset:0
    ds_read_b64_tr_b16 v[18:19], v230 offset:512
    v_mfma_f32_16x16x32_bf16 v[184:187], v[108:111], v[100:103], v[184:187]
    ds_read_b128 v[24:27], v232 offset:2048
    ds_read_b128 v[28:31], v232 offset:4096
    ds_read_b128 v[32:35], v232 offset:6144
    v_mfma_f32_16x16x32_bf16 v[188:191], v[112:115], v[100:103], v[188:191]
    ds_read_b128 v[36:39], v232 offset:8192
    ds_read_b128 v[44:47], v233 offset:0
    ds_read_b64_tr_b16 v[40:41], v230 offset:4096
    v_mfma_f32_16x16x32_bf16 v[192:195], v[116:119], v[100:103], v[192:195]
    ds_read_b64_tr_b16 v[42:43], v230 offset:4608
    ds_read_b128 v[48:51], v233 offset:2048
    ds_read_b128 v[52:55], v233 offset:4096
    v_mfma_f32_16x16x32_bf16 v[196:199], v[120:123], v[100:103], v[196:199]
    ds_read_b128 v[56:59], v233 offset:6144
    ds_read_b128 v[60:63], v233 offset:8192
    s_waitcnt lgkmcnt(0)
    v_mfma_f32_16x16x32_bf16 v[140:143], v[20:23], v[16:19], 0
    ds_read_b128 v[80:83], v232 offset:18432
    ds_read_b64_tr_b16 v[76:77], v230 offset:18432
    v_mfma_f32_16x16x32_bf16 v[144:147], v[24:27], v[16:19], 0
    ds_read_b64_tr_b16 v[78:79], v230 offset:18944
    ds_read_b128 v[84:87], v232 offset:20480
    v_mfma_f32_16x16x32_bf16 v[148:151], v[28:31], v[16:19], 0
    ds_read_b128 v[88:91], v232 offset:22528
    ds_read_b128 v[92:95], v232 offset:24576
    v_mfma_f32_16x16x32_bf16 v[152:155], v[32:35], v[16:19], 0
    ds_read_b128 v[96:99], v232 offset:26624
    ds_read_b128 v[104:107], v233 offset:18432
    v_mfma_f32_16x16x32_bf16 v[156:159], v[36:39], v[16:19], 0
    ds_read_b64_tr_b16 v[100:101], v230 offset:22528
    ds_read_b64_tr_b16 v[102:103], v230 offset:23040
    v_mfma_f32_16x16x32_bf16 v[140:143], v[44:47], v[40:43], v[140:143]
    ds_read_b128 v[108:111], v233 offset:20480
    ds_read_b128 v[112:115], v233 offset:22528
    v_mfma_f32_16x16x32_bf16 v[144:147], v[48:51], v[40:43], v[144:147]
    ds_read_b128 v[116:119], v233 offset:24576
    ds_read_b128 v[120:123], v233 offset:26624
    v_mfma_f32_16x16x32_bf16 v[148:151], v[52:55], v[40:43], v[148:151]
    v_mfma_f32_16x16x32_bf16 v[152:155], v[56:59], v[40:43], v[152:155]
    v_mfma_f32_16x16x32_bf16 v[156:159], v[60:63], v[40:43], v[156:159]
    s_waitcnt lgkmcnt(0)
    s_barrier
    v_mfma_f32_16x16x32_bf16 v[140:143], v[80:83], v[76:79], v[140:143]
    ds_read_b128 v[20:23], v238 offset:0
    ds_read_b64_tr_b16 v[16:17], v236 offset:0
    ds_read_b64 v[64:65], v14 offset:0
    ds_read_b64 v[160:161], v14 offset:256
    v_mfma_f32_16x16x32_bf16 v[144:147], v[84:87], v[76:79], v[144:147]
    ds_read_b64_tr_b16 v[18:19], v236 offset:512
    ds_read_b128 v[24:27], v238 offset:2048
    ds_read_b64 v[66:67], v14 offset:32
    ds_read_b64 v[162:163], v14 offset:288
    v_mfma_f32_16x16x32_bf16 v[148:151], v[88:91], v[76:79], v[148:151]
    ds_read_b128 v[28:31], v238 offset:4096
    ds_read_b128 v[32:35], v238 offset:6144
    ds_read_b64 v[68:69], v14 offset:64
    ds_read_b64 v[164:165], v14 offset:320
    v_mfma_f32_16x16x32_bf16 v[152:155], v[92:95], v[76:79], v[152:155]
    ds_read_b128 v[36:39], v238 offset:8192
    ds_read_b128 v[44:47], v239 offset:0
    ds_read_b64 v[70:71], v14 offset:96
    ds_read_b64 v[166:167], v14 offset:352
    v_mfma_f32_16x16x32_bf16 v[156:159], v[96:99], v[76:79], v[156:159]
    ds_read_b64_tr_b16 v[40:41], v236 offset:4096
    ds_read_b64_tr_b16 v[42:43], v236 offset:4608
    ds_read_b64 v[72:73], v14 offset:128
    ds_read_b64 v[168:169], v14 offset:384
    v_mfma_f32_16x16x32_bf16 v[140:143], v[104:107], v[100:103], v[140:143]
    ds_read_b128 v[48:51], v239 offset:2048
    ds_read_b128 v[52:55], v239 offset:4096
    s_waitcnt lgkmcnt(0)
    v_lshlrev_b32 v200, 16, v64
    v_mfma_f32_16x16x32_bf16 v[144:147], v[108:111], v[100:103], v[144:147]
    ds_read_b128 v[56:59], v239 offset:6144
    ds_read_b128 v[60:63], v239 offset:8192
    v_and_b32 v201, s20, v64
    v_lshlrev_b32 v124, 16, v160
    v_mfma_f32_16x16x32_bf16 v[148:151], v[112:115], v[100:103], v[148:151]
    v_and_b32 v125, s20, v160
    v_lshlrev_b32 v202, 16, v65
    v_mfma_f32_16x16x32_bf16 v[152:155], v[116:119], v[100:103], v[152:155]
    v_and_b32 v203, s20, v65
    v_lshlrev_b32 v126, 16, v161
    v_mfma_f32_16x16x32_bf16 v[156:159], v[120:123], v[100:103], v[156:159]
    v_and_b32 v127, s20, v161
    v_lshlrev_b32 v204, 16, v66
    v_and_b32 v205, s20, v66
    v_lshlrev_b32 v128, 16, v162
    v_and_b32 v129, s20, v162
    v_lshlrev_b32 v206, 16, v67
    v_and_b32 v207, s20, v67
    v_lshlrev_b32 v130, 16, v163
    v_and_b32 v131, s20, v163
    v_lshlrev_b32 v208, 16, v68
    v_and_b32 v209, s20, v68
    v_lshlrev_b32 v132, 16, v164
    v_and_b32 v133, s20, v164
    v_lshlrev_b32 v210, 16, v69
    v_and_b32 v211, s20, v69
    v_lshlrev_b32 v134, 16, v165
    v_and_b32 v135, s20, v165
    v_lshlrev_b32 v212, 16, v70
    s_waitcnt lgkmcnt(0)
    v_mfma_f32_16x16x32_bf16 v[140:143], v[20:23], v[16:19], v[140:143]
    ds_read_b128 v[80:83], v238 offset:18432
    ds_read_b64_tr_b16 v[76:77], v236 offset:18432
    v_and_b32 v213, s20, v70
    v_lshlrev_b32 v136, 16, v166
    v_mfma_f32_16x16x32_bf16 v[144:147], v[24:27], v[16:19], v[144:147]
    ds_read_b64_tr_b16 v[78:79], v236 offset:18944
    ds_read_b128 v[84:87], v238 offset:20480
    v_and_b32 v137, s20, v166
    v_lshlrev_b32 v214, 16, v71
    v_mfma_f32_16x16x32_bf16 v[148:151], v[28:31], v[16:19], v[148:151]
    ds_read_b128 v[88:91], v238 offset:22528
    ds_read_b128 v[92:95], v238 offset:24576
    v_and_b32 v215, s20, v71
    v_lshlrev_b32 v138, 16, v167
    v_mfma_f32_16x16x32_bf16 v[152:155], v[32:35], v[16:19], v[152:155]
    ds_read_b128 v[96:99], v238 offset:26624
    ds_read_b128 v[104:107], v239 offset:18432
    v_and_b32 v139, s20, v167
    v_lshlrev_b32 v216, 16, v72
    v_mfma_f32_16x16x32_bf16 v[156:159], v[36:39], v[16:19], v[156:159]
    ds_read_b64_tr_b16 v[100:101], v236 offset:22528
    ds_read_b64_tr_b16 v[102:103], v236 offset:23040
    v_and_b32 v217, s20, v72
    v_lshlrev_b32 v220, 16, v168
    v_mfma_f32_16x16x32_bf16 v[140:143], v[44:47], v[40:43], v[140:143]
    ds_read_b128 v[108:111], v239 offset:20480
    ds_read_b128 v[112:115], v239 offset:22528
    v_and_b32 v221, s20, v168
    v_lshlrev_b32 v218, 16, v73
    v_mfma_f32_16x16x32_bf16 v[144:147], v[48:51], v[40:43], v[144:147]
    ds_read_b128 v[116:119], v239 offset:24576
    ds_read_b128 v[120:123], v239 offset:26624
    v_and_b32 v219, s20, v73
    v_lshlrev_b32 v222, 16, v169
    v_mfma_f32_16x16x32_bf16 v[148:151], v[52:55], v[40:43], v[148:151]
    v_and_b32 v223, s20, v169
    v_cvt_pk_bf16_f32 v64, v180, v181
    v_mfma_f32_16x16x32_bf16 v[152:155], v[56:59], v[40:43], v[152:155]
    v_cvt_pk_bf16_f32 v65, v182, v183
    v_cvt_pk_bf16_f32 v66, v184, v185
    v_mfma_f32_16x16x32_bf16 v[156:159], v[60:63], v[40:43], v[156:159]
    v_cvt_pk_bf16_f32 v67, v186, v187
    v_cvt_pk_bf16_f32 v68, v188, v189
    v_cvt_pk_bf16_f32 v69, v190, v191
    v_cvt_pk_bf16_f32 v70, v192, v193
    v_cvt_pk_bf16_f32 v71, v194, v195
    v_cvt_pk_bf16_f32 v72, v196, v197
    v_cvt_pk_bf16_f32 v73, v198, v199
    v_dot2_f32_bf16 v180, v64, s21, v200
    v_dot2_f32_bf16 v181, v64, s26, v201
    v_dot2_f32_bf16 v182, v65, s21, v202
    v_dot2_f32_bf16 v183, v65, s26, v203
    v_dot2_f32_bf16 v184, v66, s21, v204
    v_dot2_f32_bf16 v185, v66, s26, v205
    v_dot2_f32_bf16 v186, v67, s21, v206
    v_dot2_f32_bf16 v187, v67, s26, v207
    v_dot2_f32_bf16 v188, v68, s21, v208
    v_dot2_f32_bf16 v189, v68, s26, v209
    v_dot2_f32_bf16 v190, v69, s21, v210
    s_waitcnt lgkmcnt(0)
    s_barrier
    v_mfma_f32_16x16x32_bf16 v[140:143], v[80:83], v[76:79], v[140:143]
    ds_read_b128 v[20:23], v244 offset:0
    ds_read_b64_tr_b16 v[16:17], v242 offset:0
    v_dot2_f32_bf16 v191, v69, s26, v211
    v_dot2_f32_bf16 v192, v70, s21, v212
    v_mfma_f32_16x16x32_bf16 v[144:147], v[84:87], v[76:79], v[144:147]
    ds_read_b64_tr_b16 v[18:19], v242 offset:512
    ds_read_b128 v[24:27], v244 offset:2048
    v_dot2_f32_bf16 v193, v70, s26, v213
    v_dot2_f32_bf16 v194, v71, s21, v214
    v_mfma_f32_16x16x32_bf16 v[148:151], v[88:91], v[76:79], v[148:151]
    ds_read_b128 v[28:31], v244 offset:4096
    ds_read_b128 v[32:35], v244 offset:6144
    v_dot2_f32_bf16 v195, v71, s26, v215
    v_dot2_f32_bf16 v196, v72, s21, v216
    v_mfma_f32_16x16x32_bf16 v[152:155], v[92:95], v[76:79], v[152:155]
    ds_read_b128 v[36:39], v244 offset:8192
    ds_read_b128 v[44:47], v245 offset:0
    v_dot2_f32_bf16 v197, v72, s26, v217
    v_dot2_f32_bf16 v198, v73, s21, v218
    v_mfma_f32_16x16x32_bf16 v[156:159], v[96:99], v[76:79], v[156:159]
    ds_read_b64_tr_b16 v[40:41], v242 offset:4096
    ds_read_b64_tr_b16 v[42:43], v242 offset:4608
    v_dot2_f32_bf16 v199, v73, s26, v219
    s_nop 1
    v_mfma_f32_16x16x32_bf16 v[140:143], v[104:107], v[100:103], v[140:143]
    ds_read_b128 v[48:51], v245 offset:2048
    ds_read_b128 v[52:55], v245 offset:4096
    v_cvt_pk_bf16_f32 v64, v180, v181
    v_cvt_pk_bf16_f32 v65, v182, v183
    v_mfma_f32_16x16x32_bf16 v[144:147], v[108:111], v[100:103], v[144:147]
    ds_read_b128 v[56:59], v245 offset:6144
    ds_read_b128 v[60:63], v245 offset:8192
    v_cvt_pk_bf16_f32 v66, v184, v185
    v_cvt_pk_bf16_f32 v67, v186, v187
    v_mfma_f32_16x16x32_bf16 v[148:151], v[112:115], v[100:103], v[148:151]
    v_cvt_pk_bf16_f32 v68, v188, v189
    v_cvt_pk_bf16_f32 v69, v190, v191
    v_mfma_f32_16x16x32_bf16 v[152:155], v[116:119], v[100:103], v[152:155]
    v_cvt_pk_bf16_f32 v70, v192, v193
    v_cvt_pk_bf16_f32 v71, v194, v195
    v_mfma_f32_16x16x32_bf16 v[156:159], v[120:123], v[100:103], v[156:159]
    v_cvt_pk_bf16_f32 v72, v196, v197
    v_cvt_pk_bf16_f32 v73, v198, v199
    v_lshlrev_b32 v180, 16, v64
    v_and_b32 v181, s20, v64
    v_lshlrev_b32 v182, 16, v65
    v_and_b32 v183, s20, v65
    v_lshlrev_b32 v184, 16, v66
    v_and_b32 v185, s20, v66
    v_lshlrev_b32 v186, 16, v67
    v_and_b32 v187, s20, v67
    v_lshlrev_b32 v188, 16, v68
    v_and_b32 v189, s20, v68
    v_lshlrev_b32 v190, 16, v69
    v_and_b32 v191, s20, v69
    v_lshlrev_b32 v192, 16, v70
    v_and_b32 v193, s20, v70
    v_lshlrev_b32 v194, 16, v71
    v_and_b32 v195, s20, v71
    s_waitcnt lgkmcnt(0)
    v_mfma_f32_16x16x32_bf16 v[140:143], v[20:23], v[16:19], v[140:143]
    ds_read_b128 v[80:83], v244 offset:18432
    ds_read_b64_tr_b16 v[76:77], v242 offset:18432
    v_lshlrev_b32 v196, 16, v72
    v_and_b32 v197, s20, v72
    v_mfma_f32_16x16x32_bf16 v[144:147], v[24:27], v[16:19], v[144:147]
    ds_read_b64_tr_b16 v[78:79], v242 offset:18944
    ds_read_b128 v[84:87], v244 offset:20480
    v_lshlrev_b32 v198, 16, v73
    v_and_b32 v199, s20, v73
    v_mfma_f32_16x16x32_bf16 v[148:151], v[28:31], v[16:19], v[148:151]
    ds_read_b128 v[88:91], v244 offset:22528
    ds_read_b128 v[92:95], v244 offset:24576
    v_pk_mul_f32 v[160:161], v[180:181], s[88:89]
    v_pk_mul_f32 v[162:163], v[182:183], s[88:89]
    v_mfma_f32_16x16x32_bf16 v[152:155], v[32:35], v[16:19], v[152:155]
    ds_read_b128 v[96:99], v244 offset:26624
    ds_read_b128 v[104:107], v245 offset:18432
    v_pk_mul_f32 v[164:165], v[184:185], s[88:89]
    v_pk_mul_f32 v[166:167], v[186:187], s[88:89]
    v_mfma_f32_16x16x32_bf16 v[156:159], v[36:39], v[16:19], v[156:159]
    ds_read_b64_tr_b16 v[100:101], v242 offset:22528
    ds_read_b64_tr_b16 v[102:103], v242 offset:23040
    v_pk_mul_f32 v[168:169], v[188:189], s[88:89]
    v_pk_mul_f32 v[170:171], v[190:191], s[88:89]
    v_mfma_f32_16x16x32_bf16 v[140:143], v[44:47], v[40:43], v[140:143]
    ds_read_b128 v[108:111], v245 offset:20480
    ds_read_b128 v[112:115], v245 offset:22528
    v_pk_mul_f32 v[172:173], v[192:193], s[88:89]
    v_pk_mul_f32 v[174:175], v[194:195], s[88:89]
    v_mfma_f32_16x16x32_bf16 v[144:147], v[48:51], v[40:43], v[144:147]
    ds_read_b128 v[116:119], v245 offset:24576
    ds_read_b128 v[120:123], v245 offset:26624
    v_pk_mul_f32 v[176:177], v[196:197], s[88:89]
    v_pk_mul_f32 v[178:179], v[198:199], s[88:89]
    v_mfma_f32_16x16x32_bf16 v[148:151], v[52:55], v[40:43], v[148:151]
    v_exp_f32 v160, v160
    v_exp_f32 v161, v161
    v_mfma_f32_16x16x32_bf16 v[152:155], v[56:59], v[40:43], v[152:155]
    v_exp_f32 v162, v162
    v_exp_f32 v163, v163
    v_mfma_f32_16x16x32_bf16 v[156:159], v[60:63], v[40:43], v[156:159]
    v_exp_f32 v164, v164
    v_exp_f32 v165, v165
    v_exp_f32 v166, v166
    v_exp_f32 v167, v167
    v_exp_f32 v168, v168
    v_exp_f32 v169, v169
    v_exp_f32 v170, v170
    v_exp_f32 v171, v171
    v_exp_f32 v172, v172
    v_exp_f32 v173, v173
    v_exp_f32 v174, v174
    v_exp_f32 v175, v175
    v_exp_f32 v176, v176
    v_exp_f32 v177, v177
    v_exp_f32 v178, v178
    v_exp_f32 v179, v179
    s_nop 0
    v_pk_add_f32 v[160:161], v[160:161], 1.0
    s_waitcnt lgkmcnt(0)
    s_barrier
    v_mfma_f32_16x16x32_bf16 v[140:143], v[80:83], v[76:79], v[140:143]
    ds_read_b128 v[20:23], v250 offset:0
    ds_read_b64_tr_b16 v[16:17], v248 offset:0
    v_pk_add_f32 v[162:163], v[162:163], 1.0
    v_pk_add_f32 v[164:165], v[164:165], 1.0
    v_mfma_f32_16x16x32_bf16 v[144:147], v[84:87], v[76:79], v[144:147]
    ds_read_b64_tr_b16 v[18:19], v248 offset:512
    ds_read_b128 v[24:27], v250 offset:2048
    v_pk_add_f32 v[166:167], v[166:167], 1.0
    v_pk_add_f32 v[168:169], v[168:169], 1.0
    v_mfma_f32_16x16x32_bf16 v[148:151], v[88:91], v[76:79], v[148:151]
    ds_read_b128 v[28:31], v250 offset:4096
    ds_read_b128 v[32:35], v250 offset:6144
    v_pk_add_f32 v[170:171], v[170:171], 1.0
    v_pk_add_f32 v[172:173], v[172:173], 1.0
    v_mfma_f32_16x16x32_bf16 v[152:155], v[92:95], v[76:79], v[152:155]
    ds_read_b128 v[36:39], v250 offset:8192
    ds_read_b128 v[44:47], v251 offset:0
    v_pk_add_f32 v[174:175], v[174:175], 1.0
    v_pk_add_f32 v[176:177], v[176:177], 1.0
    v_mfma_f32_16x16x32_bf16 v[156:159], v[96:99], v[76:79], v[156:159]
    ds_read_b64_tr_b16 v[40:41], v248 offset:4096
    ds_read_b64_tr_b16 v[42:43], v248 offset:4608
    v_pk_add_f32 v[178:179], v[178:179], 1.0
    v_rcp_f32 v160, v160
    v_mfma_f32_16x16x32_bf16 v[140:143], v[104:107], v[100:103], v[140:143]
    ds_read_b128 v[48:51], v251 offset:2048
    ds_read_b128 v[52:55], v251 offset:4096
    v_rcp_f32 v161, v161
    v_rcp_f32 v162, v162
    v_mfma_f32_16x16x32_bf16 v[144:147], v[108:111], v[100:103], v[144:147]
    ds_read_b128 v[56:59], v251 offset:6144
    ds_read_b128 v[60:63], v251 offset:8192
    v_rcp_f32 v163, v163
    v_rcp_f32 v164, v164
    v_mfma_f32_16x16x32_bf16 v[148:151], v[112:115], v[100:103], v[148:151]
    v_rcp_f32 v165, v165
    v_rcp_f32 v166, v166
    v_mfma_f32_16x16x32_bf16 v[152:155], v[116:119], v[100:103], v[152:155]
    v_rcp_f32 v167, v167
    v_rcp_f32 v168, v168
    v_mfma_f32_16x16x32_bf16 v[156:159], v[120:123], v[100:103], v[156:159]
    v_rcp_f32 v169, v169
    v_rcp_f32 v170, v170
    v_rcp_f32 v171, v171
    v_rcp_f32 v172, v172
    v_rcp_f32 v173, v173
    v_rcp_f32 v174, v174
    v_rcp_f32 v175, v175
    v_rcp_f32 v176, v176
    v_rcp_f32 v177, v177
    v_rcp_f32 v178, v178
    v_rcp_f32 v179, v179
    s_nop 0
    v_pk_mul_f32 v[180:181], v[180:181], v[160:161]
    v_pk_mul_f32 v[182:183], v[182:183], v[162:163]
    v_pk_mul_f32 v[184:185], v[184:185], v[164:165]
    v_pk_mul_f32 v[186:187], v[186:187], v[166:167]
    v_pk_mul_f32 v[188:189], v[188:189], v[168:169]
    v_pk_mul_f32 v[190:191], v[190:191], v[170:171]
    s_waitcnt lgkmcnt(0)
    v_mfma_f32_16x16x32_bf16 v[140:143], v[20:23], v[16:19], v[140:143]
    ds_read_b128 v[80:83], v250 offset:18432
    ds_read_b64_tr_b16 v[76:77], v248 offset:18432
    v_pk_mul_f32 v[192:193], v[192:193], v[172:173]
    v_pk_mul_f32 v[194:195], v[194:195], v[174:175]
    v_mfma_f32_16x16x32_bf16 v[144:147], v[24:27], v[16:19], v[144:147]
    ds_read_b64_tr_b16 v[78:79], v248 offset:18944
    ds_read_b128 v[84:87], v250 offset:20480
    v_pk_mul_f32 v[196:197], v[196:197], v[176:177]
    v_pk_mul_f32 v[198:199], v[198:199], v[178:179]
    v_mfma_f32_16x16x32_bf16 v[148:151], v[28:31], v[16:19], v[148:151]
    ds_read_b128 v[88:91], v250 offset:22528
    ds_read_b128 v[92:95], v250 offset:24576
    v_cvt_pk_bf16_f32 v64, v180, v181
    v_cvt_pk_bf16_f32 v65, v182, v183
    v_mfma_f32_16x16x32_bf16 v[152:155], v[32:35], v[16:19], v[152:155]
    ds_read_b128 v[96:99], v250 offset:26624
    ds_read_b128 v[104:107], v251 offset:18432
    v_cvt_pk_bf16_f32 v66, v184, v185
    v_cvt_pk_bf16_f32 v67, v186, v187
    v_mfma_f32_16x16x32_bf16 v[156:159], v[36:39], v[16:19], v[156:159]
    ds_read_b64_tr_b16 v[100:101], v248 offset:22528
    ds_read_b64_tr_b16 v[102:103], v248 offset:23040
    v_cvt_pk_bf16_f32 v68, v188, v189
    v_cvt_pk_bf16_f32 v69, v190, v191
    v_mfma_f32_16x16x32_bf16 v[140:143], v[44:47], v[40:43], v[140:143]
    ds_read_b128 v[108:111], v251 offset:20480
    ds_read_b128 v[112:115], v251 offset:22528
    v_cvt_pk_bf16_f32 v70, v192, v193
    v_cvt_pk_bf16_f32 v71, v194, v195
    v_mfma_f32_16x16x32_bf16 v[144:147], v[48:51], v[40:43], v[144:147]
    ds_read_b128 v[116:119], v251 offset:24576
    ds_read_b128 v[120:123], v251 offset:26624
    v_cvt_pk_bf16_f32 v72, v196, v197
    v_cvt_pk_bf16_f32 v73, v198, v199
    v_mfma_f32_16x16x32_bf16 v[148:151], v[52:55], v[40:43], v[148:151]
    v_lshlrev_b32 v160, 16, v64
    v_and_b32 v161, s20, v64
    v_mfma_f32_16x16x32_bf16 v[152:155], v[56:59], v[40:43], v[152:155]
    v_lshlrev_b32 v162, 16, v65
    v_and_b32 v163, s20, v65
    v_mfma_f32_16x16x32_bf16 v[156:159], v[60:63], v[40:43], v[156:159]
    v_lshlrev_b32 v164, 16, v66
    v_and_b32 v165, s20, v66
    v_lshlrev_b32 v166, 16, v67
    v_and_b32 v167, s20, v67
    v_lshlrev_b32 v168, 16, v68
    v_and_b32 v169, s20, v68
    v_lshlrev_b32 v170, 16, v69
    v_and_b32 v171, s20, v69
    v_lshlrev_b32 v172, 16, v70
    v_and_b32 v173, s20, v70
    v_lshlrev_b32 v174, 16, v71
    v_and_b32 v175, s20, v71
    v_lshlrev_b32 v176, 16, v72
    v_and_b32 v177, s20, v72
    v_lshlrev_b32 v178, 16, v73
    v_and_b32 v179, s20, v73
    s_waitcnt lgkmcnt(0)
    s_barrier
    v_mfma_f32_16x16x32_bf16 v[140:143], v[80:83], v[76:79], v[140:143]
    ds_read_b128 v[20:23], v232 offset:0
    ds_read_b64_tr_b16 v[16:17], v230 offset:0
    v_mfma_f32_16x16x32_bf16 v[144:147], v[84:87], v[76:79], v[144:147]
    ds_read_b64_tr_b16 v[18:19], v230 offset:512
    ds_read_b128 v[24:27], v232 offset:2048
    v_mfma_f32_16x16x32_bf16 v[148:151], v[88:91], v[76:79], v[148:151]
    ds_read_b128 v[28:31], v232 offset:4096
    ds_read_b128 v[32:35], v232 offset:6144
    v_mfma_f32_16x16x32_bf16 v[152:155], v[92:95], v[76:79], v[152:155]
    ds_read_b128 v[36:39], v232 offset:8192
    ds_read_b128 v[44:47], v233 offset:0
    v_mfma_f32_16x16x32_bf16 v[156:159], v[96:99], v[76:79], v[156:159]
    ds_read_b64_tr_b16 v[40:41], v230 offset:4096
    ds_read_b64_tr_b16 v[42:43], v230 offset:4608
    v_mfma_f32_16x16x32_bf16 v[140:143], v[104:107], v[100:103], v[140:143]
    ds_read_b128 v[48:51], v233 offset:2048
    ds_read_b128 v[52:55], v233 offset:4096
    v_mfma_f32_16x16x32_bf16 v[144:147], v[108:111], v[100:103], v[144:147]
    ds_read_b128 v[56:59], v233 offset:6144
    ds_read_b128 v[60:63], v233 offset:8192
    v_mfma_f32_16x16x32_bf16 v[148:151], v[112:115], v[100:103], v[148:151]
    v_mfma_f32_16x16x32_bf16 v[152:155], v[116:119], v[100:103], v[152:155]
    v_mfma_f32_16x16x32_bf16 v[156:159], v[120:123], v[100:103], v[156:159]
    s_waitcnt lgkmcnt(0)
    v_mfma_f32_16x16x32_bf16 v[140:143], v[20:23], v[16:19], v[140:143]
    ds_read_b128 v[80:83], v232 offset:18432
    ds_read_b64_tr_b16 v[76:77], v230 offset:18432
    v_mfma_f32_16x16x32_bf16 v[144:147], v[24:27], v[16:19], v[144:147]
    ds_read_b64_tr_b16 v[78:79], v230 offset:18944
    ds_read_b128 v[84:87], v232 offset:20480
    v_mfma_f32_16x16x32_bf16 v[148:151], v[28:31], v[16:19], v[148:151]
    ds_read_b128 v[88:91], v232 offset:22528
    ds_read_b128 v[92:95], v232 offset:24576
    v_mfma_f32_16x16x32_bf16 v[152:155], v[32:35], v[16:19], v[152:155]
    ds_read_b128 v[96:99], v232 offset:26624
    ds_read_b128 v[104:107], v233 offset:18432
    v_mfma_f32_16x16x32_bf16 v[156:159], v[36:39], v[16:19], v[156:159]
    ds_read_b64_tr_b16 v[100:101], v230 offset:22528
    ds_read_b64_tr_b16 v[102:103], v230 offset:23040
    v_mfma_f32_16x16x32_bf16 v[140:143], v[44:47], v[40:43], v[140:143]
    ds_read_b128 v[108:111], v233 offset:20480
    ds_read_b128 v[112:115], v233 offset:22528
    v_mfma_f32_16x16x32_bf16 v[144:147], v[48:51], v[40:43], v[144:147]
    ds_read_b128 v[116:119], v233 offset:24576
    ds_read_b128 v[120:123], v233 offset:26624
    v_mfma_f32_16x16x32_bf16 v[148:151], v[52:55], v[40:43], v[148:151]
    v_mfma_f32_16x16x32_bf16 v[152:155], v[56:59], v[40:43], v[152:155]
    v_mfma_f32_16x16x32_bf16 v[156:159], v[60:63], v[40:43], v[156:159]
    s_waitcnt lgkmcnt(0)
    s_barrier
    v_mfma_f32_16x16x32_bf16 v[140:143], v[80:83], v[76:79], v[140:143]
    ds_read_b128 v[20:23], v238 offset:0
    ds_read_b64_tr_b16 v[16:17], v236 offset:0
    v_mfma_f32_16x16x32_bf16 v[144:147], v[84:87], v[76:79], v[144:147]
    ds_read_b64_tr_b16 v[18:19], v236 offset:512
    ds_read_b128 v[24:27], v238 offset:2048
    v_mfma_f32_16x16x32_bf16 v[148:151], v[88:91], v[76:79], v[148:151]
    ds_read_b128 v[28:31], v238 offset:4096
    ds_read_b128 v[32:35], v238 offset:6144
    v_mfma_f32_16x16x32_bf16 v[152:155], v[92:95], v[76:79], v[152:155]
    ds_read_b128 v[36:39], v238 offset:8192
    ds_read_b128 v[44:47], v239 offset:0
    v_mfma_f32_16x16x32_bf16 v[156:159], v[96:99], v[76:79], v[156:159]
    ds_read_b64_tr_b16 v[40:41], v236 offset:4096
    ds_read_b64_tr_b16 v[42:43], v236 offset:4608
    v_mfma_f32_16x16x32_bf16 v[140:143], v[104:107], v[100:103], v[140:143]
    ds_read_b128 v[48:51], v239 offset:2048
    ds_read_b128 v[52:55], v239 offset:4096
    v_mfma_f32_16x16x32_bf16 v[144:147], v[108:111], v[100:103], v[144:147]
    ds_read_b128 v[56:59], v239 offset:6144
    ds_read_b128 v[60:63], v239 offset:8192
    v_mfma_f32_16x16x32_bf16 v[148:151], v[112:115], v[100:103], v[148:151]
    v_mfma_f32_16x16x32_bf16 v[152:155], v[116:119], v[100:103], v[152:155]
    v_mfma_f32_16x16x32_bf16 v[156:159], v[120:123], v[100:103], v[156:159]
    s_waitcnt lgkmcnt(0)
    v_mfma_f32_16x16x32_bf16 v[140:143], v[20:23], v[16:19], v[140:143]
    ds_read_b128 v[80:83], v238 offset:18432
    ds_read_b64_tr_b16 v[76:77], v236 offset:18432
    v_mfma_f32_16x16x32_bf16 v[144:147], v[24:27], v[16:19], v[144:147]
    ds_read_b64_tr_b16 v[78:79], v236 offset:18944
    ds_read_b128 v[84:87], v238 offset:20480
    v_mfma_f32_16x16x32_bf16 v[148:151], v[28:31], v[16:19], v[148:151]
    ds_read_b128 v[88:91], v238 offset:22528
    ds_read_b128 v[92:95], v238 offset:24576
    v_mfma_f32_16x16x32_bf16 v[152:155], v[32:35], v[16:19], v[152:155]
    ds_read_b128 v[96:99], v238 offset:26624
    ds_read_b128 v[104:107], v239 offset:18432
    v_mfma_f32_16x16x32_bf16 v[156:159], v[36:39], v[16:19], v[156:159]
    ds_read_b64_tr_b16 v[100:101], v236 offset:22528
    ds_read_b64_tr_b16 v[102:103], v236 offset:23040
    v_mfma_f32_16x16x32_bf16 v[140:143], v[44:47], v[40:43], v[140:143]
    ds_read_b128 v[108:111], v239 offset:20480
    ds_read_b128 v[112:115], v239 offset:22528
    v_mfma_f32_16x16x32_bf16 v[144:147], v[48:51], v[40:43], v[144:147]
    ds_read_b128 v[116:119], v239 offset:24576
    ds_read_b128 v[120:123], v239 offset:26624
    v_mfma_f32_16x16x32_bf16 v[148:151], v[52:55], v[40:43], v[148:151]
    v_mfma_f32_16x16x32_bf16 v[152:155], v[56:59], v[40:43], v[152:155]
    v_mfma_f32_16x16x32_bf16 v[156:159], v[60:63], v[40:43], v[156:159]
    s_waitcnt lgkmcnt(0)
    s_barrier
    v_mfma_f32_16x16x32_bf16 v[140:143], v[80:83], v[76:79], v[140:143]
    ds_read_b128 v[20:23], v244 offset:0
    ds_read_b64_tr_b16 v[16:17], v242 offset:0
    v_mfma_f32_16x16x32_bf16 v[144:147], v[84:87], v[76:79], v[144:147]
    ds_read_b64_tr_b16 v[18:19], v242 offset:512
    ds_read_b128 v[24:27], v244 offset:2048
    v_mfma_f32_16x16x32_bf16 v[148:151], v[88:91], v[76:79], v[148:151]
    ds_read_b128 v[28:31], v244 offset:4096
    ds_read_b128 v[32:35], v244 offset:6144
    v_mfma_f32_16x16x32_bf16 v[152:155], v[92:95], v[76:79], v[152:155]
    ds_read_b128 v[36:39], v244 offset:8192
    ds_read_b128 v[44:47], v245 offset:0
    v_mfma_f32_16x16x32_bf16 v[156:159], v[96:99], v[76:79], v[156:159]
    ds_read_b64_tr_b16 v[40:41], v242 offset:4096
    ds_read_b64_tr_b16 v[42:43], v242 offset:4608
    v_mfma_f32_16x16x32_bf16 v[140:143], v[104:107], v[100:103], v[140:143]
    ds_read_b128 v[48:51], v245 offset:2048
    ds_read_b128 v[52:55], v245 offset:4096
    v_mfma_f32_16x16x32_bf16 v[144:147], v[108:111], v[100:103], v[144:147]
    ds_read_b128 v[56:59], v245 offset:6144
    ds_read_b128 v[60:63], v245 offset:8192
    v_mfma_f32_16x16x32_bf16 v[148:151], v[112:115], v[100:103], v[148:151]
    v_mfma_f32_16x16x32_bf16 v[152:155], v[116:119], v[100:103], v[152:155]
    v_mfma_f32_16x16x32_bf16 v[156:159], v[120:123], v[100:103], v[156:159]
    s_waitcnt lgkmcnt(0)
    v_mfma_f32_16x16x32_bf16 v[140:143], v[20:23], v[16:19], v[140:143]
    ds_read_b128 v[80:83], v244 offset:18432
    ds_read_b64_tr_b16 v[76:77], v242 offset:18432
    v_mfma_f32_16x16x32_bf16 v[144:147], v[24:27], v[16:19], v[144:147]
    ds_read_b64_tr_b16 v[78:79], v242 offset:18944
    ds_read_b128 v[84:87], v244 offset:20480
    v_mfma_f32_16x16x32_bf16 v[148:151], v[28:31], v[16:19], v[148:151]
    ds_read_b128 v[88:91], v244 offset:22528
    ds_read_b128 v[92:95], v244 offset:24576
    v_mfma_f32_16x16x32_bf16 v[152:155], v[32:35], v[16:19], v[152:155]
    ds_read_b128 v[96:99], v244 offset:26624
    ds_read_b128 v[104:107], v245 offset:18432
    v_mfma_f32_16x16x32_bf16 v[156:159], v[36:39], v[16:19], v[156:159]
    ds_read_b64_tr_b16 v[100:101], v242 offset:22528
    ds_read_b64_tr_b16 v[102:103], v242 offset:23040
    v_mfma_f32_16x16x32_bf16 v[140:143], v[44:47], v[40:43], v[140:143]
    ds_read_b128 v[108:111], v245 offset:20480
    ds_read_b128 v[112:115], v245 offset:22528
    v_mfma_f32_16x16x32_bf16 v[144:147], v[48:51], v[40:43], v[144:147]
    ds_read_b128 v[116:119], v245 offset:24576
    ds_read_b128 v[120:123], v245 offset:26624
    v_mfma_f32_16x16x32_bf16 v[148:151], v[52:55], v[40:43], v[148:151]
    v_mfma_f32_16x16x32_bf16 v[152:155], v[56:59], v[40:43], v[152:155]
    v_mfma_f32_16x16x32_bf16 v[156:159], v[60:63], v[40:43], v[156:159]
    s_waitcnt lgkmcnt(0)
    s_barrier
    v_mfma_f32_16x16x32_bf16 v[140:143], v[80:83], v[76:79], v[140:143]
    ds_read_b128 v[20:23], v250 offset:0
    ds_read_b64_tr_b16 v[16:17], v248 offset:0
    v_mfma_f32_16x16x32_bf16 v[144:147], v[84:87], v[76:79], v[144:147]
    ds_read_b64_tr_b16 v[18:19], v248 offset:512
    ds_read_b128 v[24:27], v250 offset:2048
    v_mfma_f32_16x16x32_bf16 v[148:151], v[88:91], v[76:79], v[148:151]
    ds_read_b128 v[28:31], v250 offset:4096
    ds_read_b128 v[32:35], v250 offset:6144
    v_mfma_f32_16x16x32_bf16 v[152:155], v[92:95], v[76:79], v[152:155]
    ds_read_b128 v[36:39], v250 offset:8192
    ds_read_b128 v[44:47], v251 offset:0
    v_mfma_f32_16x16x32_bf16 v[156:159], v[96:99], v[76:79], v[156:159]
    ds_read_b64_tr_b16 v[40:41], v248 offset:4096
    ds_read_b64_tr_b16 v[42:43], v248 offset:4608
    v_mfma_f32_16x16x32_bf16 v[140:143], v[104:107], v[100:103], v[140:143]
    ds_read_b128 v[48:51], v251 offset:2048
    ds_read_b128 v[52:55], v251 offset:4096
    v_mfma_f32_16x16x32_bf16 v[144:147], v[108:111], v[100:103], v[144:147]
    ds_read_b128 v[56:59], v251 offset:6144
    ds_read_b128 v[60:63], v251 offset:8192
    v_mfma_f32_16x16x32_bf16 v[148:151], v[112:115], v[100:103], v[148:151]
    v_mfma_f32_16x16x32_bf16 v[152:155], v[116:119], v[100:103], v[152:155]
    v_mfma_f32_16x16x32_bf16 v[156:159], v[120:123], v[100:103], v[156:159]
    s_waitcnt lgkmcnt(0)
    v_mfma_f32_16x16x32_bf16 v[140:143], v[20:23], v[16:19], v[140:143]
    ds_read_b128 v[80:83], v250 offset:18432
    ds_read_b64_tr_b16 v[76:77], v248 offset:18432
    v_mfma_f32_16x16x32_bf16 v[144:147], v[24:27], v[16:19], v[144:147]
    ds_read_b64_tr_b16 v[78:79], v248 offset:18944
    ds_read_b128 v[84:87], v250 offset:20480
    v_mfma_f32_16x16x32_bf16 v[148:151], v[28:31], v[16:19], v[148:151]
    ds_read_b128 v[88:91], v250 offset:22528
    ds_read_b128 v[92:95], v250 offset:24576
    v_mfma_f32_16x16x32_bf16 v[152:155], v[32:35], v[16:19], v[152:155]
    ds_read_b128 v[96:99], v250 offset:26624
    ds_read_b128 v[104:107], v251 offset:18432
    v_mfma_f32_16x16x32_bf16 v[156:159], v[36:39], v[16:19], v[156:159]
    ds_read_b64_tr_b16 v[100:101], v248 offset:22528
    ds_read_b64_tr_b16 v[102:103], v248 offset:23040
    v_mfma_f32_16x16x32_bf16 v[140:143], v[44:47], v[40:43], v[140:143]
    ds_read_b128 v[108:111], v251 offset:20480
    ds_read_b128 v[112:115], v251 offset:22528
    v_mfma_f32_16x16x32_bf16 v[144:147], v[48:51], v[40:43], v[144:147]
    ds_read_b128 v[116:119], v251 offset:24576
    ds_read_b128 v[120:123], v251 offset:26624
    v_mfma_f32_16x16x32_bf16 v[148:151], v[52:55], v[40:43], v[148:151]
    v_mfma_f32_16x16x32_bf16 v[152:155], v[56:59], v[40:43], v[152:155]
    v_mfma_f32_16x16x32_bf16 v[156:159], v[60:63], v[40:43], v[156:159]
    s_waitcnt lgkmcnt(0)
    s_barrier
    v_mfma_f32_16x16x32_bf16 v[140:143], v[80:83], v[76:79], v[140:143]
    ds_read_b128 v[20:23], v232 offset:0
    ds_read_b64_tr_b16 v[16:17], v230 offset:0
    v_mfma_f32_16x16x32_bf16 v[144:147], v[84:87], v[76:79], v[144:147]
    ds_read_b64_tr_b16 v[18:19], v230 offset:512
    ds_read_b128 v[24:27], v232 offset:2048
    v_mfma_f32_16x16x32_bf16 v[148:151], v[88:91], v[76:79], v[148:151]
    ds_read_b128 v[28:31], v232 offset:4096
    ds_read_b128 v[32:35], v232 offset:6144
    v_mfma_f32_16x16x32_bf16 v[152:155], v[92:95], v[76:79], v[152:155]
    ds_read_b128 v[36:39], v232 offset:8192
    ds_read_b128 v[44:47], v233 offset:0
    v_mfma_f32_16x16x32_bf16 v[156:159], v[96:99], v[76:79], v[156:159]
    ds_read_b64_tr_b16 v[40:41], v230 offset:4096
    ds_read_b64_tr_b16 v[42:43], v230 offset:4608
    v_mfma_f32_16x16x32_bf16 v[140:143], v[104:107], v[100:103], v[140:143]
    ds_read_b128 v[48:51], v233 offset:2048
    ds_read_b128 v[52:55], v233 offset:4096
    v_mfma_f32_16x16x32_bf16 v[144:147], v[108:111], v[100:103], v[144:147]
    ds_read_b128 v[56:59], v233 offset:6144
    ds_read_b128 v[60:63], v233 offset:8192
    v_mfma_f32_16x16x32_bf16 v[148:151], v[112:115], v[100:103], v[148:151]
    v_mfma_f32_16x16x32_bf16 v[152:155], v[116:119], v[100:103], v[152:155]
    v_mfma_f32_16x16x32_bf16 v[156:159], v[120:123], v[100:103], v[156:159]
    s_waitcnt lgkmcnt(0)
    v_mfma_f32_16x16x32_bf16 v[140:143], v[20:23], v[16:19], v[140:143]
    ds_read_b128 v[80:83], v232 offset:18432
    ds_read_b64_tr_b16 v[76:77], v230 offset:18432
    v_mfma_f32_16x16x32_bf16 v[144:147], v[24:27], v[16:19], v[144:147]
    ds_read_b64_tr_b16 v[78:79], v230 offset:18944
    ds_read_b128 v[84:87], v232 offset:20480
    v_mfma_f32_16x16x32_bf16 v[148:151], v[28:31], v[16:19], v[148:151]
    ds_read_b128 v[88:91], v232 offset:22528
    ds_read_b128 v[92:95], v232 offset:24576
    v_mfma_f32_16x16x32_bf16 v[152:155], v[32:35], v[16:19], v[152:155]
    ds_read_b128 v[96:99], v232 offset:26624
    ds_read_b128 v[104:107], v233 offset:18432
    v_mfma_f32_16x16x32_bf16 v[156:159], v[36:39], v[16:19], v[156:159]
    ds_read_b64_tr_b16 v[100:101], v230 offset:22528
    ds_read_b64_tr_b16 v[102:103], v230 offset:23040
    v_mfma_f32_16x16x32_bf16 v[140:143], v[44:47], v[40:43], v[140:143]
    ds_read_b128 v[108:111], v233 offset:20480
    ds_read_b128 v[112:115], v233 offset:22528
    v_mfma_f32_16x16x32_bf16 v[144:147], v[48:51], v[40:43], v[144:147]
    ds_read_b128 v[116:119], v233 offset:24576
    ds_read_b128 v[120:123], v233 offset:26624
    v_mfma_f32_16x16x32_bf16 v[148:151], v[52:55], v[40:43], v[148:151]
    v_mfma_f32_16x16x32_bf16 v[152:155], v[56:59], v[40:43], v[152:155]
    v_mfma_f32_16x16x32_bf16 v[156:159], v[60:63], v[40:43], v[156:159]
    s_waitcnt lgkmcnt(0)
    s_barrier
    v_mfma_f32_16x16x32_bf16 v[140:143], v[80:83], v[76:79], v[140:143]
    ds_read_b128 v[20:23], v238 offset:0
    ds_read_b64_tr_b16 v[16:17], v236 offset:0
    v_mfma_f32_16x16x32_bf16 v[144:147], v[84:87], v[76:79], v[144:147]
    ds_read_b64_tr_b16 v[18:19], v236 offset:512
    ds_read_b128 v[24:27], v238 offset:2048
    v_mfma_f32_16x16x32_bf16 v[148:151], v[88:91], v[76:79], v[148:151]
    ds_read_b128 v[28:31], v238 offset:4096
    ds_read_b128 v[32:35], v238 offset:6144
    v_mfma_f32_16x16x32_bf16 v[152:155], v[92:95], v[76:79], v[152:155]
    ds_read_b128 v[36:39], v238 offset:8192
    ds_read_b128 v[44:47], v239 offset:0
    v_mfma_f32_16x16x32_bf16 v[156:159], v[96:99], v[76:79], v[156:159]
    ds_read_b64_tr_b16 v[40:41], v236 offset:4096
    ds_read_b64_tr_b16 v[42:43], v236 offset:4608
    v_mfma_f32_16x16x32_bf16 v[140:143], v[104:107], v[100:103], v[140:143]
    ds_read_b128 v[48:51], v239 offset:2048
    ds_read_b128 v[52:55], v239 offset:4096
    v_mfma_f32_16x16x32_bf16 v[144:147], v[108:111], v[100:103], v[144:147]
    ds_read_b128 v[56:59], v239 offset:6144
    ds_read_b128 v[60:63], v239 offset:8192
    v_mfma_f32_16x16x32_bf16 v[148:151], v[112:115], v[100:103], v[148:151]
    v_mfma_f32_16x16x32_bf16 v[152:155], v[116:119], v[100:103], v[152:155]
    v_mfma_f32_16x16x32_bf16 v[156:159], v[120:123], v[100:103], v[156:159]
    s_waitcnt lgkmcnt(0)
    v_mfma_f32_16x16x32_bf16 v[140:143], v[20:23], v[16:19], v[140:143]
    ds_read_b128 v[80:83], v238 offset:18432
    ds_read_b64_tr_b16 v[76:77], v236 offset:18432
    v_mfma_f32_16x16x32_bf16 v[144:147], v[24:27], v[16:19], v[144:147]
    ds_read_b64_tr_b16 v[78:79], v236 offset:18944
    ds_read_b128 v[84:87], v238 offset:20480
    v_mfma_f32_16x16x32_bf16 v[148:151], v[28:31], v[16:19], v[148:151]
    ds_read_b128 v[88:91], v238 offset:22528
    ds_read_b128 v[92:95], v238 offset:24576
    v_mfma_f32_16x16x32_bf16 v[152:155], v[32:35], v[16:19], v[152:155]
    ds_read_b128 v[96:99], v238 offset:26624
    ds_read_b128 v[104:107], v239 offset:18432
    v_mfma_f32_16x16x32_bf16 v[156:159], v[36:39], v[16:19], v[156:159]
    ds_read_b64_tr_b16 v[100:101], v236 offset:22528
    ds_read_b64_tr_b16 v[102:103], v236 offset:23040
    v_mfma_f32_16x16x32_bf16 v[140:143], v[44:47], v[40:43], v[140:143]
    ds_read_b128 v[108:111], v239 offset:20480
    ds_read_b128 v[112:115], v239 offset:22528
    v_mfma_f32_16x16x32_bf16 v[144:147], v[48:51], v[40:43], v[144:147]
    ds_read_b128 v[116:119], v239 offset:24576
    ds_read_b128 v[120:123], v239 offset:26624
    v_mfma_f32_16x16x32_bf16 v[148:151], v[52:55], v[40:43], v[148:151]
    v_mfma_f32_16x16x32_bf16 v[152:155], v[56:59], v[40:43], v[152:155]
    v_mfma_f32_16x16x32_bf16 v[156:159], v[60:63], v[40:43], v[156:159]
    s_waitcnt lgkmcnt(0)
    s_barrier
    v_mfma_f32_16x16x32_bf16 v[140:143], v[80:83], v[76:79], v[140:143]
    ds_read_b64 v[64:65], v10 offset:10240
    ds_read_b64 v[66:67], v10 offset:10272
    v_mfma_f32_16x16x32_bf16 v[144:147], v[84:87], v[76:79], v[144:147]
    ds_read_b64 v[68:69], v10 offset:10304
    ds_read_b64 v[70:71], v10 offset:10336
    v_mfma_f32_16x16x32_bf16 v[148:151], v[88:91], v[76:79], v[148:151]
    ds_read_b64 v[72:73], v10 offset:10368
    ds_read_b64 v[200:201], v10 offset:0
    v_mfma_f32_16x16x32_bf16 v[152:155], v[92:95], v[76:79], v[152:155]
    ds_read_b64 v[202:203], v10 offset:32
    ds_read_b64 v[204:205], v10 offset:64
    v_mfma_f32_16x16x32_bf16 v[156:159], v[96:99], v[76:79], v[156:159]
    ds_read_b64 v[206:207], v10 offset:96
    ds_read_b64 v[208:209], v10 offset:128
    v_mfma_f32_16x16x32_bf16 v[140:143], v[104:107], v[100:103], v[140:143]
    s_waitcnt lgkmcnt(0)
    v_lshlrev_b32 v180, 16, v64
    v_mfma_f32_16x16x32_bf16 v[144:147], v[108:111], v[100:103], v[144:147]
    v_and_b32 v181, s20, v64
    v_lshlrev_b32 v182, 16, v65
    v_mfma_f32_16x16x32_bf16 v[148:151], v[112:115], v[100:103], v[148:151]
    v_and_b32 v183, s20, v65
    v_lshlrev_b32 v184, 16, v66
    v_mfma_f32_16x16x32_bf16 v[152:155], v[116:119], v[100:103], v[152:155]
    v_and_b32 v185, s20, v66
    v_lshlrev_b32 v186, 16, v67
    v_mfma_f32_16x16x32_bf16 v[156:159], v[120:123], v[100:103], v[156:159]
    v_and_b32 v187, s20, v67
    v_lshlrev_b32 v188, 16, v68
    v_and_b32 v189, s20, v68
    v_lshlrev_b32 v190, 16, v69
    v_and_b32 v191, s20, v69
    v_lshlrev_b32 v192, 16, v70
    v_and_b32 v193, s20, v70
    v_lshlrev_b32 v194, 16, v71
    v_and_b32 v195, s20, v71
    v_lshlrev_b32 v196, 16, v72
    v_and_b32 v197, s20, v72
    v_lshlrev_b32 v198, 16, v73
    v_and_b32 v199, s20, v73
    v_pk_mul_f32 v[180:181], v[180:181], v[124:125]
    v_pk_mul_f32 v[182:183], v[182:183], v[126:127]
    v_pk_mul_f32 v[184:185], v[184:185], v[128:129]
    v_pk_mul_f32 v[186:187], v[186:187], v[130:131]
    v_pk_mul_f32 v[188:189], v[188:189], v[132:133]
    v_pk_mul_f32 v[190:191], v[190:191], v[134:135]
    v_pk_mul_f32 v[192:193], v[192:193], v[136:137]
    v_pk_mul_f32 v[194:195], v[194:195], v[138:139]
    v_pk_mul_f32 v[196:197], v[196:197], v[220:221]
    v_pk_mul_f32 v[198:199], v[198:199], v[222:223]
    v_cvt_pk_bf16_f32 v64, v180, v181
    v_cvt_pk_bf16_f32 v65, v182, v183
    v_cvt_pk_bf16_f32 v66, v184, v185
    v_cvt_pk_bf16_f32 v67, v186, v187
    v_cvt_pk_bf16_f32 v68, v188, v189
    v_cvt_pk_bf16_f32 v69, v190, v191
    v_cvt_pk_bf16_f32 v70, v192, v193
    v_cvt_pk_bf16_f32 v71, v194, v195
    v_cvt_pk_bf16_f32 v72, v196, v197
    v_cvt_pk_bf16_f32 v73, v198, v199
    v_lshlrev_b32 v180, 16, v64
    v_and_b32 v181, s20, v64
    v_lshlrev_b32 v182, 16, v65
    v_and_b32 v183, s20, v65
    v_lshlrev_b32 v184, 16, v66
    v_and_b32 v185, s20, v66
    v_lshlrev_b32 v186, 16, v67
    v_and_b32 v187, s20, v67
    v_lshlrev_b32 v188, 16, v68
    v_and_b32 v189, s20, v68
    v_lshlrev_b32 v190, 16, v69
    v_and_b32 v191, s20, v69
    v_lshlrev_b32 v192, 16, v70
    v_and_b32 v193, s20, v70
    v_lshlrev_b32 v194, 16, v71
    v_and_b32 v195, s20, v71
    v_lshlrev_b32 v196, 16, v72
    v_and_b32 v197, s20, v72
    v_lshlrev_b32 v198, 16, v73
    v_and_b32 v199, s20, v73
    v_and_b32 v219, s20, v209
    v_lshlrev_b32 v218, 16, v209
    v_and_b32 v217, s20, v208
    v_lshlrev_b32 v216, 16, v208
    v_and_b32 v215, s20, v207
    v_lshlrev_b32 v214, 16, v207
    v_and_b32 v213, s20, v206
    v_lshlrev_b32 v212, 16, v206
    v_and_b32 v211, s20, v205
    v_lshlrev_b32 v210, 16, v205
    v_and_b32 v209, s20, v204
    v_lshlrev_b32 v208, 16, v204
    v_and_b32 v207, s20, v203
    v_lshlrev_b32 v206, 16, v203
    v_and_b32 v205, s20, v202
    v_lshlrev_b32 v204, 16, v202
    v_and_b32 v203, s20, v201
    v_lshlrev_b32 v202, 16, v201
    v_and_b32 v201, s20, v200
    v_lshlrev_b32 v200, 16, v200
    s_nop 7
    v_pk_fma_f32 v[140:141], v[140:141], 2.0, v[180:181]
    v_pk_fma_f32 v[142:143], v[142:143], 2.0, v[182:183]
    v_pk_fma_f32 v[144:145], v[144:145], 2.0, v[184:185]
    v_pk_fma_f32 v[146:147], v[146:147], 2.0, v[186:187]
    v_pk_fma_f32 v[148:149], v[148:149], 2.0, v[188:189]
    v_pk_fma_f32 v[150:151], v[150:151], 2.0, v[190:191]
    v_pk_fma_f32 v[152:153], v[152:153], 2.0, v[192:193]
    v_pk_fma_f32 v[154:155], v[154:155], 2.0, v[194:195]
    v_pk_fma_f32 v[156:157], v[156:157], 2.0, v[196:197]
    v_pk_fma_f32 v[158:159], v[158:159], 2.0, v[198:199]
    v_pk_mul_f32 v[140:141], v[140:141], v[160:161]
    v_pk_mul_f32 v[142:143], v[142:143], v[162:163]
    v_pk_mul_f32 v[144:145], v[144:145], v[164:165]
    v_pk_mul_f32 v[146:147], v[146:147], v[166:167]
    v_pk_mul_f32 v[148:149], v[148:149], v[168:169]
    v_pk_mul_f32 v[150:151], v[150:151], v[170:171]
    v_pk_mul_f32 v[152:153], v[152:153], v[172:173]
    v_pk_mul_f32 v[154:155], v[154:155], v[174:175]
    v_pk_mul_f32 v[156:157], v[156:157], v[176:177]
    v_pk_mul_f32 v[158:159], v[158:159], v[178:179]
    v_pk_add_f32 v[140:141], v[140:141], v[200:201]
    v_pk_add_f32 v[142:143], v[142:143], v[202:203]
    v_pk_add_f32 v[144:145], v[144:145], v[204:205]
    v_pk_add_f32 v[146:147], v[146:147], v[206:207]
    v_pk_add_f32 v[148:149], v[148:149], v[208:209]
    v_pk_add_f32 v[150:151], v[150:151], v[210:211]
    v_pk_add_f32 v[152:153], v[152:153], v[212:213]
    v_pk_add_f32 v[154:155], v[154:155], v[214:215]
    v_pk_add_f32 v[156:157], v[156:157], v[216:217]
    v_pk_add_f32 v[158:159], v[158:159], v[218:219]
    buffer_store_dwordx4 v[140:143], v15, s[80:83], s27 offen offset:0 nt
    buffer_store_dwordx4 v[144:147], v15, s[80:83], s27 offen offset:64 nt
    buffer_store_dwordx4 v[148:151], v15, s[80:83], s27 offen offset:128 nt
    buffer_store_dwordx4 v[152:155], v15, s[80:83], s27 offen offset:192 nt
    buffer_store_dwordx4 v[156:159], v15, s[80:83], s27 offen offset:256 nt
    s_endpgm
U_ld_2:
    v_mov_b32 v15, 147456
    v_mov_b32 v24, 0
    v_mov_b32 v25, 0
    v_mov_b32 v26, 0
    v_mov_b32 v27, 0
    ds_write_b128 v15, v[24:27]
    ds_write_b128 v15, v[24:27] offset:16
    s_waitcnt lgkmcnt(0)
    s_barrier
    s_cmp_lg_u32 s17, 0
    s_cbranch_scc1 U_lp0a
    s_cmp_lg_u32 s2, 0
    s_cbranch_scc1 U_noinit_16
    v_lshlrev_b32 v18, 8, v1
    v_add_u32 v18, 4096, v18
    s_movk_i32 s24, 16384
    buffer_store_dword v17, v18, s[76:79], 0 offen sc1
    buffer_store_dword v17, v18, s[76:79], s24 offen sc1
    s_waitcnt vmcnt(0)
    v_mov_b32 v18, 1
    buffer_store_dword v18, v17, s[92:95], 0 offen offset:8 sc1
U_noinit_16:
    s_sleep 12
    s_mov_b32 s31, 0x100000
U_nq_17:
    buffer_load_dwordx2 v[20:21], v17, s[92:95], 0 offen sc1
    s_waitcnt vmcnt(0)
    v_readfirstlane_b32 s30, v20
    s_nop 3
    s_cmp_lg_u32 s30, 0
    s_cbranch_scc1 U_nqd_18
    s_sleep 5
    s_sub_u32 s31, s31, 1
    s_cmp_lg_u32 s31, 0
    s_cbranch_scc1 U_nq_17
U_nqd_18:
    ds_write_b64 v15, v[20:21] offset:16
    s_mov_b32 s31, 0x1000000
U_ln_19:
    ds_read_b32 v18, v15 offset:0
    s_waitcnt lgkmcnt(0)
    v_readfirstlane_b32 s30, v18
    s_sub_u32 s31, s31, 1
    s_cbranch_scc1 U_lnd_20
    s_nop 1
    s_cmp_ge_u32 s30, 4
    s_cbranch_scc1 U_lnd_20
    s_sleep 2
    s_branch U_ln_19
U_lnd_20:
    s_sleep 8
    s_movk_i32 s24, 8
    s_mov_b32 s31, 0x100000
U_ini_poll_21:
    buffer_load_dword v18, v17, s[92:95], s24 offen sc1
    s_waitcnt vmcnt(0)
    v_readfirstlane_b32 s30, v18
    s_nop 3
    s_cmp_ge_u32 s30, 1
    s_cbranch_scc1 U_ini_done_22
    s_sleep 8
    s_sub_u32 s31, s31, 1
    s_cmp_lg_u32 s31, 0
    s_cbranch_scc1 U_ini_poll_21
U_ini_done_22:
    s_branch U_lp0d
U_lp0a:
    s_cmp_lt_u32 s17, 2
    s_cbranch_scc1 U_lp0d
    s_cmp_eq_u32 s17, 3
    s_cbranch_scc1 U_lp0c
    s_cmp_ge_u32 s2, 240
    s_cbranch_scc1 U_lp0d
    s_mul_hi_u32 s28, s2, 0xaaaaaab
    s_mul_i32 s29, s28, 24
    s_sub_u32 s29, s2, s29
    s_mul_i32 s22, s29, 81920
    s_lshl_b32 s23, s28, 7
    s_add_u32 s22, s22, s23
    v_lshrrev_b32 v18, 2, v3
    v_and_b32 v19, 3, v3
    v_lshlrev_b32 v18, 5, v18
    v_lshl_add_u32 v18, v19, 2, v18
    v_mul_u32_u24 v18, 1280, v18
    v_lshl_add_u32 v18, v2, 4, v18
    s_mov_b32 s72, s56
    s_and_b32 s73, s57, 0xffff
    s_mov_b32 s74, 0x1e0000
    s_mov_b32 s75, 0x00020000
    s_add_u32 s24, s22, 0
    buffer_load_dwordx4 v[180:183], v18, s[72:75], s24 offen
    s_add_u32 s24, s22, 1280
    buffer_load_dwordx4 v[184:187], v18, s[72:75], s24 offen
    s_add_u32 s24, s22, 2560
    buffer_load_dwordx4 v[188:191], v18, s[72:75], s24 offen
    s_add_u32 s24, s22, 3840
    buffer_load_dwordx4 v[192:195], v18, s[72:75], s24 offen
    s_add_u32 s24, s22, 20480
    buffer_load_dwordx4 v[196:199], v18, s[72:75], s24 offen
    s_add_u32 s24, s22, 21760
    buffer_load_dwordx4 v[200:203], v18, s[72:75], s24 offen
    s_add_u32 s24, s22, 23040
    buffer_load_dwordx4 v[204:207], v18, s[72:75], s24 offen
    s_add_u32 s24, s22, 24320
    buffer_load_dwordx4 v[208:211], v18, s[72:75], s24 offen
    v_mul_u32_u24 v11, 24576, v2
    v_lshl_add_u32 v11, v3, 4, v11
    s_mul_i32 s23, s28, 196608
    s_lshl_b32 s24, s29, 7
    s_add_u32 s23, s23, s24
    s_add_u32 s68, s10, 0x500000
    s_addc_u32 s69, s11, 0
    s_and_b32 s69, s69, 0xffff
    s_mov_b32 s70, 0x1e0000
    s_mov_b32 s71, 0x00020000
    s_mov_b32 s26, 0x05040100
    s_mov_b32 s27, 0x07060302
    s_waitcnt vmcnt(0)
    v_perm_b32 v212, v184, v180, s26
    v_perm_b32 v213, v192, v188, s26
    v_perm_b32 v214, v200, v196, s26
    v_perm_b32 v215, v208, v204, s26
    v_perm_b32 v216, v184, v180, s27
    v_perm_b32 v217, v192, v188, s27
    v_perm_b32 v218, v200, v196, s27
    v_perm_b32 v219, v208, v204, s27
    v_perm_b32 v220, v185, v181, s26
    v_perm_b32 v221, v193, v189, s26
    v_perm_b32 v222, v201, v197, s26
    v_perm_b32 v223, v209, v205, s26
    v_perm_b32 v224, v185, v181, s27
    v_perm_b32 v225, v193, v189, s27
    v_perm_b32 v226, v201, v197, s27
    v_perm_b32 v227, v209, v205, s27
    v_perm_b32 v228, v186, v182, s26
    v_perm_b32 v229, v194, v190, s26
    v_perm_b32 v230, v202, v198, s26
    v_perm_b32 v231, v210, v206, s26
    v_perm_b32 v232, v186, v182, s27
    v_perm_b32 v233, v194, v190, s27
    v_perm_b32 v234, v202, v198, s27
    v_perm_b32 v235, v210, v206, s27
    v_perm_b32 v236, v187, v183, s26
    v_perm_b32 v237, v195, v191, s26
    v_perm_b32 v238, v203, v199, s26
    v_perm_b32 v239, v211, v207, s26
    v_perm_b32 v240, v187, v183, s27
    v_perm_b32 v241, v195, v191, s27
    v_perm_b32 v242, v203, v199, s27
    v_perm_b32 v243, v211, v207, s27
    s_add_u32 s24, s23, 0
    buffer_store_dwordx4 v[212:215], v11, s[68:71], s24 offen sc1
    s_add_u32 s24, s23, 3072
    buffer_store_dwordx4 v[216:219], v11, s[68:71], s24 offen sc1
    s_add_u32 s24, s23, 6144
    buffer_store_dwordx4 v[220:223], v11, s[68:71], s24 offen sc1
    s_add_u32 s24, s23, 9216
    buffer_store_dwordx4 v[224:227], v11, s[68:71], s24 offen sc1
    s_add_u32 s24, s23, 12288
    buffer_store_dwordx4 v[228:231], v11, s[68:71], s24 offen sc1
    s_add_u32 s24, s23, 15360
    buffer_store_dwordx4 v[232:235], v11, s[68:71], s24 offen sc1
    s_add_u32 s24, s23, 18432
    buffer_store_dwordx4 v[236:239], v11, s[68:71], s24 offen sc1
    s_add_u32 s24, s23, 21504
    buffer_store_dwordx4 v[240:243], v11, s[68:71], s24 offen sc1
    s_branch U_lp0d
U_lp0c:
    s_mov_b32 s64, s34
    s_and_b32 s65, s35, 0xffff
    s_mov_b32 s66, 0x500
    s_mov_b32 s67, 0x00020000
    s_mov_b32 s68, s36
    s_and_b32 s69, s37, 0xffff
    s_mov_b32 s70, 0x500
    s_mov_b32 s71, 0x00020000
    s_mov_b32 s72, s46
    s_and_b32 s73, s47, 0xffff
    s_mov_b32 s74, 0x500
    s_mov_b32 s75, 0x00020000
    s_mul_i32 s20, s14, 80
    v_lshlrev_b32 v18, 1, v3
    buffer_load_ushort v160, v18, s[64:67], s20 offen offset:0
    buffer_load_ushort v161, v18, s[68:71], s20 offen offset:0
    buffer_load_ushort v162, v18, s[72:75], s20 offen offset:0
    buffer_load_ushort v163, v18, s[64:67], s20 offen offset:16
    buffer_load_ushort v164, v18, s[68:71], s20 offen offset:16
    buffer_load_ushort v165, v18, s[72:75], s20 offen offset:16
    buffer_load_ushort v166, v18, s[64:67], s20 offen offset:32
    buffer_load_ushort v167, v18, s[68:71], s20 offen offset:32
    buffer_load_ushort v168, v18, s[72:75], s20 offen offset:32
    buffer_load_ushort v169, v18, s[64:67], s20 offen offset:48
    buffer_load_ushort v170, v18, s[68:71], s20 offen offset:48
    buffer_load_ushort v171, v18, s[72:75], s20 offen offset:48
    buffer_load_ushort v172, v18, s[64:67], s20 offen offset:64
    buffer_load_ushort v173, v18, s[68:71], s20 offen offset:64
    buffer_load_ushort v174, v18, s[72:75], s20 offen offset:64
    v_and_b32 v12, 8, v7
    v_lshlrev_b32 v12, 28, v12
    v_xor_b32 v12, 0x80000000, v12
    v_lshlrev_b32 v13, 3, v6
    v_cvt_f32_u32 v13, v13
    v_mul_u32_u24 v10, 48, v7
    v_add_u32 v10, 149504, v10
    v_lshlrev_b32 v11, 3, v1
    v_add_u32 v11, 153600, v11
    s_waitcnt vmcnt(0)
    v_lshlrev_b32 v160, 16, v160
    v_lshlrev_b32 v161, 16, v161
    v_lshlrev_b32 v162, 16, v162
    v_mul_f32 v162, 0x3fb8aa3b, v162
    v_exp_f32 v162, v162
    s_nop 0
    v_cvt_pk_bf16_f32 v162, v162, v162
    v_and_b32 v162, 0xffff0000, v162
    v_mul_f32 v96, v162, v160
    v_mul_f32 v101, v162, v161
    v_mul_f32 v96, 0x3fb8aa3b, v96
    v_mul_f32 v101, 0.15915494, v101
    v_lshlrev_b32 v163, 16, v163
    v_lshlrev_b32 v164, 16, v164
    v_lshlrev_b32 v165, 16, v165
    v_mul_f32 v165, 0x3fb8aa3b, v165
    v_exp_f32 v165, v165
    s_nop 0
    v_cvt_pk_bf16_f32 v165, v165, v165
    v_and_b32 v165, 0xffff0000, v165
    v_mul_f32 v97, v165, v163
    v_mul_f32 v102, v165, v164
    v_mul_f32 v97, 0x3fb8aa3b, v97
    v_mul_f32 v102, 0.15915494, v102
    v_lshlrev_b32 v166, 16, v166
    v_lshlrev_b32 v167, 16, v167
    v_lshlrev_b32 v168, 16, v168
    v_mul_f32 v168, 0x3fb8aa3b, v168
    v_exp_f32 v168, v168
    s_nop 0
    v_cvt_pk_bf16_f32 v168, v168, v168
    v_and_b32 v168, 0xffff0000, v168
    v_mul_f32 v98, v168, v166
    v_mul_f32 v103, v168, v167
    v_mul_f32 v98, 0x3fb8aa3b, v98
    v_mul_f32 v103, 0.15915494, v103
    v_lshlrev_b32 v169, 16, v169
    v_lshlrev_b32 v170, 16, v170
    v_lshlrev_b32 v171, 16, v171
    v_mul_f32 v171, 0x3fb8aa3b, v171
    v_exp_f32 v171, v171
    s_nop 0
    v_cvt_pk_bf16_f32 v171, v171, v171
    v_and_b32 v171, 0xffff0000, v171
    v_mul_f32 v99, v171, v169
    v_mul_f32 v104, v171, v170
    v_mul_f32 v99, 0x3fb8aa3b, v99
    v_mul_f32 v104, 0.15915494, v104
    v_lshlrev_b32 v172, 16, v172
    v_lshlrev_b32 v173, 16, v173
    v_lshlrev_b32 v174, 16, v174
    v_mul_f32 v174, 0x3fb8aa3b, v174
    v_exp_f32 v174, v174
    s_nop 0
    v_cvt_pk_bf16_f32 v174, v174, v174
    v_and_b32 v174, 0xffff0000, v174
    v_mul_f32 v100, v174, v172
    v_mul_f32 v105, v174, v173
    v_mul_f32 v100, 0x3fb8aa3b, v100
    v_mul_f32 v105, 0.15915494, v105
    v_mul_f32 v108, 0x3f800000, v96
    v_mul_f32 v109, 0x3f800000, v101
    v_exp_f32 v108, v108
    v_fract_f32 v109, v109
    v_cos_f32 v110, v109
    v_sin_f32 v111, v109
    v_mul_f32 v112, 0x3f800000, v97
    v_mul_f32 v113, 0x3f800000, v102
    v_exp_f32 v112, v112
    v_fract_f32 v113, v113
    v_cos_f32 v114, v113
    v_sin_f32 v115, v113
    v_mul_f32 v116, 0x3f800000, v98
    v_mul_f32 v117, 0x3f800000, v103
    v_exp_f32 v116, v116
    v_fract_f32 v117, v117
    v_cos_f32 v118, v117
    v_sin_f32 v119, v117
    v_mul_f32 v120, 0x3f800000, v99
    v_mul_f32 v121, 0x3f800000, v104
    v_exp_f32 v120, v120
    v_fract_f32 v121, v121
    v_cos_f32 v122, v121
    v_sin_f32 v123, v121
    v_mul_f32 v124, 0x3f800000, v100
    v_mul_f32 v125, 0x3f800000, v105
    v_exp_f32 v124, v124
    v_fract_f32 v125, v125
    v_cos_f32 v126, v125
    v_sin_f32 v127, v125
    s_nop 0
    v_mul_f32 v180, v108, v110
    v_mul_f32 v181, v108, v111
    v_mul_f32 v192, v112, v114
    v_mul_f32 v193, v112, v115
    v_mul_f32 v204, v116, v118
    v_mul_f32 v205, v116, v119
    v_mul_f32 v216, v120, v122
    v_mul_f32 v217, v120, v123
    v_mul_f32 v228, v124, v126
    v_mul_f32 v229, v124, v127
    v_add_f32 v108, -1.0, v180
    v_mul_f32 v109, v160, v160
    v_fmac_f32 v109, v161, v161
    v_rcp_f32 v110, v109
    s_nop 0
    v_fma_f32 v111, -v109, v110, 1.0
    v_fma_f32 v110, v111, v110, v110
    v_mul_f32 v182, v108, v160
    v_fmac_f32 v182, v181, v161
    v_mul_f32 v183, v181, v160
    v_fma_f32 v183, -v108, v161, v183
    v_mul_f32 v182, v182, v110
    v_mul_f32 v183, v183, v110
    v_add_f32 v112, -1.0, v192
    v_mul_f32 v113, v163, v163
    v_fmac_f32 v113, v164, v164
    v_rcp_f32 v114, v113
    s_nop 0
    v_fma_f32 v115, -v113, v114, 1.0
    v_fma_f32 v114, v115, v114, v114
    v_mul_f32 v194, v112, v163
    v_fmac_f32 v194, v193, v164
    v_mul_f32 v195, v193, v163
    v_fma_f32 v195, -v112, v164, v195
    v_mul_f32 v194, v194, v114
    v_mul_f32 v195, v195, v114
    v_add_f32 v116, -1.0, v204
    v_mul_f32 v117, v166, v166
    v_fmac_f32 v117, v167, v167
    v_rcp_f32 v118, v117
    s_nop 0
    v_fma_f32 v119, -v117, v118, 1.0
    v_fma_f32 v118, v119, v118, v118
    v_mul_f32 v206, v116, v166
    v_fmac_f32 v206, v205, v167
    v_mul_f32 v207, v205, v166
    v_fma_f32 v207, -v116, v167, v207
    v_mul_f32 v206, v206, v118
    v_mul_f32 v207, v207, v118
    v_add_f32 v120, -1.0, v216
    v_mul_f32 v121, v169, v169
    v_fmac_f32 v121, v170, v170
    v_rcp_f32 v122, v121
    s_nop 0
    v_fma_f32 v123, -v121, v122, 1.0
    v_fma_f32 v122, v123, v122, v122
    v_mul_f32 v218, v120, v169
    v_fmac_f32 v218, v217, v170
    v_mul_f32 v219, v217, v169
    v_fma_f32 v219, -v120, v170, v219
    v_mul_f32 v218, v218, v122
    v_mul_f32 v219, v219, v122
    v_add_f32 v124, -1.0, v228
    v_mul_f32 v125, v172, v172
    v_fmac_f32 v125, v173, v173
    v_rcp_f32 v126, v125
    s_nop 0
    v_fma_f32 v127, -v125, v126, 1.0
    v_fma_f32 v126, v127, v126, v126
    v_mul_f32 v230, v124, v172
    v_fmac_f32 v230, v229, v173
    v_mul_f32 v231, v229, v172
    v_fma_f32 v231, -v124, v173, v231
    v_mul_f32 v230, v230, v126
    v_mul_f32 v231, v231, v126
    v_mul_f32 v108, 0x41000000, v96
    v_mul_f32 v109, 0x41000000, v101
    v_exp_f32 v108, v108
    v_fract_f32 v109, v109
    v_cos_f32 v110, v109
    v_sin_f32 v111, v109
    v_mul_f32 v112, 0x41000000, v97
    v_mul_f32 v113, 0x41000000, v102
    v_exp_f32 v112, v112
    v_fract_f32 v113, v113
    v_cos_f32 v114, v113
    v_sin_f32 v115, v113
    v_mul_f32 v116, 0x41000000, v98
    v_mul_f32 v117, 0x41000000, v103
    v_exp_f32 v116, v116
    v_fract_f32 v117, v117
    v_cos_f32 v118, v117
    v_sin_f32 v119, v117
    v_mul_f32 v120, 0x41000000, v99
    v_mul_f32 v121, 0x41000000, v104
    v_exp_f32 v120, v120
    v_fract_f32 v121, v121
    v_cos_f32 v122, v121
    v_sin_f32 v123, v121
    v_mul_f32 v124, 0x41000000, v100
    v_mul_f32 v125, 0x41000000, v105
    v_exp_f32 v124, v124
    v_fract_f32 v125, v125
    v_cos_f32 v126, v125
    v_sin_f32 v127, v125
    s_nop 0
    v_mul_f32 v184, v108, v110
    v_mul_f32 v185, v108, v111
    v_mul_f32 v196, v112, v114
    v_mul_f32 v197, v112, v115
    v_mul_f32 v208, v116, v118
    v_mul_f32 v209, v116, v119
    v_mul_f32 v220, v120, v122
    v_mul_f32 v221, v120, v123
    v_mul_f32 v232, v124, v126
    v_mul_f32 v233, v124, v127
    v_mul_f32 v108, 0x42000000, v96
    v_mul_f32 v109, 0x42000000, v101
    v_exp_f32 v108, v108
    v_fract_f32 v109, v109
    v_cos_f32 v110, v109
    v_sin_f32 v111, v109
    v_mul_f32 v112, 0x42000000, v97
    v_mul_f32 v113, 0x42000000, v102
    v_exp_f32 v112, v112
    v_fract_f32 v113, v113
    v_cos_f32 v114, v113
    v_sin_f32 v115, v113
    v_mul_f32 v116, 0x42000000, v98
    v_mul_f32 v117, 0x42000000, v103
    v_exp_f32 v116, v116
    v_fract_f32 v117, v117
    v_cos_f32 v118, v117
    v_sin_f32 v119, v117
    v_mul_f32 v120, 0x42000000, v99
    v_mul_f32 v121, 0x42000000, v104
    v_exp_f32 v120, v120
    v_fract_f32 v121, v121
    v_cos_f32 v122, v121
    v_sin_f32 v123, v121
    v_mul_f32 v124, 0x42000000, v100
    v_mul_f32 v125, 0x42000000, v105
    v_exp_f32 v124, v124
    v_fract_f32 v125, v125
    v_cos_f32 v126, v125
    v_sin_f32 v127, v125
    s_nop 0
    v_mul_f32 v186, v108, v110
    v_mul_f32 v187, v108, v111
    v_mul_f32 v198, v112, v114
    v_mul_f32 v199, v112, v115
    v_mul_f32 v210, v116, v118
    v_mul_f32 v211, v116, v119
    v_mul_f32 v222, v120, v122
    v_mul_f32 v223, v120, v123
    v_mul_f32 v234, v124, v126
    v_mul_f32 v235, v124, v127
    v_mul_f32 v108, 0x43000000, v96
    v_mul_f32 v109, 0x43000000, v101
    v_exp_f32 v108, v108
    v_fract_f32 v109, v109
    v_cos_f32 v110, v109
    v_sin_f32 v111, v109
    v_mul_f32 v112, 0x43000000, v97
    v_mul_f32 v113, 0x43000000, v102
    v_exp_f32 v112, v112
    v_fract_f32 v113, v113
    v_cos_f32 v114, v113
    v_sin_f32 v115, v113
    v_mul_f32 v116, 0x43000000, v98
    v_mul_f32 v117, 0x43000000, v103
    v_exp_f32 v116, v116
    v_fract_f32 v117, v117
    v_cos_f32 v118, v117
    v_sin_f32 v119, v117
    v_mul_f32 v120, 0x43000000, v99
    v_mul_f32 v121, 0x43000000, v104
    v_exp_f32 v120, v120
    v_fract_f32 v121, v121
    v_cos_f32 v122, v121
    v_sin_f32 v123, v121
    v_mul_f32 v124, 0x43000000, v100
    v_mul_f32 v125, 0x43000000, v105
    v_exp_f32 v124, v124
    v_fract_f32 v125, v125
    v_cos_f32 v126, v125
    v_sin_f32 v127, v125
    s_nop 0
    v_mul_f32 v188, v108, v110
    v_mul_f32 v189, v108, v111
    v_mul_f32 v200, v112, v114
    v_mul_f32 v201, v112, v115
    v_mul_f32 v212, v116, v118
    v_mul_f32 v213, v116, v119
    v_mul_f32 v224, v120, v122
    v_mul_f32 v225, v120, v123
    v_mul_f32 v236, v124, v126
    v_mul_f32 v237, v124, v127
    v_mul_f32 v108, 0x44000000, v96
    v_mul_f32 v109, 0x44000000, v101
    v_exp_f32 v108, v108
    v_fract_f32 v109, v109
    v_cos_f32 v110, v109
    v_sin_f32 v111, v109
    v_mul_f32 v112, 0x44000000, v97
    v_mul_f32 v113, 0x44000000, v102
    v_exp_f32 v112, v112
    v_fract_f32 v113, v113
    v_cos_f32 v114, v113
    v_sin_f32 v115, v113
    v_mul_f32 v116, 0x44000000, v98
    v_mul_f32 v117, 0x44000000, v103
    v_exp_f32 v116, v116
    v_fract_f32 v117, v117
    v_cos_f32 v118, v117
    v_sin_f32 v119, v117
    v_mul_f32 v120, 0x44000000, v99
    v_mul_f32 v121, 0x44000000, v104
    v_exp_f32 v120, v120
    v_fract_f32 v121, v121
    v_cos_f32 v122, v121
    v_sin_f32 v123, v121
    v_mul_f32 v124, 0x44000000, v100
    v_mul_f32 v125, 0x44000000, v105
    v_exp_f32 v124, v124
    v_fract_f32 v125, v125
    v_cos_f32 v126, v125
    v_sin_f32 v127, v125
    s_nop 0
    v_mul_f32 v190, v108, v110
    v_mul_f32 v191, v108, v111
    v_mul_f32 v202, v112, v114
    v_mul_f32 v203, v112, v115
    v_mul_f32 v214, v116, v118
    v_mul_f32 v215, v116, v119
    v_mul_f32 v226, v120, v122
    v_mul_f32 v227, v120, v123
    v_mul_f32 v238, v124, v126
    v_mul_f32 v239, v124, v127
    v_xor_b32 v181, v12, v181
    v_xor_b32 v183, v12, v183
    v_xor_b32 v185, v12, v185
    v_xor_b32 v187, v12, v187
    v_xor_b32 v189, v12, v189
    v_xor_b32 v191, v12, v191
    ds_write_b128 v10, v[180:183] offset:0
    ds_write_b128 v10, v[184:187] offset:16
    ds_write_b128 v10, v[188:191] offset:32
    v_xor_b32 v193, v12, v193
    v_xor_b32 v195, v12, v195
    v_xor_b32 v197, v12, v197
    v_xor_b32 v199, v12, v199
    v_xor_b32 v201, v12, v201
    v_xor_b32 v203, v12, v203
    ds_write_b128 v10, v[192:195] offset:768
    ds_write_b128 v10, v[196:199] offset:784
    ds_write_b128 v10, v[200:203] offset:800
    v_xor_b32 v205, v12, v205
    v_xor_b32 v207, v12, v207
    v_xor_b32 v209, v12, v209
    v_xor_b32 v211, v12, v211
    v_xor_b32 v213, v12, v213
    v_xor_b32 v215, v12, v215
    ds_write_b128 v10, v[204:207] offset:1536
    ds_write_b128 v10, v[208:211] offset:1552
    ds_write_b128 v10, v[212:215] offset:1568
    v_xor_b32 v217, v12, v217
    v_xor_b32 v219, v12, v219
    v_xor_b32 v221, v12, v221
    v_xor_b32 v223, v12, v223
    v_xor_b32 v225, v12, v225
    v_xor_b32 v227, v12, v227
    ds_write_b128 v10, v[216:219] offset:2304
    ds_write_b128 v10, v[220:223] offset:2320
    ds_write_b128 v10, v[224:227] offset:2336
    v_xor_b32 v229, v12, v229
    v_xor_b32 v231, v12, v231
    v_xor_b32 v233, v12, v233
    v_xor_b32 v235, v12, v235
    v_xor_b32 v237, v12, v237
    v_xor_b32 v239, v12, v239
    ds_write_b128 v10, v[228:231] offset:3072
    ds_write_b128 v10, v[232:235] offset:3088
    ds_write_b128 v10, v[236:239] offset:3104
    v_mul_f32 v108, v13, v96
    v_mul_f32 v109, v13, v101
    v_exp_f32 v108, v108
    v_fract_f32 v109, v109
    v_cos_f32 v110, v109
    v_sin_f32 v111, v109
    v_mul_f32 v112, v13, v97
    v_mul_f32 v113, v13, v102
    v_exp_f32 v112, v112
    v_fract_f32 v113, v113
    v_cos_f32 v114, v113
    v_sin_f32 v115, v113
    v_mul_f32 v116, v13, v98
    v_mul_f32 v117, v13, v103
    v_exp_f32 v116, v116
    v_fract_f32 v117, v117
    v_cos_f32 v118, v117
    v_sin_f32 v119, v117
    v_mul_f32 v120, v13, v99
    v_mul_f32 v121, v13, v104
    v_exp_f32 v120, v120
    v_fract_f32 v121, v121
    v_cos_f32 v122, v121
    v_sin_f32 v123, v121
    v_mul_f32 v124, v13, v100
    v_mul_f32 v125, v13, v105
    v_exp_f32 v124, v124
    v_fract_f32 v125, v125
    v_cos_f32 v126, v125
    v_sin_f32 v127, v125
    s_nop 0
    v_mul_f32 v130, v108, v110
    v_mul_f32 v131, v108, v111
    v_mul_f32 v132, v112, v114
    v_mul_f32 v133, v112, v115
    v_mul_f32 v134, v116, v118
    v_mul_f32 v135, v116, v119
    v_mul_f32 v136, v120, v122
    v_mul_f32 v137, v120, v123
    v_mul_f32 v138, v124, v126
    v_mul_f32 v139, v124, v127
    v_xor_b32 v131, v12, v131
    ds_write_b64 v11, v[130:131] offset:0
    v_xor_b32 v133, v12, v133
    ds_write_b64 v11, v[132:133] offset:512
    v_xor_b32 v135, v12, v135
    ds_write_b64 v11, v[134:135] offset:1024
    v_xor_b32 v137, v12, v137
    ds_write_b64 v11, v[136:137] offset:1536
    v_xor_b32 v139, v12, v139
    ds_write_b64 v11, v[138:139] offset:2048
    v_add_f32 v13, 0x42000000, v13
    v_mul_f32 v108, v13, v96
    v_mul_f32 v109, v13, v101
    v_exp_f32 v108, v108
    v_fract_f32 v109, v109
    v_cos_f32 v110, v109
    v_sin_f32 v111, v109
    v_mul_f32 v112, v13, v97
    v_mul_f32 v113, v13, v102
    v_exp_f32 v112, v112
    v_fract_f32 v113, v113
    v_cos_f32 v114, v113
    v_sin_f32 v115, v113
    v_mul_f32 v116, v13, v98
    v_mul_f32 v117, v13, v103
    v_exp_f32 v116, v116
    v_fract_f32 v117, v117
    v_cos_f32 v118, v117
    v_sin_f32 v119, v117
    v_mul_f32 v120, v13, v99
    v_mul_f32 v121, v13, v104
    v_exp_f32 v120, v120
    v_fract_f32 v121, v121
    v_cos_f32 v122, v121
    v_sin_f32 v123, v121
    v_mul_f32 v124, v13, v100
    v_mul_f32 v125, v13, v105
    v_exp_f32 v124, v124
    v_fract_f32 v125, v125
    v_cos_f32 v126, v125
    v_sin_f32 v127, v125
    s_nop 0
    v_mul_f32 v140, v108, v110
    v_mul_f32 v141, v108, v111
    v_mul_f32 v142, v112, v114
    v_mul_f32 v143, v112, v115
    v_mul_f32 v144, v116, v118
    v_mul_f32 v145, v116, v119
    v_mul_f32 v146, v120, v122
    v_mul_f32 v147, v120, v123
    v_mul_f32 v148, v124, v126
    v_mul_f32 v149, v124, v127
    v_xor_b32 v141, v12, v141
    ds_write_b64 v11, v[140:141] offset:2560
    v_xor_b32 v143, v12, v143
    ds_write_b64 v11, v[142:143] offset:3072
    v_xor_b32 v145, v12, v145
    ds_write_b64 v11, v[144:145] offset:3584
    v_xor_b32 v147, v12, v147
    ds_write_b64 v11, v[146:147] offset:4096
    v_xor_b32 v149, v12, v149
    ds_write_b64 v11, v[148:149] offset:4608
    v_add_f32 v13, 0x42000000, v13
    v_mul_f32 v108, v13, v96
    v_mul_f32 v109, v13, v101
    v_exp_f32 v108, v108
    v_fract_f32 v109, v109
    v_cos_f32 v110, v109
    v_sin_f32 v111, v109
    v_mul_f32 v112, v13, v97
    v_mul_f32 v113, v13, v102
    v_exp_f32 v112, v112
    v_fract_f32 v113, v113
    v_cos_f32 v114, v113
    v_sin_f32 v115, v113
    v_mul_f32 v116, v13, v98
    v_mul_f32 v117, v13, v103
    v_exp_f32 v116, v116
    v_fract_f32 v117, v117
    v_cos_f32 v118, v117
    v_sin_f32 v119, v117
    v_mul_f32 v120, v13, v99
    v_mul_f32 v121, v13, v104
    v_exp_f32 v120, v120
    v_fract_f32 v121, v121
    v_cos_f32 v122, v121
    v_sin_f32 v123, v121
    v_mul_f32 v124, v13, v100
    v_mul_f32 v125, v13, v105
    v_exp_f32 v124, v124
    v_fract_f32 v125, v125
    v_cos_f32 v126, v125
    v_sin_f32 v127, v125
    s_nop 0
    v_mul_f32 v130, v108, v110
    v_mul_f32 v131, v108, v111
    v_mul_f32 v132, v112, v114
    v_mul_f32 v133, v112, v115
    v_mul_f32 v134, v116, v118
    v_mul_f32 v135, v116, v119
    v_mul_f32 v136, v120, v122
    v_mul_f32 v137, v120, v123
    v_mul_f32 v138, v124, v126
    v_mul_f32 v139, v124, v127
    v_xor_b32 v131, v12, v131
    ds_write_b64 v11, v[130:131] offset:5120
    v_xor_b32 v133, v12, v133
    ds_write_b64 v11, v[132:133] offset:5632
    v_xor_b32 v135, v12, v135
    ds_write_b64 v11, v[134:135] offset:6144
    v_xor_b32 v137, v12, v137
    ds_write_b64 v11, v[136:137] offset:6656
    v_xor_b32 v139, v12, v139
    ds_write_b64 v11, v[138:139] offset:7168
    v_add_f32 v13, 0x42000000, v13
    v_mul_f32 v108, v13, v96
    v_mul_f32 v109, v13, v101
    v_exp_f32 v108, v108
    v_fract_f32 v109, v109
    v_cos_f32 v110, v109
    v_sin_f32 v111, v109
    v_mul_f32 v112, v13, v97
    v_mul_f32 v113, v13, v102
    v_exp_f32 v112, v112
    v_fract_f32 v113, v113
    v_cos_f32 v114, v113
    v_sin_f32 v115, v113
    v_mul_f32 v116, v13, v98
    v_mul_f32 v117, v13, v103
    v_exp_f32 v116, v116
    v_fract_f32 v117, v117
    v_cos_f32 v118, v117
    v_sin_f32 v119, v117
    v_mul_f32 v120, v13, v99
    v_mul_f32 v121, v13, v104
    v_exp_f32 v120, v120
    v_fract_f32 v121, v121
    v_cos_f32 v122, v121
    v_sin_f32 v123, v121
    v_mul_f32 v124, v13, v100
    v_mul_f32 v125, v13, v105
    v_exp_f32 v124, v124
    v_fract_f32 v125, v125
    v_cos_f32 v126, v125
    v_sin_f32 v127, v125
    s_nop 0
    v_mul_f32 v140, v108, v110
    v_mul_f32 v141, v108, v111
    v_mul_f32 v142, v112, v114
    v_mul_f32 v143, v112, v115
    v_mul_f32 v144, v116, v118
    v_mul_f32 v145, v116, v119
    v_mul_f32 v146, v120, v122
    v_mul_f32 v147, v120, v123
    v_mul_f32 v148, v124, v126
    v_mul_f32 v149, v124, v127
    v_xor_b32 v141, v12, v141
    ds_write_b64 v11, v[140:141] offset:7680
    v_xor_b32 v143, v12, v143
    ds_write_b64 v11, v[142:143] offset:8192
    v_xor_b32 v145, v12, v145
    ds_write_b64 v11, v[144:145] offset:8704
    v_xor_b32 v147, v12, v147
    ds_write_b64 v11, v[146:147] offset:9216
    v_xor_b32 v149, v12, v149
    ds_write_b64 v11, v[148:149] offset:9728
U_lp0d:
    s_mul_i32 s24, s14, 192
    s_add_u32 s68, s52, s24
    s_addc_u32 s69, s53, 0
    s_and_b32 s69, s69, 0xffff
    s_mov_b32 s70, 0x1df4c0
    s_mov_b32 s71, 0x00020000
    v_lshrrev_b32 v10, 2, v1
    v_and_b32 v11, 3, v10
    v_lshrrev_b32 v12, 2, v10
    v_and_b32 v12, 1, v12
    v_lshrrev_b32 v13, 3, v10
    v_lshl_add_u32 v11, v12, 3, v11
    v_lshl_add_u32 v11, v13, 2, v11
    v_mul_u32_u24 v22, 3072, v11
    v_lshrrev_b32 v13, 1, v1
    v_and_b32 v13, 1, v13
    v_xor_b32 v13, v13, v12
    v_lshl_add_u32 v22, v13, 5, v22
    v_and_b32 v13, 1, v1
    v_lshl_add_u32 v22, v13, 4, v22
    s_mul_i32 s3, s17, 49152
    s_lshl_b32 s4, s17, 10
    s_mul_i32 s24, s13, 163840
    s_add_u32 s24, s24, 0
    s_add_u32 s64, s10, s24
    s_addc_u32 s65, s11, 0
    s_and_b32 s65, s65, 0xffff
    s_mov_b32 s66, 0x28000
    s_mov_b32 s67, 0x00020000
    s_cmp_eq_u32 s18, 0
    s_cselect_b32 s24, s38, s40
    s_cselect_b32 s25, s39, s41
    s_mul_i32 s26, s14, 51200
    s_add_u32 s72, s24, s26
    s_addc_u32 s73, s25, 0
    s_and_b32 s73, s73, 0xffff
    s_mov_b32 s74, 0xc800
    s_mov_b32 s75, 0x00020000
    s_mul_i32 s24, s15, 196608
    s_add_u32 s24, s24, 8388608
    s_add_u32 s80, s10, s24
    s_addc_u32 s81, s11, 0
    s_and_b32 s81, s81, 0xffff
    s_mov_b32 s82, 0x30000
    s_mov_b32 s83, 0x00020000
    s_mul_i32 s24, s16, 245760
    s_add_u32 s24, s24, 5242880
    s_add_u32 s84, s10, s24
    s_addc_u32 s85, s11, 0
    s_and_b32 s85, s85, 0xffff
    s_mov_b32 s86, 0x3c000
    s_mov_b32 s87, 0x00020000
    s_mul_i32 s24, s15, 163840
    s_add_u32 s24, s24, 33554432
    s_add_u32 s88, s10, s24
    s_addc_u32 s89, s11, 0
    s_and_b32 s89, s89, 0xffff
    s_mov_b32 s90, 0x28000
    s_mov_b32 s91, 0x00020000
    s_lshr_b32 s24, s2, 3
    s_and_b32 s25, s2, 7
    v_lshlrev_b32 v18, 7, v1
    s_cmp_eq_u32 s17, 3
    s_cbranch_scc1 U_pf3_24
    s_cmp_lg_u32 s17, 0
    s_cbranch_scc1 U_pf1_23
    s_lshr_b32 s25, s25, 1
    s_mul_i32 s25, s25, 204800
    s_mul_i32 s26, s24, 6400
    s_add_u32 s25, s25, s26
    s_add_u32 s92, s38, s25
    s_addc_u32 s93, s39, 0
    s_and_b32 s93, s93, 0xffff
    s_mov_b32 s94, 0x1900
    s_mov_b32 s95, 0x00020000
    s_add_u32 s96, s40, s25
    s_addc_u32 s97, s41, 0
    s_and_b32 s97, s97, 0xffff
    s_mov_b32 s98, 0x1900
    s_mov_b32 s99, 0x00020000
    buffer_load_dword v19, v18, s[92:95], 0 offen
    buffer_load_dword v20, v18, s[96:99], 0 offen
    s_branch U_pfd_25
U_pf1_23:
    s_lshr_b32 s25, s25, 2
    s_mul_i32 s25, s25, 409600
    s_mul_i32 s26, s24, 12800
    s_add_u32 s25, s25, s26
    s_cmp_eq_u32 s17, 1
    s_cselect_b32 s26, s42, s44
    s_cselect_b32 s27, s43, s45
    s_add_u32 s92, s26, s25
    s_addc_u32 s93, s27, 0
    s_and_b32 s93, s93, 0xffff
    s_mov_b32 s94, 0x3200
    s_mov_b32 s95, 0x00020000
    s_movk_i32 s26, 8192
    buffer_load_dword v19, v18, s[92:95], 0 offen
    buffer_load_dword v20, v18, s[92:95], s26 offen
    s_branch U_pfd_25
U_pf3_24:
    s_lshr_b32 s25, s25, 1
    s_mul_i32 s25, s25, 768
    s_mul_i32 s26, s24, 61440
    s_add_u32 s25, s25, s26
    s_add_u32 s92, s52, s25
    s_addc_u32 s93, s53, 0
    s_and_b32 s93, s93, 0xffff
    s_mov_b32 s94, 0xe700
    s_mov_b32 s95, 0x00020000
    v_mul_u32_u24 v19, 43, v1
    v_lshrrev_b32 v19, 8, v19
    v_mul_u32_u24 v20, 6, v19
    v_sub_u32 v20, v1, v20
    v_mul_u32_u24 v19, 3072, v19
    v_lshl_add_u32 v18, v20, 7, v19
    s_movk_i32 s26, 30720
    buffer_load_dword v19, v18, s[92:95], 0 offen
    buffer_load_dword v20, v18, s[92:95], s26 offen
U_pfd_25:
    s_cmp_eq_u32 s18, 0
    s_cselect_b32 s24, s58, s48
    s_cselect_b32 s25, s59, s49
    s_mul_i32 s26, s16, 160
    s_add_u32 s92, s24, s26
    s_addc_u32 s93, s25, 0
    s_and_b32 s93, s93, 0xffff
    s_mov_b32 s94, 0xa0
    s_mov_b32 s95, 0x00020000
    v_lshlrev_b32 v18, 4, v1
    v_cmp_gt_u32 vcc, 16, v1
    s_and_saveexec_b64 s[26:27], vcc
    s_lshl_b32 s24, s18, 8
    s_add_u32 m0, s24, 148992
    s_nop 0
    buffer_load_dwordx4 v18, s[92:95], 0 offen lds
    s_mov_b64 exec, -1
    s_mul_i32 s24, s16, 102400
    s_add_u32 s92, s42, s24
    s_addc_u32 s93, s43, 0
    s_and_b32 s93, s93, 0xffff
    s_mov_b32 s94, 0x19000
    s_mov_b32 s95, 0x00020000
    s_add_u32 s96, s44, s24
    s_addc_u32 s97, s45, 0
    s_and_b32 s97, s97, 0xffff
    s_mov_b32 s98, 0x19000
    s_mov_b32 s99, 0x00020000
    v_mul_u32_u24 v5, 1280, v2
    v_lshl_add_u32 v5, v4, 4, v5
    v_mul_u32_u24 v16, 3072, v2
    v_lshl_add_u32 v16, v4, 4, v16
    v_and_b32 v10, 1, v6
    s_lshl_b32 s24, s18, 1
    v_or_b32 v10, s24, v10
    v_lshrrev_b32 v11, 1, v3
    v_xor_b32 v11, v10, v11
    v_lshrrev_b32 v10, 1, v11
    v_mul_u32_u24 v10, 81920, v10
    v_lshl_add_u32 v10, v2, 6, v10
    v_and_b32 v11, 1, v11
    v_lshl_add_u32 v10, v11, 5, v10
    v_and_b32 v11, 1, v1
    v_lshl_add_u32 v10, v11, 4, v10
    v_lshrrev_b32 v21, 2, v4
    v_lshlrev_b32 v21, 12, v21
    v_lshl_add_u32 v21, v2, 6, v21
    v_and_b32 v11, 3, v4
    v_lshl_add_u32 v21, v11, 4, v21
    s_mul_i32 s47, s17, 10240
    s_mul_i32 s5, s19, 10240
    s_lshl_b32 s50, s19, 13
    s_lshl_b32 s24, s18, 9
    s_add_u32 s50, s50, s24
    s_lshl_b32 s9, s19, 12
    s_add_u32 s9, s9, s24
    s_mul_i32 s7, s18, 24576
    s_lshl_b32 s24, s19, 7
    s_add_u32 s7, s7, s24
    s_mul_i32 s8, s18, 10240
    s_add_u32 s8, s8, s24
    s_mul_i32 s46, s19, 18432
    s_lshl_b32 s24, s18, 10
    s_add_u32 s46, s46, s24
    s_mov_b32 s31, 0x1000000
U_gx_26:
    ds_read_b32 v18, v15 offset:4
    s_waitcnt lgkmcnt(0)
    v_readfirstlane_b32 s30, v18
    s_sub_u32 s31, s31, 1
    s_cbranch_scc1 U_gxd_27
    s_nop 1
    s_cmp_ge_u32 s30, 1
    s_cbranch_scc1 U_gxd_27
    s_sleep 1
    s_branch U_gx_26
U_gxd_27:
    s_add_u32 m0, s4, 16384
    s_add_u32 s6, s3, 0
    buffer_load_dwordx4 v22, s[68:71], s6 offen lds
    s_add_u32 m0, s4, 20480
    s_add_u32 s6, s3, 64
    buffer_load_dwordx4 v22, s[68:71], s6 offen lds
    s_add_u32 m0, s4, 24576
    s_add_u32 s6, s3, 128
    buffer_load_dwordx4 v22, s[68:71], s6 offen lds
    s_add_u32 m0, s4, 0
    s_add_u32 s6, s47, 0
    buffer_load_dwordx4 v5, s[64:67], s6 offen sc1 lds
    s_add_u32 m0, s4, 4096
    s_add_u32 s6, s47, 40960
    buffer_load_dwordx4 v5, s[64:67], s6 offen sc1 lds
    s_add_u32 m0, s4, 8192
    s_add_u32 s6, s47, 81920
    buffer_load_dwordx4 v5, s[64:67], s6 offen sc1 lds
    s_add_u32 m0, s4, 12288
    s_add_u32 s6, s47, 122880
    buffer_load_dwordx4 v5, s[64:67], s6 offen sc1 lds
    s_add_u32 m0, s4, 53248
    s_add_u32 s6, s3, 196608
    buffer_load_dwordx4 v22, s[68:71], s6 offen lds
    s_add_u32 m0, s4, 57344
    s_add_u32 s6, s3, 196672
    buffer_load_dwordx4 v22, s[68:71], s6 offen lds
    s_add_u32 m0, s4, 61440
    s_add_u32 s6, s3, 196736
    buffer_load_dwordx4 v22, s[68:71], s6 offen lds
    s_add_u32 m0, s4, 36864
    s_add_u32 s6, s47, 128
    buffer_load_dwordx4 v5, s[64:67], s6 offen sc1 lds
    s_add_u32 m0, s4, 40960
    s_add_u32 s6, s47, 41088
    buffer_load_dwordx4 v5, s[64:67], s6 offen sc1 lds
    s_add_u32 m0, s4, 45056
    s_add_u32 s6, s47, 82048
    buffer_load_dwordx4 v5, s[64:67], s6 offen sc1 lds
    s_add_u32 m0, s4, 49152
    s_add_u32 s6, s47, 123008
    buffer_load_dwordx4 v5, s[64:67], s6 offen sc1 lds
    s_waitcnt vmcnt(7)
    s_barrier
    s_add_u32 m0, s4, 90112
    s_add_u32 s6, s3, 393216
    buffer_load_dwordx4 v22, s[68:71], s6 offen lds
    s_add_u32 m0, s4, 94208
    s_add_u32 s6, s3, 393280
    buffer_load_dwordx4 v22, s[68:71], s6 offen lds
    s_add_u32 m0, s4, 98304
    s_add_u32 s6, s3, 393344
    buffer_load_dwordx4 v22, s[68:71], s6 offen lds
    s_add_u32 m0, s4, 73728
    s_add_u32 s6, s47, 256
    buffer_load_dwordx4 v5, s[64:67], s6 offen sc1 lds
    s_add_u32 m0, s4, 77824
    s_add_u32 s6, s47, 41216
    buffer_load_dwordx4 v5, s[64:67], s6 offen sc1 lds
    s_add_u32 m0, s4, 81920
    s_add_u32 s6, s47, 82176
    buffer_load_dwordx4 v5, s[64:67], s6 offen sc1 lds
    s_add_u32 m0, s4, 86016
    s_add_u32 s6, s47, 123136
    buffer_load_dwordx4 v5, s[64:67], s6 offen sc1 lds
    s_add_u32 m0, s4, 126976
    s_add_u32 s6, s3, 589824
    buffer_load_dwordx4 v22, s[68:71], s6 offen lds
    s_add_u32 m0, s4, 131072
    s_add_u32 s6, s3, 589888
    buffer_load_dwordx4 v22, s[68:71], s6 offen lds
    s_add_u32 m0, s4, 135168
    s_add_u32 s6, s3, 589952
    buffer_load_dwordx4 v22, s[68:71], s6 offen lds
    s_add_u32 m0, s4, 110592
    s_add_u32 s6, s47, 384
    buffer_load_dwordx4 v5, s[64:67], s6 offen sc1 lds
    s_add_u32 m0, s4, 114688
    s_add_u32 s6, s47, 41344
    buffer_load_dwordx4 v5, s[64:67], s6 offen sc1 lds
    s_add_u32 m0, s4, 118784
    s_add_u32 s6, s47, 82304
    buffer_load_dwordx4 v5, s[64:67], s6 offen sc1 lds
    s_add_u32 m0, s4, 122880
    s_add_u32 s6, s47, 123264
    buffer_load_dwordx4 v5, s[64:67], s6 offen sc1 lds
    s_waitcnt vmcnt(14)
    s_barrier
    s_add_u32 m0, s4, 16384
    s_add_u32 s6, s3, 786432
    buffer_load_dwordx4 v22, s[68:71], s6 offen lds
    s_add_u32 m0, s4, 20480
    s_add_u32 s6, s3, 786496
    buffer_load_dwordx4 v22, s[68:71], s6 offen lds
    s_add_u32 m0, s4, 24576
    s_add_u32 s6, s3, 786560
    buffer_load_dwordx4 v22, s[68:71], s6 offen lds
    s_add_u32 m0, s4, 0
    s_add_u32 s6, s47, 512
    buffer_load_dwordx4 v5, s[64:67], s6 offen sc1 lds
    s_add_u32 m0, s4, 4096
    s_add_u32 s6, s47, 41472
    buffer_load_dwordx4 v5, s[64:67], s6 offen sc1 lds
    s_add_u32 m0, s4, 8192
    s_add_u32 s6, s47, 82432
    buffer_load_dwordx4 v5, s[64:67], s6 offen sc1 lds
    s_add_u32 m0, s4, 12288
    s_add_u32 s6, s47, 123392
    buffer_load_dwordx4 v5, s[64:67], s6 offen sc1 lds
    s_waitcnt vmcnt(14)
    s_barrier
    s_cmp_lg_u32 s17, 2
    s_cbranch_scc1 U_w2s_28
    s_cmp_ge_u32 s2, 240
    s_cbranch_scc1 U_w2s_28
    s_lshl_b32 s24, s28, 8
    s_add_u32 s24, s24, 24576
    v_cmp_eq_u32 vcc, 0, v1
    s_and_saveexec_b64 s[30:31], vcc
    v_mov_b32 v18, 1
    v_mov_b32 v19, 0
    buffer_atomic_add v18, v19, s[76:79], s24 offen
    s_mov_b64 exec, -1
U_w2s_28:
    s_add_u32 m0, s4, 53248
    s_add_u32 s6, s3, 983040
    buffer_load_dwordx4 v22, s[68:71], s6 offen lds
    s_add_u32 m0, s4, 57344
    s_add_u32 s6, s3, 983104
    buffer_load_dwordx4 v22, s[68:71], s6 offen lds
    s_add_u32 m0, s4, 61440
    s_add_u32 s6, s3, 983168
    buffer_load_dwordx4 v22, s[68:71], s6 offen lds
    s_add_u32 m0, s4, 36864
    s_add_u32 s6, s47, 640
    buffer_load_dwordx4 v5, s[64:67], s6 offen sc1 lds
    s_add_u32 m0, s4, 40960
    s_add_u32 s6, s47, 41600
    buffer_load_dwordx4 v5, s[64:67], s6 offen sc1 lds
    s_add_u32 m0, s4, 45056
    s_add_u32 s6, s47, 82560
    buffer_load_dwordx4 v5, s[64:67], s6 offen sc1 lds
    s_add_u32 m0, s4, 49152
    s_add_u32 s6, s47, 123520
    buffer_load_dwordx4 v5, s[64:67], s6 offen sc1 lds
    s_waitcnt vmcnt(14)
    s_barrier
    s_add_u32 m0, s4, 90112
    s_add_u32 s6, s3, 1179648
    buffer_load_dwordx4 v22, s[68:71], s6 offen lds
    s_add_u32 m0, s4, 94208
    s_add_u32 s6, s3, 1179712
    buffer_load_dwordx4 v22, s[68:71], s6 offen lds
    s_add_u32 m0, s4, 98304
    s_add_u32 s6, s3, 1179776
    buffer_load_dwordx4 v22, s[68:71], s6 offen lds
    s_add_u32 m0, s4, 73728
    s_add_u32 s6, s47, 768
    buffer_load_dwordx4 v5, s[64:67], s6 offen sc1 lds
    s_add_u32 m0, s4, 77824
    s_add_u32 s6, s47, 41728
    buffer_load_dwordx4 v5, s[64:67], s6 offen sc1 lds
    s_add_u32 m0, s4, 81920
    s_add_u32 s6, s47, 82688
    buffer_load_dwordx4 v5, s[64:67], s6 offen sc1 lds
    s_add_u32 m0, s4, 86016
    s_add_u32 s6, s47, 123648
    buffer_load_dwordx4 v5, s[64:67], s6 offen sc1 lds
    s_waitcnt vmcnt(14)
    s_barrier
    s_add_u32 m0, s4, 126976
    s_add_u32 s6, s3, 1376256
    buffer_load_dwordx4 v22, s[68:71], s6 offen lds
    s_add_u32 m0, s4, 131072
    s_add_u32 s6, s3, 1376320
    buffer_load_dwordx4 v22, s[68:71], s6 offen lds
    s_add_u32 m0, s4, 135168
    s_add_u32 s6, s3, 1376384
    buffer_load_dwordx4 v22, s[68:71], s6 offen lds
    s_add_u32 m0, s4, 110592
    s_add_u32 s6, s47, 896
    buffer_load_dwordx4 v5, s[64:67], s6 offen sc1 lds
    s_add_u32 m0, s4, 114688
    s_add_u32 s6, s47, 41856
    buffer_load_dwordx4 v5, s[64:67], s6 offen sc1 lds
    s_add_u32 m0, s4, 118784
    s_add_u32 s6, s47, 82816
    buffer_load_dwordx4 v5, s[64:67], s6 offen sc1 lds
    s_add_u32 m0, s4, 122880
    s_add_u32 s6, s47, 123776
    buffer_load_dwordx4 v5, s[64:67], s6 offen sc1 lds
    s_waitcnt vmcnt(14)
    s_barrier
    s_add_u32 m0, s4, 16384
    s_add_u32 s6, s3, 1572864
    buffer_load_dwordx4 v22, s[68:71], s6 offen lds
    s_add_u32 m0, s4, 20480
    s_add_u32 s6, s3, 1572928
    buffer_load_dwordx4 v22, s[68:71], s6 offen lds
    s_add_u32 m0, s4, 24576
    s_add_u32 s6, s3, 1572992
    buffer_load_dwordx4 v22, s[68:71], s6 offen lds
    s_add_u32 m0, s4, 0
    s_add_u32 s6, s47, 1024
    buffer_load_dwordx4 v5, s[64:67], s6 offen sc1 lds
    s_add_u32 m0, s4, 4096
    s_add_u32 s6, s47, 41984
    buffer_load_dwordx4 v5, s[64:67], s6 offen sc1 lds
    s_add_u32 m0, s4, 8192
    s_add_u32 s6, s47, 82944
    buffer_load_dwordx4 v5, s[64:67], s6 offen sc1 lds
    s_add_u32 m0, s4, 12288
    s_add_u32 s6, s47, 123904
    buffer_load_dwordx4 v5, s[64:67], s6 offen sc1 lds
    s_waitcnt vmcnt(14)
    s_barrier
    s_add_u32 m0, s4, 53248
    s_add_u32 s6, s3, 1769472
    buffer_load_dwordx4 v22, s[68:71], s6 offen lds
    s_add_u32 m0, s4, 57344
    s_add_u32 s6, s3, 1769536
    buffer_load_dwordx4 v22, s[68:71], s6 offen lds
    s_add_u32 m0, s4, 61440
    s_add_u32 s6, s3, 1769600
    buffer_load_dwordx4 v22, s[68:71], s6 offen lds
    s_add_u32 m0, s4, 36864
    s_add_u32 s6, s47, 1152
    buffer_load_dwordx4 v5, s[64:67], s6 offen sc1 lds
    s_add_u32 m0, s4, 40960
    s_add_u32 s6, s47, 42112
    buffer_load_dwordx4 v5, s[64:67], s6 offen sc1 lds
    s_add_u32 m0, s4, 45056
    s_add_u32 s6, s47, 83072
    buffer_load_dwordx4 v5, s[64:67], s6 offen sc1 lds
    s_add_u32 m0, s4, 49152
    s_add_u32 s6, s47, 124032
    buffer_load_dwordx4 v5, s[64:67], s6 offen sc1 lds
    s_waitcnt vmcnt(14)
    s_barrier
    s_add_u32 m0, s4, 90112
    s_add_u32 s6, s5, 768
    buffer_load_dwordx4 v5, s[72:75], s6 offen lds
    s_add_u32 m0, s4, 94208
    s_add_u32 s6, s5, 21248
    buffer_load_dwordx4 v5, s[72:75], s6 offen lds
    s_add_u32 m0, s4, 98304
    s_add_u32 s6, s5, 41728
    buffer_load_dwordx4 v5, s[72:75], s6 offen lds
    s_waitcnt vmcnt(10)
    s_barrier
    s_add_u32 m0, s4, 126976
    s_add_u32 s6, s5, 896
    buffer_load_dwordx4 v5, s[72:75], s6 offen lds
    s_add_u32 m0, s4, 131072
    s_add_u32 s6, s5, 21376
    buffer_load_dwordx4 v5, s[72:75], s6 offen lds
    s_add_u32 m0, s4, 135168
    s_add_u32 s6, s5, 41856
    buffer_load_dwordx4 v5, s[72:75], s6 offen lds
    s_waitcnt vmcnt(6)
    s_barrier
    s_add_u32 m0, s4, 16384
    s_add_u32 s6, s5, 1024
    buffer_load_dwordx4 v5, s[72:75], s6 offen lds
    s_add_u32 m0, s4, 20480
    s_add_u32 s6, s5, 21504
    buffer_load_dwordx4 v5, s[72:75], s6 offen lds
    s_add_u32 m0, s4, 24576
    s_add_u32 s6, s5, 41984
    buffer_load_dwordx4 v5, s[72:75], s6 offen lds
    s_waitcnt vmcnt(6)
    s_barrier
    s_add_u32 m0, s4, 53248
    s_add_u32 s6, s5, 1152
    buffer_load_dwordx4 v5, s[72:75], s6 offen lds
    s_add_u32 m0, s4, 57344
    s_add_u32 s6, s5, 21632
    buffer_load_dwordx4 v5, s[72:75], s6 offen lds
    s_add_u32 m0, s4, 61440
    s_add_u32 s6, s5, 42112
    buffer_load_dwordx4 v5, s[72:75], s6 offen lds
    s_waitcnt vmcnt(6)
    s_barrier
    s_add_u32 m0, s4, 90112
    s_add_u32 s6, s5, 0
    buffer_load_dwordx4 v5, s[72:75], s6 offen lds
    s_add_u32 m0, s4, 94208
    s_add_u32 s6, s5, 20480
    buffer_load_dwordx4 v5, s[72:75], s6 offen lds
    s_add_u32 m0, s4, 98304
    s_add_u32 s6, s5, 40960
    buffer_load_dwordx4 v5, s[72:75], s6 offen lds
    s_add_u32 m0, s4, 73728
    s_add_u32 s6, s47, 0
    buffer_load_dwordx4 v5, s[64:67], s6 offen sc1 lds
    s_add_u32 m0, s4, 77824
    s_add_u32 s6, s47, 40960
    buffer_load_dwordx4 v5, s[64:67], s6 offen sc1 lds
    s_add_u32 m0, s4, 81920
    s_add_u32 s6, s47, 81920
    buffer_load_dwordx4 v5, s[64:67], s6 offen sc1 lds
    s_add_u32 m0, s4, 86016
    s_add_u32 s6, s47, 122880
    buffer_load_dwordx4 v5, s[64:67], s6 offen sc1 lds
    s_waitcnt vmcnt(10)
    s_barrier
    s_add_u32 m0, s4, 126976
    s_add_u32 s6, s5, 128
    buffer_load_dwordx4 v5, s[72:75], s6 offen lds
    s_add_u32 m0, s4, 131072
    s_add_u32 s6, s5, 20608
    buffer_load_dwordx4 v5, s[72:75], s6 offen lds
    s_add_u32 m0, s4, 135168
    s_add_u32 s6, s5, 41088
    buffer_load_dwordx4 v5, s[72:75], s6 offen lds
    s_add_u32 m0, s4, 110592
    s_add_u32 s6, s47, 128
    buffer_load_dwordx4 v5, s[64:67], s6 offen sc1 lds
    s_add_u32 m0, s4, 114688
    s_add_u32 s6, s47, 41088
    buffer_load_dwordx4 v5, s[64:67], s6 offen sc1 lds
    s_add_u32 m0, s4, 118784
    s_add_u32 s6, s47, 82048
    buffer_load_dwordx4 v5, s[64:67], s6 offen sc1 lds
    s_add_u32 m0, s4, 122880
    s_add_u32 s6, s47, 123008
    buffer_load_dwordx4 v5, s[64:67], s6 offen sc1 lds
    s_waitcnt vmcnt(14)
    s_barrier
    s_add_u32 m0, s4, 16384
    s_add_u32 s6, s5, 256
    buffer_load_dwordx4 v5, s[72:75], s6 offen lds
    s_add_u32 m0, s4, 20480
    s_add_u32 s6, s5, 20736
    buffer_load_dwordx4 v5, s[72:75], s6 offen lds
    s_add_u32 m0, s4, 24576
    s_add_u32 s6, s5, 41216
    buffer_load_dwordx4 v5, s[72:75], s6 offen lds
    s_add_u32 m0, s4, 0
    s_add_u32 s6, s47, 256
    buffer_load_dwordx4 v5, s[64:67], s6 offen sc1 lds
    s_add_u32 m0, s4, 4096
    s_add_u32 s6, s47, 41216
    buffer_load_dwordx4 v5, s[64:67], s6 offen sc1 lds
    s_add_u32 m0, s4, 8192
    s_add_u32 s6, s47, 82176
    buffer_load_dwordx4 v5, s[64:67], s6 offen sc1 lds
    s_add_u32 m0, s4, 12288
    s_add_u32 s6, s47, 123136
    buffer_load_dwordx4 v5, s[64:67], s6 offen sc1 lds
    s_waitcnt vmcnt(14)
    s_barrier
    s_add_u32 m0, s4, 53248
    s_add_u32 s6, s5, 384
    buffer_load_dwordx4 v5, s[72:75], s6 offen lds
    s_add_u32 m0, s4, 57344
    s_add_u32 s6, s5, 20864
    buffer_load_dwordx4 v5, s[72:75], s6 offen lds
    s_add_u32 m0, s4, 61440
    s_add_u32 s6, s5, 41344
    buffer_load_dwordx4 v5, s[72:75], s6 offen lds
    s_add_u32 m0, s4, 36864
    s_add_u32 s6, s47, 384
    buffer_load_dwordx4 v5, s[64:67], s6 offen sc1 lds
    s_add_u32 m0, s4, 40960
    s_add_u32 s6, s47, 41344
    buffer_load_dwordx4 v5, s[64:67], s6 offen sc1 lds
    s_add_u32 m0, s4, 45056
    s_add_u32 s6, s47, 82304
    buffer_load_dwordx4 v5, s[64:67], s6 offen sc1 lds
    s_add_u32 m0, s4, 49152
    s_add_u32 s6, s47, 123264
    buffer_load_dwordx4 v5, s[64:67], s6 offen sc1 lds
    s_waitcnt vmcnt(14)
    s_barrier
    s_add_u32 m0, s4, 90112
    s_add_u32 s6, s5, 512
    buffer_load_dwordx4 v5, s[72:75], s6 offen lds
    s_add_u32 m0, s4, 94208
    s_add_u32 s6, s5, 20992
    buffer_load_dwordx4 v5, s[72:75], s6 offen lds
    s_add_u32 m0, s4, 98304
    s_add_u32 s6, s5, 41472
    buffer_load_dwordx4 v5, s[72:75], s6 offen lds
    s_add_u32 m0, s4, 73728
    s_add_u32 s6, s47, 512
    buffer_load_dwordx4 v5, s[64:67], s6 offen sc1 lds
    s_add_u32 m0, s4, 77824
    s_add_u32 s6, s47, 41472
    buffer_load_dwordx4 v5, s[64:67], s6 offen sc1 lds
    s_add_u32 m0, s4, 81920
    s_add_u32 s6, s47, 82432
    buffer_load_dwordx4 v5, s[64:67], s6 offen sc1 lds
    s_add_u32 m0, s4, 86016
    s_add_u32 s6, s47, 123392
    buffer_load_dwordx4 v5, s[64:67], s6 offen sc1 lds
    s_waitcnt vmcnt(14)
    s_barrier
    s_mul_i32 s25, s16, 80
    s_add_u32 s26, s25, 79
    s_lshr_b32 s25, s25, 6
    s_lshr_b32 s26, s26, 6
    s_lshl_b32 s25, s25, 8
    s_lshl_b32 s26, s26, 8
    s_add_u32 s25, s25, 24576
    s_add_u32 s26, s26, 24576
    buffer_load_dword v19, v17, s[76:79], s25 offen sc1
    buffer_load_dword v20, v17, s[76:79], s26 offen sc1
    s_add_u32 m0, s4, 126976
    s_add_u32 s6, s5, 640
    buffer_load_dwordx4 v5, s[72:75], s6 offen lds
    s_add_u32 m0, s4, 131072
    s_add_u32 s6, s5, 21120
    buffer_load_dwordx4 v5, s[72:75], s6 offen lds
    s_add_u32 m0, s4, 135168
    s_add_u32 s6, s5, 41600
    buffer_load_dwordx4 v5, s[72:75], s6 offen lds
    s_add_u32 m0, s4, 110592
    s_add_u32 s6, s47, 640
    buffer_load_dwordx4 v5, s[64:67], s6 offen sc1 lds
    s_add_u32 m0, s4, 114688
    s_add_u32 s6, s47, 41600
    buffer_load_dwordx4 v5, s[64:67], s6 offen sc1 lds
    s_add_u32 m0, s4, 118784
    s_add_u32 s6, s47, 82560
    buffer_load_dwordx4 v5, s[64:67], s6 offen sc1 lds
    s_add_u32 m0, s4, 122880
    s_add_u32 s6, s47, 123520
    buffer_load_dwordx4 v5, s[64:67], s6 offen sc1 lds
    s_waitcnt vmcnt(16)
    s_barrier
    s_waitcnt vmcnt(7)
    v_min_u32 v19, v19, v20
    s_nop 0
    v_readfirstlane_b32 s30, v19
    s_nop 3
    s_cmp_ge_u32 s30, 24
    s_cbranch_scc1 U_w2ok_29
    s_mov_b32 s31, 0x100000
U_w2_poll_30:
    buffer_load_dword v19, v17, s[76:79], s25 offen sc1
    s_waitcnt vmcnt(0)
    v_readfirstlane_b32 s30, v19
    s_nop 3
    s_cmp_ge_u32 s30, 24
    s_cbranch_scc1 U_w2_done_31
    s_sleep 4
    s_sub_u32 s31, s31, 1
    s_cmp_lg_u32 s31, 0
    s_cbranch_scc1 U_w2_poll_30
U_w2_done_31:
    s_mov_b32 s31, 0x100000
U_w2_poll_32:
    buffer_load_dword v19, v17, s[76:79], s26 offen sc1
    s_waitcnt vmcnt(0)
    v_readfirstlane_b32 s30, v19
    s_nop 3
    s_cmp_ge_u32 s30, 24
    s_cbranch_scc1 U_w2_done_33
    s_sleep 4
    s_sub_u32 s31, s31, 1
    s_cmp_lg_u32 s31, 0
    s_cbranch_scc1 U_w2_poll_32
U_w2_done_33:
U_w2ok_29:
    s_add_u32 m0, s46, 8192
    s_add_u32 s6, s7, 0
    buffer_load_dwordx4 v16, s[84:87], s6 offen sc1 lds
    s_add_u32 m0, s46, 10240
    s_add_u32 s6, s7, 49152
    buffer_load_dwordx4 v16, s[84:87], s6 offen sc1 lds
    s_add_u32 m0, s46, 12288
    s_add_u32 s6, s7, 98304
    buffer_load_dwordx4 v16, s[84:87], s6 offen sc1 lds
    s_add_u32 m0, s46, 14336
    s_add_u32 s6, s7, 147456
    buffer_load_dwordx4 v16, s[84:87], s6 offen sc1 lds
    s_add_u32 m0, s46, 16384
    s_add_u32 s6, s7, 196608
    buffer_load_dwordx4 v16, s[84:87], s6 offen sc1 lds
    s_barrier
    s_add_u32 m0, s46, 45056
    s_add_u32 s6, s7, 256
    buffer_load_dwordx4 v16, s[84:87], s6 offen sc1 lds
    s_add_u32 m0, s46, 47104
    s_add_u32 s6, s7, 49408
    buffer_load_dwordx4 v16, s[84:87], s6 offen sc1 lds
    s_add_u32 m0, s46, 49152
    s_add_u32 s6, s7, 98560
    buffer_load_dwordx4 v16, s[84:87], s6 offen sc1 lds
    s_add_u32 m0, s46, 51200
    s_add_u32 s6, s7, 147712
    buffer_load_dwordx4 v16, s[84:87], s6 offen sc1 lds
    s_add_u32 m0, s46, 53248
    s_add_u32 s6, s7, 196864
    buffer_load_dwordx4 v16, s[84:87], s6 offen sc1 lds
    s_waitcnt vmcnt(10)
    s_barrier
    s_add_u32 m0, s46, 81920
    s_add_u32 s6, s7, 512
    buffer_load_dwordx4 v16, s[84:87], s6 offen sc1 lds
    s_add_u32 m0, s46, 83968
    s_add_u32 s6, s7, 49664
    buffer_load_dwordx4 v16, s[84:87], s6 offen sc1 lds
    s_add_u32 m0, s46, 86016
    s_add_u32 s6, s7, 98816
    buffer_load_dwordx4 v16, s[84:87], s6 offen sc1 lds
    s_add_u32 m0, s46, 88064
    s_add_u32 s6, s7, 147968
    buffer_load_dwordx4 v16, s[84:87], s6 offen sc1 lds
    s_add_u32 m0, s46, 90112
    s_add_u32 s6, s7, 197120
    buffer_load_dwordx4 v16, s[84:87], s6 offen sc1 lds
    s_barrier
    s_add_u32 m0, s46, 118784
    s_add_u32 s6, s7, 768
    buffer_load_dwordx4 v16, s[84:87], s6 offen sc1 lds
    s_add_u32 m0, s46, 120832
    s_add_u32 s6, s7, 49920
    buffer_load_dwordx4 v16, s[84:87], s6 offen sc1 lds
    s_add_u32 m0, s46, 122880
    s_add_u32 s6, s7, 99072
    buffer_load_dwordx4 v16, s[84:87], s6 offen sc1 lds
    s_add_u32 m0, s46, 124928
    s_add_u32 s6, s7, 148224
    buffer_load_dwordx4 v16, s[84:87], s6 offen sc1 lds
    s_add_u32 m0, s46, 126976
    s_add_u32 s6, s7, 197376
    buffer_load_dwordx4 v16, s[84:87], s6 offen sc1 lds
    s_cmp_lg_u32 s17, 0
    s_cbranch_scc1 U_gnp_34
    v_mov_b32 v23, 1
    s_lshl_b32 s24, s15, 8
    s_add_u32 s24, s24, 4096
    s_mov_b32 s31, 0x100000
U_g_poll_36:
    buffer_load_dword v18, v17, s[76:79], s24 offen sc1
    s_waitcnt vmcnt(0)
    v_readfirstlane_b32 s30, v18
    s_nop 3
    s_cmp_ge_u32 s30, 32
    s_cbranch_scc1 U_g_done_37
    s_sleep 3
    s_sub_u32 s31, s31, 1
    s_cmp_lg_u32 s31, 0
    s_cbranch_scc1 U_g_poll_36
U_g_done_37:
    ds_write_b32 v15, v23 offset:12
    s_branch U_ggo_35
U_gnp_34:
    s_mov_b32 s31, 0x1000000
U_gw_38:
    ds_read_b32 v18, v15 offset:12
    s_waitcnt lgkmcnt(0)
    v_readfirstlane_b32 s30, v18
    s_sub_u32 s31, s31, 1
    s_cbranch_scc1 U_gwd_39
    s_nop 1
    s_cmp_ge_u32 s30, 1
    s_cbranch_scc1 U_gwd_39
    s_sleep 1
    s_branch U_gw_38
U_gwd_39:
U_ggo_35:
    s_add_u32 m0, s46, 0
    s_add_u32 s6, s50, 0
    buffer_load_dwordx4 v21, s[80:83], s6 offen sc1 lds
    s_add_u32 m0, s46, 2048
    s_add_u32 s6, s50, 1024
    buffer_load_dwordx4 v21, s[80:83], s6 offen sc1 lds
    s_add_u32 m0, s46, 4096
    s_add_u32 s6, s50, 2048
    buffer_load_dwordx4 v21, s[80:83], s6 offen sc1 lds
    s_add_u32 m0, s46, 6144
    s_add_u32 s6, s50, 3072
    buffer_load_dwordx4 v21, s[80:83], s6 offen sc1 lds
    s_add_u32 m0, s46, 36864
    s_add_u32 s6, s50, 16384
    buffer_load_dwordx4 v21, s[80:83], s6 offen sc1 lds
    s_add_u32 m0, s46, 38912
    s_add_u32 s6, s50, 17408
    buffer_load_dwordx4 v21, s[80:83], s6 offen sc1 lds
    s_add_u32 m0, s46, 40960
    s_add_u32 s6, s50, 18432
    buffer_load_dwordx4 v21, s[80:83], s6 offen sc1 lds
    s_add_u32 m0, s46, 43008
    s_add_u32 s6, s50, 19456
    buffer_load_dwordx4 v21, s[80:83], s6 offen sc1 lds
    s_waitcnt vmcnt(4)
    s_barrier
    s_add_u32 m0, s46, 73728
    s_add_u32 s6, s50, 32768
    buffer_load_dwordx4 v21, s[80:83], s6 offen sc1 lds
    s_add_u32 m0, s46, 75776
    s_add_u32 s6, s50, 33792
    buffer_load_dwordx4 v21, s[80:83], s6 offen sc1 lds
    s_add_u32 m0, s46, 77824
    s_add_u32 s6, s50, 34816
    buffer_load_dwordx4 v21, s[80:83], s6 offen sc1 lds
    s_add_u32 m0, s46, 79872
    s_add_u32 s6, s50, 35840
    buffer_load_dwordx4 v21, s[80:83], s6 offen sc1 lds
    s_add_u32 m0, s46, 110592
    s_add_u32 s6, s50, 49152
    buffer_load_dwordx4 v21, s[80:83], s6 offen sc1 lds
    s_add_u32 m0, s46, 112640
    s_add_u32 s6, s50, 50176
    buffer_load_dwordx4 v21, s[80:83], s6 offen sc1 lds
    s_add_u32 m0, s46, 114688
    s_add_u32 s6, s50, 51200
    buffer_load_dwordx4 v21, s[80:83], s6 offen sc1 lds
    s_add_u32 m0, s46, 116736
    s_add_u32 s6, s50, 52224
    buffer_load_dwordx4 v21, s[80:83], s6 offen sc1 lds
    s_waitcnt vmcnt(8)
    s_barrier
    s_add_u32 m0, s46, 8192
    s_add_u32 s6, s7, 1024
    buffer_load_dwordx4 v16, s[84:87], s6 offen sc1 lds
    s_add_u32 m0, s46, 10240
    s_add_u32 s6, s7, 50176
    buffer_load_dwordx4 v16, s[84:87], s6 offen sc1 lds
    s_add_u32 m0, s46, 12288
    s_add_u32 s6, s7, 99328
    buffer_load_dwordx4 v16, s[84:87], s6 offen sc1 lds
    s_add_u32 m0, s46, 14336
    s_add_u32 s6, s7, 148480
    buffer_load_dwordx4 v16, s[84:87], s6 offen sc1 lds
    s_add_u32 m0, s46, 16384
    s_add_u32 s6, s7, 197632
    buffer_load_dwordx4 v16, s[84:87], s6 offen sc1 lds
    s_add_u32 m0, s46, 0
    s_add_u32 s6, s50, 65536
    buffer_load_dwordx4 v21, s[80:83], s6 offen sc1 lds
    s_add_u32 m0, s46, 2048
    s_add_u32 s6, s50, 66560
    buffer_load_dwordx4 v21, s[80:83], s6 offen sc1 lds
    s_add_u32 m0, s46, 4096
    s_add_u32 s6, s50, 67584
    buffer_load_dwordx4 v21, s[80:83], s6 offen sc1 lds
    s_add_u32 m0, s46, 6144
    s_add_u32 s6, s50, 68608
    buffer_load_dwordx4 v21, s[80:83], s6 offen sc1 lds
    s_waitcnt vmcnt(13)
    s_barrier
    s_lshl_b32 s26, 1, s13
    s_sub_u32 s26, s26, 1
    s_lshl_b32 s27, s14, 8
    s_add_u32 s27, s27, 12288
    buffer_load_dword v20, v17, s[76:79], s27 offen sc1
    s_add_u32 m0, s46, 45056
    s_add_u32 s6, s7, 1280
    buffer_load_dwordx4 v16, s[84:87], s6 offen sc1 lds
    s_add_u32 m0, s46, 47104
    s_add_u32 s6, s7, 50432
    buffer_load_dwordx4 v16, s[84:87], s6 offen sc1 lds
    s_add_u32 m0, s46, 49152
    s_add_u32 s6, s7, 99584
    buffer_load_dwordx4 v16, s[84:87], s6 offen sc1 lds
    s_add_u32 m0, s46, 51200
    s_add_u32 s6, s7, 148736
    buffer_load_dwordx4 v16, s[84:87], s6 offen sc1 lds
    s_add_u32 m0, s46, 53248
    s_add_u32 s6, s7, 197888
    buffer_load_dwordx4 v16, s[84:87], s6 offen sc1 lds
    s_add_u32 m0, s46, 36864
    s_add_u32 s6, s50, 81920
    buffer_load_dwordx4 v21, s[80:83], s6 offen sc1 lds
    s_add_u32 m0, s46, 38912
    s_add_u32 s6, s50, 82944
    buffer_load_dwordx4 v21, s[80:83], s6 offen sc1 lds
    s_add_u32 m0, s46, 40960
    s_add_u32 s6, s50, 83968
    buffer_load_dwordx4 v21, s[80:83], s6 offen sc1 lds
    s_add_u32 m0, s46, 43008
    s_add_u32 s6, s50, 84992
    buffer_load_dwordx4 v21, s[80:83], s6 offen sc1 lds
    s_waitcnt vmcnt(19)
    s_barrier
    s_waitcnt vmcnt(9)
    v_readfirstlane_b32 s30, v20
    s_nop 3
    s_and_b32 s30, s30, s26
    s_cmp_eq_u32 s30, s26
    s_cbranch_scc1 U_eok_40
    s_mov_b32 s31, 0x100000
U_e_poll_41:
    buffer_load_dword v20, v17, s[76:79], s27 offen sc1
    s_waitcnt vmcnt(0)
    v_readfirstlane_b32 s30, v20
    s_nop 3
    s_and_b32 s30, s30, s26
    s_cmp_eq_u32 s30, s26
    s_cbranch_scc1 U_e_done_42
    s_sleep 2
    s_sub_u32 s31, s31, 1
    s_cmp_lg_u32 s31, 0
    s_cbranch_scc1 U_e_poll_41
U_e_done_42:
U_eok_40:
    s_mul_i32 s24, s14, 5120
    s_add_u32 s24, s24, 15728640
    s_add_u32 s64, s10, s24
    s_addc_u32 s65, s11, 0
    s_and_b32 s65, s65, 0xffff
    s_mov_b32 s66, 0x1400
    s_mov_b32 s67, 0x00020000
    v_lshlrev_b32 v18, 4, v1
    s_add_u32 m0, s4, 158720
    s_nop 0
    buffer_load_dwordx4 v18, s[64:67], s4 offen sc1 lds
    s_cmp_lg_u32 s17, 0
    s_cbranch_scc1 U_e5_43
    s_mov_b32 m0, 162816
    s_movk_i32 s24, 4096
    buffer_load_dwordx4 v18, s[64:67], s24 offen sc1 lds
U_e5_43:
    s_add_u32 m0, s46, 81920
    s_add_u32 s6, s7, 1536
    buffer_load_dwordx4 v16, s[84:87], s6 offen sc1 lds
    s_add_u32 m0, s46, 83968
    s_add_u32 s6, s7, 50688
    buffer_load_dwordx4 v16, s[84:87], s6 offen sc1 lds
    s_add_u32 m0, s46, 86016
    s_add_u32 s6, s7, 99840
    buffer_load_dwordx4 v16, s[84:87], s6 offen sc1 lds
    s_add_u32 m0, s46, 88064
    s_add_u32 s6, s7, 148992
    buffer_load_dwordx4 v16, s[84:87], s6 offen sc1 lds
    s_add_u32 m0, s46, 90112
    s_add_u32 s6, s7, 198144
    buffer_load_dwordx4 v16, s[84:87], s6 offen sc1 lds
    s_add_u32 m0, s46, 73728
    s_add_u32 s6, s50, 98304
    buffer_load_dwordx4 v21, s[80:83], s6 offen sc1 lds
    s_add_u32 m0, s46, 75776
    s_add_u32 s6, s50, 99328
    buffer_load_dwordx4 v21, s[80:83], s6 offen sc1 lds
    s_add_u32 m0, s46, 77824
    s_add_u32 s6, s50, 100352
    buffer_load_dwordx4 v21, s[80:83], s6 offen sc1 lds
    s_add_u32 m0, s46, 79872
    s_add_u32 s6, s50, 101376
    buffer_load_dwordx4 v21, s[80:83], s6 offen sc1 lds
    s_barrier
    s_add_u32 m0, s46, 118784
    s_add_u32 s6, s7, 1792
    buffer_load_dwordx4 v16, s[84:87], s6 offen sc1 lds
    s_add_u32 m0, s46, 120832
    s_add_u32 s6, s7, 50944
    buffer_load_dwordx4 v16, s[84:87], s6 offen sc1 lds
    s_add_u32 m0, s46, 122880
    s_add_u32 s6, s7, 100096
    buffer_load_dwordx4 v16, s[84:87], s6 offen sc1 lds
    s_add_u32 m0, s46, 124928
    s_add_u32 s6, s7, 149248
    buffer_load_dwordx4 v16, s[84:87], s6 offen sc1 lds
    s_add_u32 m0, s46, 126976
    s_add_u32 s6, s7, 198400
    buffer_load_dwordx4 v16, s[84:87], s6 offen sc1 lds
    s_add_u32 m0, s46, 110592
    s_add_u32 s6, s50, 114688
    buffer_load_dwordx4 v21, s[80:83], s6 offen sc1 lds
    s_add_u32 m0, s46, 112640
    s_add_u32 s6, s50, 115712
    buffer_load_dwordx4 v21, s[80:83], s6 offen sc1 lds
    s_add_u32 m0, s46, 114688
    s_add_u32 s6, s50, 116736
    buffer_load_dwordx4 v21, s[80:83], s6 offen sc1 lds
    s_add_u32 m0, s46, 116736
    s_add_u32 s6, s50, 117760
    buffer_load_dwordx4 v21, s[80:83], s6 offen sc1 lds
    s_waitcnt vmcnt(19)
    s_waitcnt vmcnt(18)
    s_barrier
    s_add_u32 m0, s46, 8192
    s_add_u32 s6, s7, 2048
    buffer_load_dwordx4 v16, s[84:87], s6 offen sc1 lds
    s_add_u32 m0, s46, 10240
    s_add_u32 s6, s7, 51200
    buffer_load_dwordx4 v16, s[84:87], s6 offen sc1 lds
    s_add_u32 m0, s46, 12288
    s_add_u32 s6, s7, 100352
    buffer_load_dwordx4 v16, s[84:87], s6 offen sc1 lds
    s_add_u32 m0, s46, 14336
    s_add_u32 s6, s7, 149504
    buffer_load_dwordx4 v16, s[84:87], s6 offen sc1 lds
    s_add_u32 m0, s46, 16384
    s_add_u32 s6, s7, 198656
    buffer_load_dwordx4 v16, s[84:87], s6 offen sc1 lds
    s_add_u32 m0, s46, 0
    s_add_u32 s6, s50, 131072
    buffer_load_dwordx4 v21, s[80:83], s6 offen sc1 lds
    s_add_u32 m0, s46, 2048
    s_add_u32 s6, s50, 132096
    buffer_load_dwordx4 v21, s[80:83], s6 offen sc1 lds
    s_add_u32 m0, s46, 4096
    s_add_u32 s6, s50, 133120
    buffer_load_dwordx4 v21, s[80:83], s6 offen sc1 lds
    s_add_u32 m0, s46, 6144
    s_add_u32 s6, s50, 134144
    buffer_load_dwordx4 v21, s[80:83], s6 offen sc1 lds
    s_waitcnt vmcnt(18)
    s_barrier
    s_add_u32 m0, s46, 45056
    s_add_u32 s6, s7, 2304
    buffer_load_dwordx4 v16, s[84:87], s6 offen sc1 lds
    s_add_u32 m0, s46, 47104
    s_add_u32 s6, s7, 51456
    buffer_load_dwordx4 v16, s[84:87], s6 offen sc1 lds
    s_add_u32 m0, s46, 49152
    s_add_u32 s6, s7, 100608
    buffer_load_dwordx4 v16, s[84:87], s6 offen sc1 lds
    s_add_u32 m0, s46, 51200
    s_add_u32 s6, s7, 149760
    buffer_load_dwordx4 v16, s[84:87], s6 offen sc1 lds
    s_add_u32 m0, s46, 53248
    s_add_u32 s6, s7, 198912
    buffer_load_dwordx4 v16, s[84:87], s6 offen sc1 lds
    s_add_u32 m0, s46, 36864
    s_add_u32 s6, s50, 147456
    buffer_load_dwordx4 v21, s[80:83], s6 offen sc1 lds
    s_add_u32 m0, s46, 38912
    s_add_u32 s6, s50, 148480
    buffer_load_dwordx4 v21, s[80:83], s6 offen sc1 lds
    s_add_u32 m0, s46, 40960
    s_add_u32 s6, s50, 149504
    buffer_load_dwordx4 v21, s[80:83], s6 offen sc1 lds
    s_add_u32 m0, s46, 43008
    s_add_u32 s6, s50, 150528
    buffer_load_dwordx4 v21, s[80:83], s6 offen sc1 lds
    s_waitcnt vmcnt(18)
    s_barrier
    s_add_u32 m0, s46, 81920
    s_add_u32 s6, s7, 2560
    buffer_load_dwordx4 v16, s[84:87], s6 offen sc1 lds
    s_add_u32 m0, s46, 83968
    s_add_u32 s6, s7, 51712
    buffer_load_dwordx4 v16, s[84:87], s6 offen sc1 lds
    s_add_u32 m0, s46, 86016
    s_add_u32 s6, s7, 100864
    buffer_load_dwordx4 v16, s[84:87], s6 offen sc1 lds
    s_add_u32 m0, s46, 88064
    s_add_u32 s6, s7, 150016
    buffer_load_dwordx4 v16, s[84:87], s6 offen sc1 lds
    s_add_u32 m0, s46, 90112
    s_add_u32 s6, s7, 199168
    buffer_load_dwordx4 v16, s[84:87], s6 offen sc1 lds
    s_add_u32 m0, s46, 73728
    s_add_u32 s6, s50, 163840
    buffer_load_dwordx4 v21, s[80:83], s6 offen sc1 lds
    s_add_u32 m0, s46, 75776
    s_add_u32 s6, s50, 164864
    buffer_load_dwordx4 v21, s[80:83], s6 offen sc1 lds
    s_add_u32 m0, s46, 77824
    s_add_u32 s6, s50, 165888
    buffer_load_dwordx4 v21, s[80:83], s6 offen sc1 lds
    s_add_u32 m0, s46, 79872
    s_add_u32 s6, s50, 166912
    buffer_load_dwordx4 v21, s[80:83], s6 offen sc1 lds
    s_waitcnt vmcnt(18)
    s_barrier
    s_lshl_b32 s25, s15, 8
    s_add_u32 s25, s25, 16384
    buffer_load_dword v19, v17, s[76:79], s25 offen sc1
    s_add_u32 m0, s46, 118784
    s_add_u32 s6, s7, 2816
    buffer_load_dwordx4 v16, s[84:87], s6 offen sc1 lds
    s_add_u32 m0, s46, 120832
    s_add_u32 s6, s7, 51968
    buffer_load_dwordx4 v16, s[84:87], s6 offen sc1 lds
    s_add_u32 m0, s46, 122880
    s_add_u32 s6, s7, 101120
    buffer_load_dwordx4 v16, s[84:87], s6 offen sc1 lds
    s_add_u32 m0, s46, 124928
    s_add_u32 s6, s7, 150272
    buffer_load_dwordx4 v16, s[84:87], s6 offen sc1 lds
    s_add_u32 m0, s46, 126976
    s_add_u32 s6, s7, 199424
    buffer_load_dwordx4 v16, s[84:87], s6 offen sc1 lds
    s_add_u32 m0, s46, 110592
    s_add_u32 s6, s50, 180224
    buffer_load_dwordx4 v21, s[80:83], s6 offen sc1 lds
    s_add_u32 m0, s46, 112640
    s_add_u32 s6, s50, 181248
    buffer_load_dwordx4 v21, s[80:83], s6 offen sc1 lds
    s_add_u32 m0, s46, 114688
    s_add_u32 s6, s50, 182272
    buffer_load_dwordx4 v21, s[80:83], s6 offen sc1 lds
    s_add_u32 m0, s46, 116736
    s_add_u32 s6, s50, 183296
    buffer_load_dwordx4 v21, s[80:83], s6 offen sc1 lds
    s_waitcnt vmcnt(19)
    s_barrier
    s_add_u32 m0, s46, 8192
    s_add_u32 s6, s8, 0
    buffer_load_dwordx4 v5, s[92:95], s6 offen lds
    s_add_u32 m0, s46, 10240
    s_add_u32 s6, s8, 20480
    buffer_load_dwordx4 v5, s[92:95], s6 offen lds
    s_add_u32 m0, s46, 12288
    s_add_u32 s6, s8, 40960
    buffer_load_dwordx4 v5, s[92:95], s6 offen lds
    s_add_u32 m0, s46, 14336
    s_add_u32 s6, s8, 61440
    buffer_load_dwordx4 v5, s[92:95], s6 offen lds
    s_add_u32 m0, s46, 16384
    s_add_u32 s6, s8, 81920
    buffer_load_dwordx4 v5, s[92:95], s6 offen lds
    s_waitcnt vmcnt(14)
    v_readfirstlane_b32 s30, v19
    s_nop 3
    s_cmp_ge_u32 s30, 32
    s_cbranch_scc1 U_htok_44
    s_mov_b32 s31, 0x100000
U_ht_poll_45:
    buffer_load_dword v19, v17, s[76:79], s25 offen sc1
    s_waitcnt vmcnt(0)
    v_readfirstlane_b32 s30, v19
    s_nop 3
    s_cmp_ge_u32 s30, 32
    s_cbranch_scc1 U_ht_done_46
    s_sleep 4
    s_sub_u32 s31, s31, 1
    s_cmp_lg_u32 s31, 0
    s_cbranch_scc1 U_ht_poll_45
U_ht_done_46:
U_htok_44:
    s_add_u32 m0, s46, 0
    s_add_u32 s6, s9, 0
    buffer_load_dwordx4 v10, s[88:91], s6 offen sc1 lds
    s_add_u32 m0, s46, 2048
    s_add_u32 s6, s9, 1024
    buffer_load_dwordx4 v10, s[88:91], s6 offen sc1 lds
    s_add_u32 m0, s46, 4096
    s_add_u32 s6, s9, 2048
    buffer_load_dwordx4 v10, s[88:91], s6 offen sc1 lds
    s_add_u32 m0, s46, 6144
    s_add_u32 s6, s9, 3072
    buffer_load_dwordx4 v10, s[88:91], s6 offen sc1 lds
    s_barrier
    s_add_u32 m0, s46, 45056
    s_add_u32 s6, s8, 256
    buffer_load_dwordx4 v5, s[92:95], s6 offen lds
    s_add_u32 m0, s46, 47104
    s_add_u32 s6, s8, 20736
    buffer_load_dwordx4 v5, s[92:95], s6 offen lds
    s_add_u32 m0, s46, 49152
    s_add_u32 s6, s8, 41216
    buffer_load_dwordx4 v5, s[92:95], s6 offen lds
    s_add_u32 m0, s46, 51200
    s_add_u32 s6, s8, 61696
    buffer_load_dwordx4 v5, s[92:95], s6 offen lds
    s_add_u32 m0, s46, 53248
    s_add_u32 s6, s8, 82176
    buffer_load_dwordx4 v5, s[92:95], s6 offen lds
    s_add_u32 m0, s46, 36864
    s_add_u32 s6, s9, 8192
    buffer_load_dwordx4 v10, s[88:91], s6 offen sc1 lds
    s_add_u32 m0, s46, 38912
    s_add_u32 s6, s9, 9216
    buffer_load_dwordx4 v10, s[88:91], s6 offen sc1 lds
    s_add_u32 m0, s46, 40960
    s_add_u32 s6, s9, 10240
    buffer_load_dwordx4 v10, s[88:91], s6 offen sc1 lds
    s_add_u32 m0, s46, 43008
    s_add_u32 s6, s9, 11264
    buffer_load_dwordx4 v10, s[88:91], s6 offen sc1 lds
    s_waitcnt vmcnt(18)
    s_barrier
    s_add_u32 m0, s46, 81920
    s_add_u32 s6, s8, 512
    buffer_load_dwordx4 v5, s[92:95], s6 offen lds
    s_add_u32 m0, s46, 83968
    s_add_u32 s6, s8, 20992
    buffer_load_dwordx4 v5, s[92:95], s6 offen lds
    s_add_u32 m0, s46, 86016
    s_add_u32 s6, s8, 41472
    buffer_load_dwordx4 v5, s[92:95], s6 offen lds
    s_add_u32 m0, s46, 88064
    s_add_u32 s6, s8, 61952
    buffer_load_dwordx4 v5, s[92:95], s6 offen lds
    s_add_u32 m0, s46, 90112
    s_add_u32 s6, s8, 82432
    buffer_load_dwordx4 v5, s[92:95], s6 offen lds
    s_add_u32 m0, s46, 73728
    s_add_u32 s6, s9, 16384
    buffer_load_dwordx4 v10, s[88:91], s6 offen sc1 lds
    s_add_u32 m0, s46, 75776
    s_add_u32 s6, s9, 17408
    buffer_load_dwordx4 v10, s[88:91], s6 offen sc1 lds
    s_add_u32 m0, s46, 77824
    s_add_u32 s6, s9, 18432
    buffer_load_dwordx4 v10, s[88:91], s6 offen sc1 lds
    s_add_u32 m0, s46, 79872
    s_add_u32 s6, s9, 19456
    buffer_load_dwordx4 v10, s[88:91], s6 offen sc1 lds
    s_waitcnt vmcnt(18)
    s_barrier
    s_add_u32 m0, s46, 118784
    s_add_u32 s6, s8, 768
    buffer_load_dwordx4 v5, s[92:95], s6 offen lds
    s_add_u32 m0, s46, 120832
    s_add_u32 s6, s8, 21248
    buffer_load_dwordx4 v5, s[92:95], s6 offen lds
    s_add_u32 m0, s46, 122880
    s_add_u32 s6, s8, 41728
    buffer_load_dwordx4 v5, s[92:95], s6 offen lds
    s_add_u32 m0, s46, 124928
    s_add_u32 s6, s8, 62208
    buffer_load_dwordx4 v5, s[92:95], s6 offen lds
    s_add_u32 m0, s46, 126976
    s_add_u32 s6, s8, 82688
    buffer_load_dwordx4 v5, s[92:95], s6 offen lds
    s_add_u32 m0, s46, 110592
    s_add_u32 s6, s9, 24576
    buffer_load_dwordx4 v10, s[88:91], s6 offen sc1 lds
    s_add_u32 m0, s46, 112640
    s_add_u32 s6, s9, 25600
    buffer_load_dwordx4 v10, s[88:91], s6 offen sc1 lds
    s_add_u32 m0, s46, 114688
    s_add_u32 s6, s9, 26624
    buffer_load_dwordx4 v10, s[88:91], s6 offen sc1 lds
    s_add_u32 m0, s46, 116736
    s_add_u32 s6, s9, 27648
    buffer_load_dwordx4 v10, s[88:91], s6 offen sc1 lds
    s_waitcnt vmcnt(18)
    s_barrier
    s_add_u32 m0, s46, 8192
    s_add_u32 s6, s8, 1024
    buffer_load_dwordx4 v5, s[92:95], s6 offen lds
    s_add_u32 m0, s46, 10240
    s_add_u32 s6, s8, 21504
    buffer_load_dwordx4 v5, s[92:95], s6 offen lds
    s_add_u32 m0, s46, 12288
    s_add_u32 s6, s8, 41984
    buffer_load_dwordx4 v5, s[92:95], s6 offen lds
    s_add_u32 m0, s46, 14336
    s_add_u32 s6, s8, 62464
    buffer_load_dwordx4 v5, s[92:95], s6 offen lds
    s_add_u32 m0, s46, 16384
    s_add_u32 s6, s8, 82944
    buffer_load_dwordx4 v5, s[92:95], s6 offen lds
    s_add_u32 m0, s46, 0
    s_add_u32 s6, s9, 32768
    buffer_load_dwordx4 v10, s[88:91], s6 offen sc1 lds
    s_add_u32 m0, s46, 2048
    s_add_u32 s6, s9, 33792
    buffer_load_dwordx4 v10, s[88:91], s6 offen sc1 lds
    s_add_u32 m0, s46, 4096
    s_add_u32 s6, s9, 34816
    buffer_load_dwordx4 v10, s[88:91], s6 offen sc1 lds
    s_add_u32 m0, s46, 6144
    s_add_u32 s6, s9, 35840
    buffer_load_dwordx4 v10, s[88:91], s6 offen sc1 lds
    s_waitcnt vmcnt(18)
    s_barrier
    s_add_u32 m0, s46, 45056
    s_add_u32 s6, s8, 0
    buffer_load_dwordx4 v5, s[96:99], s6 offen lds
    s_add_u32 m0, s46, 47104
    s_add_u32 s6, s8, 20480
    buffer_load_dwordx4 v5, s[96:99], s6 offen lds
    s_add_u32 m0, s46, 49152
    s_add_u32 s6, s8, 40960
    buffer_load_dwordx4 v5, s[96:99], s6 offen lds
    s_add_u32 m0, s46, 51200
    s_add_u32 s6, s8, 61440
    buffer_load_dwordx4 v5, s[96:99], s6 offen lds
    s_add_u32 m0, s46, 53248
    s_add_u32 s6, s8, 81920
    buffer_load_dwordx4 v5, s[96:99], s6 offen lds
    s_add_u32 m0, s46, 36864
    s_add_u32 s6, s9, 40960
    buffer_load_dwordx4 v10, s[88:91], s6 offen sc1 lds
    s_add_u32 m0, s46, 38912
    s_add_u32 s6, s9, 41984
    buffer_load_dwordx4 v10, s[88:91], s6 offen sc1 lds
    s_add_u32 m0, s46, 40960
    s_add_u32 s6, s9, 43008
    buffer_load_dwordx4 v10, s[88:91], s6 offen sc1 lds
    s_add_u32 m0, s46, 43008
    s_add_u32 s6, s9, 44032
    buffer_load_dwordx4 v10, s[88:91], s6 offen sc1 lds
    s_waitcnt vmcnt(18)
    s_barrier
    s_add_u32 m0, s46, 81920
    s_add_u32 s6, s8, 256
    buffer_load_dwordx4 v5, s[96:99], s6 offen lds
    s_add_u32 m0, s46, 83968
    s_add_u32 s6, s8, 20736
    buffer_load_dwordx4 v5, s[96:99], s6 offen lds
    s_add_u32 m0, s46, 86016
    s_add_u32 s6, s8, 41216
    buffer_load_dwordx4 v5, s[96:99], s6 offen lds
    s_add_u32 m0, s46, 88064
    s_add_u32 s6, s8, 61696
    buffer_load_dwordx4 v5, s[96:99], s6 offen lds
    s_add_u32 m0, s46, 90112
    s_add_u32 s6, s8, 82176
    buffer_load_dwordx4 v5, s[96:99], s6 offen lds
    s_add_u32 m0, s46, 73728
    s_add_u32 s6, s9, 49152
    buffer_load_dwordx4 v10, s[88:91], s6 offen sc1 lds
    s_add_u32 m0, s46, 75776
    s_add_u32 s6, s9, 50176
    buffer_load_dwordx4 v10, s[88:91], s6 offen sc1 lds
    s_add_u32 m0, s46, 77824
    s_add_u32 s6, s9, 51200
    buffer_load_dwordx4 v10, s[88:91], s6 offen sc1 lds
    s_add_u32 m0, s46, 79872
    s_add_u32 s6, s9, 52224
    buffer_load_dwordx4 v10, s[88:91], s6 offen sc1 lds
    s_waitcnt vmcnt(18)
    s_barrier
    s_add_u32 m0, s46, 118784
    s_add_u32 s6, s8, 512
    buffer_load_dwordx4 v5, s[96:99], s6 offen lds
    s_add_u32 m0, s46, 120832
    s_add_u32 s6, s8, 20992
    buffer_load_dwordx4 v5, s[96:99], s6 offen lds
    s_add_u32 m0, s46, 122880
    s_add_u32 s6, s8, 41472
    buffer_load_dwordx4 v5, s[96:99], s6 offen lds
    s_add_u32 m0, s46, 124928
    s_add_u32 s6, s8, 61952
    buffer_load_dwordx4 v5, s[96:99], s6 offen lds
    s_add_u32 m0, s46, 126976
    s_add_u32 s6, s8, 82432
    buffer_load_dwordx4 v5, s[96:99], s6 offen lds
    s_add_u32 m0, s46, 110592
    s_add_u32 s6, s9, 57344
    buffer_load_dwordx4 v10, s[88:91], s6 offen sc1 lds
    s_add_u32 m0, s46, 112640
    s_add_u32 s6, s9, 58368
    buffer_load_dwordx4 v10, s[88:91], s6 offen sc1 lds
    s_add_u32 m0, s46, 114688
    s_add_u32 s6, s9, 59392
    buffer_load_dwordx4 v10, s[88:91], s6 offen sc1 lds
    s_add_u32 m0, s46, 116736
    s_add_u32 s6, s9, 60416
    buffer_load_dwordx4 v10, s[88:91], s6 offen sc1 lds
    s_waitcnt vmcnt(18)
    s_barrier
    s_add_u32 m0, s46, 8192
    s_add_u32 s6, s8, 768
    buffer_load_dwordx4 v5, s[96:99], s6 offen lds
    s_add_u32 m0, s46, 10240
    s_add_u32 s6, s8, 21248
    buffer_load_dwordx4 v5, s[96:99], s6 offen lds
    s_add_u32 m0, s46, 12288
    s_add_u32 s6, s8, 41728
    buffer_load_dwordx4 v5, s[96:99], s6 offen lds
    s_add_u32 m0, s46, 14336
    s_add_u32 s6, s8, 62208
    buffer_load_dwordx4 v5, s[96:99], s6 offen lds
    s_add_u32 m0, s46, 16384
    s_add_u32 s6, s8, 82688
    buffer_load_dwordx4 v5, s[96:99], s6 offen lds
    s_add_u32 m0, s46, 0
    s_add_u32 s6, s9, 65536
    buffer_load_dwordx4 v10, s[88:91], s6 offen sc1 lds
    s_add_u32 m0, s46, 2048
    s_add_u32 s6, s9, 66560
    buffer_load_dwordx4 v10, s[88:91], s6 offen sc1 lds
    s_add_u32 m0, s46, 4096
    s_add_u32 s6, s9, 67584
    buffer_load_dwordx4 v10, s[88:91], s6 offen sc1 lds
    s_add_u32 m0, s46, 6144
    s_add_u32 s6, s9, 68608
    buffer_load_dwordx4 v10, s[88:91], s6 offen sc1 lds
    s_waitcnt vmcnt(18)
    s_barrier
    s_add_u32 m0, s46, 45056
    s_add_u32 s6, s8, 1024
    buffer_load_dwordx4 v5, s[96:99], s6 offen lds
    s_add_u32 m0, s46, 47104
    s_add_u32 s6, s8, 21504
    buffer_load_dwordx4 v5, s[96:99], s6 offen lds
    s_add_u32 m0, s46, 49152
    s_add_u32 s6, s8, 41984
    buffer_load_dwordx4 v5, s[96:99], s6 offen lds
    s_add_u32 m0, s46, 51200
    s_add_u32 s6, s8, 62464
    buffer_load_dwordx4 v5, s[96:99], s6 offen lds
    s_add_u32 m0, s46, 53248
    s_add_u32 s6, s8, 82944
    buffer_load_dwordx4 v5, s[96:99], s6 offen lds
    s_add_u32 m0, s46, 36864
    s_add_u32 s6, s9, 73728
    buffer_load_dwordx4 v10, s[88:91], s6 offen sc1 lds
    s_add_u32 m0, s46, 38912
    s_add_u32 s6, s9, 74752
    buffer_load_dwordx4 v10, s[88:91], s6 offen sc1 lds
    s_add_u32 m0, s46, 40960
    s_add_u32 s6, s9, 75776
    buffer_load_dwordx4 v10, s[88:91], s6 offen sc1 lds
    s_add_u32 m0, s46, 43008
    s_add_u32 s6, s9, 76800
    buffer_load_dwordx4 v10, s[88:91], s6 offen sc1 lds
    s_waitcnt vmcnt(18)
    s_barrier
    s_lshl_b32 s24, s15, 6
    s_mul_i32 s24, s24, 1280
    s_mul_i32 s25, s16, 160
    s_add_u32 s24, s24, s25
    s_add_u32 s64, s32, s24
    s_addc_u32 s65, s33, 0
    s_and_b32 s65, s65, 0xffff
    s_mov_b32 s66, 0x13ba0
    s_mov_b32 s67, 0x00020000
    s_add_u32 s24, s24, 0
    s_add_u32 s68, s10, s24
    s_addc_u32 s69, s11, 0
    s_and_b32 s69, s69, 0xffff
    s_mov_b32 s70, 0x13ba0
    s_mov_b32 s71, 0x00020000
    s_lshl_b32 s24, s17, 6
    v_add_u32 v18, s24, v1
    v_mul_u32_u24 v19, 6554, v18
    v_lshrrev_b32 v19, 16, v19
    v_mul_u32_u24 v20, 10, v19
    v_sub_u32 v20, v18, v20
    v_mul_u32_u24 v23, 1280, v19
    v_lshl_add_u32 v23, v20, 4, v23
    v_and_b32 v24, 0xffe3, v19
    v_lshrrev_b32 v25, 2, v19
    v_and_b32 v25, 1, v25
    v_lshl_add_u32 v24, v25, 4, v24
    v_lshrrev_b32 v25, 3, v19
    v_and_b32 v25, 3, v25
    v_lshl_add_u32 v24, v25, 2, v24
    v_mul_u32_u24 v24, 1280, v24
    v_lshl_add_u32 v24, v20, 4, v24
    s_add_u32 m0, s4, 73728
    s_nop 0
    buffer_load_dwordx4 v23, s[64:67], 0 offen lds
    s_add_u32 m0, s4, 83968
    s_nop 0
    buffer_load_dwordx4 v24, s[68:71], 0 offen sc1 lds
    v_add_u32 v18, s24, v1
    v_add_u32 v18, 256, v18
    v_mul_u32_u24 v19, 6554, v18
    v_lshrrev_b32 v19, 16, v19
    v_mul_u32_u24 v20, 10, v19
    v_sub_u32 v20, v18, v20
    v_mul_u32_u24 v23, 1280, v19
    v_lshl_add_u32 v23, v20, 4, v23
    v_and_b32 v24, 0xffe3, v19
    v_lshrrev_b32 v25, 2, v19
    v_and_b32 v25, 1, v25
    v_lshl_add_u32 v24, v25, 4, v24
    v_lshrrev_b32 v25, 3, v19
    v_and_b32 v25, 3, v25
    v_lshl_add_u32 v24, v25, 2, v24
    v_mul_u32_u24 v24, 1280, v24
    v_lshl_add_u32 v24, v20, 4, v24
    s_add_u32 m0, s4, 77824
    s_nop 0
    buffer_load_dwordx4 v23, s[64:67], 0 offen lds
    s_add_u32 m0, s4, 88064
    s_nop 0
    buffer_load_dwordx4 v24, s[68:71], 0 offen sc1 lds
    v_add_u32 v18, s24, v1
    v_add_u32 v18, 512, v18
    v_mul_u32_u24 v19, 6554, v18
    v_lshrrev_b32 v19, 16, v19
    v_mul_u32_u24 v20, 10, v19
    v_sub_u32 v20, v18, v20
    v_mul_u32_u24 v23, 1280, v19
    v_lshl_add_u32 v23, v20, 4, v23
    v_and_b32 v24, 0xffe3, v19
    v_lshrrev_b32 v25, 2, v19
    v_and_b32 v25, 1, v25
    v_lshl_add_u32 v24, v25, 4, v24
    v_lshrrev_b32 v25, 3, v19
    v_and_b32 v25, 3, v25
    v_lshl_add_u32 v24, v25, 2, v24
    v_mul_u32_u24 v24, 1280, v24
    v_lshl_add_u32 v24, v20, 4, v24
    s_cmp_ge_u32 s17, 2
    s_cbranch_scc1 U_x3_47
    s_add_u32 m0, s4, 81920
    s_nop 0
    buffer_load_dwordx4 v23, s[64:67], 0 offen lds
    s_add_u32 m0, s4, 92160
    s_nop 0
    buffer_load_dwordx4 v24, s[68:71], 0 offen sc1 lds
U_x3_47:
    s_waitcnt vmcnt(13)
    s_barrier
    s_waitcnt vmcnt(4)
    s_barrier
    s_waitcnt vmcnt(0)
    s_barrier
U_end_1:
    s_endpgm
U_code_end:
.section .rodata,"a"
.p2align 6
.amdhsa_kernel recurrent_scan__ssm_conv_s5__dense_activation_gelu__prompt_kernel
  .amdhsa_next_free_vgpr 256
  .amdhsa_next_free_sgpr 102
  .amdhsa_accum_offset 256
  .amdhsa_group_segment_fixed_size 0
  .amdhsa_kernarg_size 136
  .amdhsa_user_sgpr_count 2
  .amdhsa_user_sgpr_kernarg_segment_ptr 1
  .amdhsa_system_sgpr_workgroup_id_x 1
.end_amdhsa_kernel
```
